```python
import torch

def _softmax(x, axis=-1):
    return torch.softmax(x, dim=axis)

def _gelu(x):
    return torch.nn.functional.gelu(x, approximate='tanh')

def _silu(x):
    return torch.nn.functional.silu(x)

def _sigmoid(x):
    return torch.sigmoid(x)

def _layernorm(x, axis=-1, eps=1e-05):
    m = x.mean(dim=axis, keepdim=True)
    v = x.var(dim=axis, keepdim=True, unbiased=False)
    return (x - m) / torch.sqrt(v + eps)

def _scatter_add(tgt, idx, src, axis=0):
    return tgt.clone().index_add_(axis, idx, src)

def _segment_sum(src, seg, n):
    out = torch.zeros((n,) + src.shape[1:], dtype=src.dtype)
    return out.index_add_(0, seg, src)

def _pad(x, pw):
    flat = tuple((v for pair in reversed(pw) for v in pair))
    return torch.nn.functional.pad(x, flat)
kernel_name = 'adaLN_cond__compressed_kv_cla__moe_arch_mod__prompt'

def setup_inputs():

    _w = lambda a: (lambda t: t.to(torch.bfloat16) if t.is_floating_point() else t)(torch.as_tensor(a))

    def _A_setup():
        B, H, Sq, Sk, D, M = (1, 32, 2048, 2048, 128, 640)
        Dc = 4 * D
        return {'x': _w((lambda *s: torch.randn(*s, dtype=torch.bfloat16) * 0.1)(B, Sq, M)), 'c_kv': _w((lambda *s: torch.randn(*s, dtype=torch.bfloat16) * 1.6)(B, Sk, Dc)), 'w_q': _w((lambda *s: torch.randn(*s, dtype=torch.bfloat16) * 0.8)(M, H, D) * M ** (-0.5)), 'w_uk': _w((lambda *s: torch.randn(*s, dtype=torch.bfloat16) * 0.8)(Dc, H, D) * Dc ** (-0.5)), 'w_uv': _w((lambda *s: torch.randn(*s, dtype=torch.bfloat16) * 1.6)(Dc, H, D) * Dc ** (-0.5)), 'w_o': _w((lambda *s: torch.randn(*s, dtype=torch.bfloat16) * 1.6)(H, D, M) * (H * D) ** (-0.5))}
    _A_in = _A_setup()

    def _B_setup():
        B, S, D, F, C = (1, 2048, 640, 1728, 8)
        return {'x': _w((lambda *s: torch.randn(*s, dtype=torch.bfloat16) * 0.1)(B, S, D)), 'w_r': _w((lambda *s: torch.randn(*s, dtype=torch.bfloat16) * 0.1)(D)), 'w_gate': _w((lambda *s: torch.randn(*s, dtype=torch.bfloat16) * 0.1)(D, F)), 'w_up': _w((lambda *s: torch.randn(*s, dtype=torch.bfloat16) * 0.1)(D, F)), 'w_down': _w((lambda *s: torch.randn(*s, dtype=torch.bfloat16) * 0.1)(F, D))}
    _B_in = _B_setup()
    return {'A_x': _A_in['x'], 'A_c_kv': _A_in['c_kv'], 'A_w_q': _A_in['w_q'], 'A_w_uk': _A_in['w_uk'], 'A_w_uv': _A_in['w_uv'], 'A_w_o': _A_in['w_o'], 'B_x': _B_in['x'], 'B_w_r': _B_in['w_r'], 'B_w_gate': _B_in['w_gate'], 'B_w_up': _B_in['w_up'], 'B_w_down': _B_in['w_down'], 'c': _w((lambda *s: torch.randn(*s, dtype=torch.bfloat16) * 0.2)(1, 640) * 8.0), 'w_mod': _w((lambda *s: torch.randn(*s, dtype=torch.bfloat16) * 0.2)(640, 6 * 640) * 640 ** (-0.5) * 8.0)}

def reference(A_x, A_c_kv, A_w_q, A_w_uk, A_w_uv, A_w_o, B_x, B_w_r, B_w_gate, B_w_up, B_w_down, c, w_mod):

    def _A_ref(x, c_kv, w_q, w_uk, w_uv, w_o):
        B, Sq, M = (x.shape[0], x.shape[1], x.shape[2])
        Sk = c_kv.shape[1]
        H, D = (w_q.shape[1], w_q.shape[2])
        q = torch.einsum('bqm,mhd->bhqd', x, w_q)
        k = torch.einsum('bkc,chd->bhkd', c_kv, w_uk)
        v = torch.einsum('bkc,chd->bhkd', c_kv, w_uv)
        scores = torch.einsum('bhqd,bhkd->bhqk', q, k) * D ** (-0.5)
        off = Sk - Sq
        qi = torch.arange(Sq)[:, None]
        kj = torch.arange(Sk)[None, :]
        cmask = kj <= qi + off
        scores = torch.where(cmask[None, None], scores, -1000000000.0)
        p = _softmax(scores, axis=-1)
        ctx = torch.einsum('bhqk,bhkd->bhqd', p, v)
        return torch.einsum('bhqd,hdm->bqm', ctx, w_o)

    def _B_ref(x, w_r, w_gate, w_up, w_down):
        B, S, D = x.shape
        C = 8
        r = x @ w_r
        idx = torch.argsort(-r, axis=-1)[:, :C]
        idx_e = (lambda x, n, axis: torch.repeat_interleave(x, n, dim=axis))(idx.reshape(B, C, 1), D, axis=2)
        x_sel = (lambda x, i, axis: torch.take_along_dim(x, i, dim=axis))(x, idx_e, axis=1)
        g = _silu(x_sel @ w_gate)
        u = x_sel @ w_up
        y = g * u @ w_down
        r_sel = _sigmoid((lambda x, i, axis: torch.take_along_dim(x, i, dim=axis))(r, idx, axis=1))
        y = y * r_sel.reshape(B, C, 1)
        b_off = (torch.arange(B) * S).reshape(B, 1)
        flat_idx = (idx + b_off).reshape(B * C)
        zero = (x * 0.0).reshape(B * S, D)
        upd = _scatter_add(zero, flat_idx, y.reshape(B * C, D), axis=0)
        return x + upd.reshape(B, S, D)
    x = A_x
    mod = (_silu(c) @ w_mod).reshape(c.shape[0], 6, 1, -1)
    sa, ca, ga, sb, cb, gb = (mod[:, 0].clone(), mod[:, 1].clone(), mod[:, 2].clone(), mod[:, 3].clone(), mod[:, 4].clone(), mod[:, 5].clone())
    h = _layernorm(x, axis=-1) * (1 + ca) + sa
    x = x + ga * _A_ref(h, A_c_kv, A_w_q, A_w_uk, A_w_uv, A_w_o)
    h = _layernorm(x, axis=-1) * (1 + cb) + sb
    x = x + gb * _B_ref(h, B_w_r, B_w_gate, B_w_up, B_w_down)
    return x
```

```asm
; @launch kernel=kva_kernel grid=(256,1,1) block=(512,1,1) lds=163840
; @launch kernel=tail_kernel grid=(256,1,1) block=(768,1,1) lds=66048
.amdgcn_target "amdgcn-amd-amdhsa--gfx950"
.text
.globl kva_kernel
.p2align 8
.type kva_kernel,@function
kva_kernel:
  s_load_dwordx2 s[4:5], s[0:1], 8
  s_load_dwordx2 s[8:9], s[0:1], 24
  s_load_dwordx2 s[12:13], s[0:1], 32
  s_load_dwordx2 s[16:17], s[0:1], 120
  s_load_dwordx2 s[20:21], s[0:1], 120
  s_load_dwordx2 s[24:25], s[0:1], 88
  s_load_dwordx2 s[28:29], s[0:1], 96
  s_load_dwordx2 s[32:33], s[0:1], 120
  s_load_dwordx2 s[36:37], s[0:1], 112
  s_load_dwordx2 s[40:41], s[0:1], 0
  s_load_dwordx2 s[44:45], s[0:1], 120
  s_load_dwordx2 s[48:49], s[0:1], 96
  s_load_dwordx2 s[52:53], s[0:1], 120
  s_load_dwordx2 s[56:57], s[0:1], 112
  s_load_dwordx2 s[84:85], s[0:1], 120
  s_load_dwordx2 s[76:77], s[0:1], 16
  s_load_dwordx2 s[80:81], s[0:1], 40
  s_waitcnt lgkmcnt(0)
  s_mov_b32 s6, 2097152
  s_mov_b32 s7, 0x00020000
  s_mov_b32 s10, 4194304
  s_mov_b32 s11, 0x00020000
  s_mov_b32 s14, 4194304
  s_mov_b32 s15, 0x00020000
  s_add_u32 s16, s16, 16777216
  s_addc_u32 s17, s17, 0
  s_mov_b32 s18, 16777216
  s_mov_b32 s19, 0x00020000
  s_add_u32 s20, s20, 33554432
  s_addc_u32 s21, s21, 0
  s_mov_b32 s22, 16777216
  s_mov_b32 s23, 0x00020000
  s_mov_b32 s26, 1280
  s_mov_b32 s27, 0x00020000
  s_mov_b32 s30, 4915200
  s_mov_b32 s31, 0x00020000
  s_add_u32 s32, s32, 32768
  s_addc_u32 s33, s33, 0
  s_mov_b32 s34, 2560
  s_mov_b32 s35, 0x00020000
  s_mov_b32 s38, 256
  s_mov_b32 s39, 0x00020000
  s_mov_b32 s42, 2621440
  s_mov_b32 s43, 0x00020000
  s_add_u32 s44, s44, 1048576
  s_addc_u32 s45, s45, 0
  s_mov_b32 s46, 3145728
  s_mov_b32 s47, 0x00020000
  s_mov_b32 s50, 4915200
  s_mov_b32 s51, 0x00020000
  s_mov_b32 s54, 64
  s_mov_b32 s55, 0x00020000
  s_mov_b32 s58, 4
  s_mov_b32 s59, 0x00020000
  s_add_u32 s84, s84, 32768
  s_addc_u32 s85, s85, 0
  s_mov_b32 s86, 32
  s_mov_b32 s87, 0x00020000
  s_mov_b32 s78, 5242880
  s_mov_b32 s79, 0x00020000
  s_mov_b32 s82, 5242880
  s_mov_b32 s83, 0x00020000
  s_cmp_lt_u32 s2, 256
  s_cbranch_scc1 kva_kernel_go_2
  s_endpgm
kva_kernel_go_2:
  v_lshrrev_b32 v1, 6, v0
  v_lshlrev_b32 v62, 6, v0
  v_lshrrev_b32 v22, 1, v0
  v_and_b32 v23, 1, v0
  v_and_b32 v0, 63, v0
  v_readfirstlane_b32 s3, v1
  s_and_b32 s94, s2, 7
  s_lshr_b32 s95, s2, 3
  s_mul_i32 s90, s94, 10
  s_lshl_b32 s92, s90, 1
  s_add_u32 s92, s92, 70
  s_cmp_lt_u32 s2, 80
  s_cselect_b32 s90, s90, s92
  s_add_u32 s90, s90, s95
  s_movk_i32 s92, 7680
  v_mul_lo_u32 v250, v22, s92
  v_lshl_add_u32 v250, v23, 4, v250
  v_lshlrev_b32 v251, 1, v22
  s_lshl_b32 s99, s90, 5
  v_add_u32 v250, s99, v250
  s_cmp_ge_u32 s2, 80
  s_cbranch_scc1 kva_kernel_noearly_3
  s_mov_b32 s92, 0
  buffer_load_dwordx4 v[228:231], v250, s[28:31], s92 offen
  s_mov_b32 s92, 1966080
  buffer_load_dwordx4 v[232:235], v250, s[28:31], s92 offen
  s_mov_b32 s92, 3932160
  buffer_load_dwordx4 v[236:239], v250, s[28:31], s92 offen
  buffer_load_ushort v224, v251, s[24:27], 0 offen offset:0
  buffer_load_ushort v225, v251, s[24:27], 0 offen offset:512
  buffer_load_ushort v226, v251, s[24:27], 0 offen offset:1024
kva_kernel_noearly_3:
  s_cmp_lt_u32 s2, 240
  s_cselect_b32 s30, 4915200, 0
  s_cselect_b32 s54, 64, 0
  s_cmp_lt_u32 s2, 80
  s_cselect_b32 s30, 0, s30
  s_lshr_b32 s92, s2, 5
  s_and_b32 s95, s95, 3
  s_lshl_b32 s93, s95, 2
  s_lshr_b32 s93, 29984, s93
  s_and_b32 s93, s93, 7
  s_xor_b32 s93, s93, s94
  s_lshl_b32 s99, s95, 3
  s_add_u32 s93, s93, s99
  s_xor_b32 s95, s95, 2
  s_lshl_b32 s88, s95, 2
  s_lshr_b32 s88, 29984, s88
  s_and_b32 s88, s88, 7
  s_xor_b32 s88, s88, s94
  s_lshl_b32 s99, s95, 3
  s_add_u32 s88, s88, s99
  s_lshl_b32 s72, s94, 5
  s_add_u32 s72, s72, s92
  s_bfe_u32 s99, s2, 0x10003
  s_lshl_b32 s99, s99, 4
  s_add_u32 s72, s72, s99
  s_bfe_u32 s99, s2, 0x10004
  s_lshl_b32 s99, s99, 3
  s_add_u32 s72, s72, s99
  v_lshrrev_b32 v1, 3, v0
  s_lshl_b32 s94, s92, 8
  s_lshl_b32 s95, s3, 5
  s_add_u32 s94, s94, s95
  v_add_u32 v1, s94, v1
  v_lshrrev_b32 v4, 4, v0
  v_and_b32 v5, 7, v0
  v_xor_b32 v5, v5, v4
  v_lshlrev_b32 v5, 4, v5
  v_lshl_add_u32 v2, v1, 10, v5
  v_xor_b32 v3, 64, v2
  s_mul_i32 s96, s3, 12288
  s_add_u32 m0, s96, 0
  s_mov_b32 s94, 0
  buffer_load_dwordx4 v2, s[4:7], s94 offen lds
  s_add_u32 m0, s96, 1024
  s_mov_b32 s94, 8192
  buffer_load_dwordx4 v3, s[4:7], s94 offen lds
  s_add_u32 m0, s96, 2048
  s_mov_b32 s94, 16384
  buffer_load_dwordx4 v2, s[4:7], s94 offen lds
  s_add_u32 m0, s96, 3072
  s_mov_b32 s94, 24576
  buffer_load_dwordx4 v3, s[4:7], s94 offen lds
  v_bfe_u32 v1, v0, 2, 2
  v_and_b32 v10, 3, v0
  s_lshl_b32 s94, s3, 3
  v_add_u32 v5, s94, v1
  v_lshlrev_b32 v5, 13, v5
  v_lshl_add_u32 v4, v4, 6, v5
  v_lshl_add_u32 v4, v10, 4, v4
  s_lshl_b32 s94, s93, 8
  v_add_u32 v4, s94, v4
  s_lshl_b32 s97, s3, 11
  s_add_u32 s97, s97, 98304
  s_bitcmp1_b32 s2, 4
  s_cbranch_scc1 kva_kernel_V_4
  s_add_u32 m0, s97, 0
  s_mov_b32 s94, 0
  buffer_load_dwordx4 v4, s[8:11], s94 offen lds
  s_add_u32 m0, s97, 1024
  s_mov_b32 s94, 32768
  buffer_load_dwordx4 v4, s[8:11], s94 offen lds
  s_add_u32 m0, s96, 4096
  s_mov_b32 s94, 128
  buffer_load_dwordx4 v2, s[4:7], s94 offen lds
  s_add_u32 m0, s96, 5120
  s_mov_b32 s94, 8320
  buffer_load_dwordx4 v3, s[4:7], s94 offen lds
  s_add_u32 m0, s96, 6144
  s_mov_b32 s94, 16512
  buffer_load_dwordx4 v2, s[4:7], s94 offen lds
  s_add_u32 m0, s96, 7168
  s_mov_b32 s94, 24704
  buffer_load_dwordx4 v3, s[4:7], s94 offen lds
  s_add_u32 m0, s97, 16384
  s_mov_b32 s94, 524288
  buffer_load_dwordx4 v4, s[8:11], s94 offen lds
  s_add_u32 m0, s97, 17408
  s_mov_b32 s94, 557056
  buffer_load_dwordx4 v4, s[8:11], s94 offen lds
  s_lshl_b32 s94, s72, 3
  s_add_u32 s94, s94, s3
  s_mul_i32 s100, s94, 1280
  v_mov_b32 v63, s72
  v_cmp_eq_u32 vcc, 0, v0
  s_nop 1
  v_cndmask_b32 v60, 2.0, v63, vcc
  v_and_b32 v63, 3, v0
  v_lshlrev_b32 v63, 2, v63
  v_mov_b32 v61, 0x010101
  v_lshrrev_b32 v63, v63, v61
  v_and_b32 v63, 0x01010101, v63
  s_mov_b32 s68, s36
  s_mov_b32 s69, s37
  s_mov_b32 s70, s38
  s_mov_b32 s71, s39
  v_lshlrev_b32 v15, 2, v0
  s_lshr_b32 s101, s94, 5
  s_mul_i32 s101, s101, 40960
  s_and_b32 s94, s94, 31
  s_lshl_b32 s94, s94, 4
  s_add_u32 s101, s101, s94
  v_lshrrev_b32 v252, 3, v22
  v_lshlrev_b32 v252, 6, v252
  v_lshl_add_u32 v252, v23, 5, v252
  v_add_u32 v252, 147456, v252
  v_lshrrev_b32 v22, 5, v0
  v_bfe_u32 v23, v0, 1, 3
  v_xor_b32 v23, v23, v22
  v_and_b32 v6, 31, v0
  v_lshlrev_b32 v6, 7, v6
  v_lshl_add_u32 v6, v23, 4, v6
  v_xor_b32 v7, 32, v6
  v_xor_b32 v8, 64, v6
  v_xor_b32 v9, 96, v6
  v_add_u32 v6, s96, v6
  v_add_u32 v7, s96, v7
  v_add_u32 v8, s96, v8
  v_add_u32 v9, s96, v9
  v_bfe_u32 v23, v0, 4, 1
  v_lshl_add_u32 v5, v22, 2, v1
  v_lshlrev_b32 v5, 13, v5
  v_lshl_add_u32 v5, v23, 6, v5
  v_lshl_add_u32 v5, v10, 4, v5
  s_lshl_b32 s94, s88, 8
  v_add_u32 v5, s94, v5
  s_lshl_b32 s98, s3, 18
  v_lshlrev_b32 v10, 3, v10
  v_lshl_add_u32 v10, v1, 6, v10
  v_lshl_add_u32 v10, v23, 5, v10
  v_lshl_add_u32 v11, v22, 10, v10
  v_lshl_add_u32 v10, v22, 11, v10
  v_add_u32 v10, 98304, v10
  v_add_u32 v12, 0x10000, v11
  v_add_u32 v13, 0x20000, v11
  v_lshlrev_b32 v14, 4, v0
  s_lshl_b32 s99, s92, 3
  s_add_u32 s99, s99, s3
  s_lshl_b32 s99, s99, 13
  s_lshl_b32 s94, s88, 19
  s_add_u32 s89, s99, s94
  s_lshl_b32 s94, s93, 19
  s_add_u32 s99, s99, s94
  s_lshl_b32 s94, s90, 6
  s_add_u32 s52, s52, s94
  s_addc_u32 s53, s53, 0
  s_lshl_b32 s94, s90, 5
  s_add_u32 s84, s84, s94
  s_addc_u32 s85, s85, 0
  s_cmp_lt_u32 s2, 80
  s_cselect_b32 s58, 256, 0
  s_cselect_b32 s86, 32, 0
  s_cmp_eq_u32 s3, 0
  s_cselect_b32 s54, s54, 0
  s_cselect_b32 s58, s58, 0
  s_cselect_b32 s86, s86, 0
  s_cmp_lt_u32 s90, 40
  s_cselect_b32 s91, 0, 1.0
  v_lshrrev_b32 v253, 4, v0
  v_lshlrev_b32 v253, 9, v253
  v_and_b32 v249, 15, v0
  v_lshl_add_u32 v253, v249, 2, v253
  v_add_u32 v253, 147456, v253
  v_lshlrev_b32 v254, 1, v0
  s_cmp_ge_u32 s2, 80
  s_cbranch_scc1 kva_kernel_noearly2_5
  s_waitcnt vmcnt(12)
  s_mov_b32 s95, 1069066811
  v_lshlrev_b32 v224, 16, v224
  v_mul_f32 v248, s95, v224
  v_exp_f32 v248, -v248
  s_nop 0
  v_add_f32 v248, 1.0, v248
  v_rcp_f32 v248, v248
  s_nop 0
  v_mul_f32 v224, v224, v248
  v_cvt_pk_bf16_f32 v224, v224, v224
  v_lshlrev_b32 v224, 16, v224
  v_lshlrev_b32 v225, 16, v225
  v_mul_f32 v249, s95, v225
  v_exp_f32 v249, -v249
  s_nop 0
  v_add_f32 v249, 1.0, v249
  v_rcp_f32 v249, v249
  s_nop 0
  v_mul_f32 v225, v225, v249
  v_cvt_pk_bf16_f32 v225, v225, v225
  v_lshlrev_b32 v225, 16, v225
  v_lshlrev_b32 v226, 16, v226
  v_mul_f32 v248, s95, v226
  v_exp_f32 v248, -v248
  s_nop 0
  v_add_f32 v248, 1.0, v248
  v_rcp_f32 v248, v248
  s_nop 0
  v_mul_f32 v226, v226, v248
  v_cvt_pk_bf16_f32 v226, v226, v226
  v_lshlrev_b32 v226, 16, v226
  s_waitcnt vmcnt(17)
  v_lshlrev_b32 v248, 16, v228
  v_and_b32 v249, 0xffff0000, v228
  v_mul_f32 v240, v248, v224
  v_mul_f32 v241, v249, v224
  v_lshlrev_b32 v248, 16, v229
  v_and_b32 v249, 0xffff0000, v229
  v_mul_f32 v242, v248, v224
  v_mul_f32 v243, v249, v224
  v_lshlrev_b32 v248, 16, v230
  v_and_b32 v249, 0xffff0000, v230
  v_mul_f32 v244, v248, v224
  v_mul_f32 v245, v249, v224
  v_lshlrev_b32 v248, 16, v231
  v_and_b32 v249, 0xffff0000, v231
  v_mul_f32 v246, v248, v224
  v_mul_f32 v247, v249, v224
  s_waitcnt vmcnt(16)
  v_lshlrev_b32 v248, 16, v232
  v_and_b32 v249, 0xffff0000, v232
  v_fmac_f32 v240, v248, v225
  v_fmac_f32 v241, v249, v225
  v_lshlrev_b32 v248, 16, v233
  v_and_b32 v249, 0xffff0000, v233
  v_fmac_f32 v242, v248, v225
  v_fmac_f32 v243, v249, v225
  v_lshlrev_b32 v248, 16, v234
  v_and_b32 v249, 0xffff0000, v234
  v_fmac_f32 v244, v248, v225
  v_fmac_f32 v245, v249, v225
  v_lshlrev_b32 v248, 16, v235
  v_and_b32 v249, 0xffff0000, v235
  v_fmac_f32 v246, v248, v225
  v_fmac_f32 v247, v249, v225
  s_waitcnt vmcnt(15)
  v_lshlrev_b32 v248, 16, v236
  v_and_b32 v249, 0xffff0000, v236
  v_fmac_f32 v240, v248, v226
  v_fmac_f32 v241, v249, v226
  v_lshlrev_b32 v248, 16, v237
  v_and_b32 v249, 0xffff0000, v237
  v_fmac_f32 v242, v248, v226
  v_fmac_f32 v243, v249, v226
  v_lshlrev_b32 v248, 16, v238
  v_and_b32 v249, 0xffff0000, v238
  v_fmac_f32 v244, v248, v226
  v_fmac_f32 v245, v249, v226
  v_lshlrev_b32 v248, 16, v239
  v_and_b32 v249, 0xffff0000, v239
  v_fmac_f32 v246, v248, v226
  v_fmac_f32 v247, v249, v226
  v_add_f32_dpp v240, v240, v240 row_ror:2 row_mask:0xf bank_mask:0xf
  v_add_f32_dpp v241, v241, v241 row_ror:2 row_mask:0xf bank_mask:0xf
  v_add_f32_dpp v242, v242, v242 row_ror:2 row_mask:0xf bank_mask:0xf
  v_add_f32_dpp v243, v243, v243 row_ror:2 row_mask:0xf bank_mask:0xf
  v_add_f32_dpp v244, v244, v244 row_ror:2 row_mask:0xf bank_mask:0xf
  v_add_f32_dpp v245, v245, v245 row_ror:2 row_mask:0xf bank_mask:0xf
  v_add_f32_dpp v246, v246, v246 row_ror:2 row_mask:0xf bank_mask:0xf
  v_add_f32_dpp v247, v247, v247 row_ror:2 row_mask:0xf bank_mask:0xf
  v_add_f32_dpp v240, v240, v240 row_ror:4 row_mask:0xf bank_mask:0xf
  v_add_f32_dpp v241, v241, v241 row_ror:4 row_mask:0xf bank_mask:0xf
  v_add_f32_dpp v242, v242, v242 row_ror:4 row_mask:0xf bank_mask:0xf
  v_add_f32_dpp v243, v243, v243 row_ror:4 row_mask:0xf bank_mask:0xf
  v_add_f32_dpp v244, v244, v244 row_ror:4 row_mask:0xf bank_mask:0xf
  v_add_f32_dpp v245, v245, v245 row_ror:4 row_mask:0xf bank_mask:0xf
  v_add_f32_dpp v246, v246, v246 row_ror:4 row_mask:0xf bank_mask:0xf
  v_add_f32_dpp v247, v247, v247 row_ror:4 row_mask:0xf bank_mask:0xf
  v_add_f32_dpp v240, v240, v240 row_ror:8 row_mask:0xf bank_mask:0xf
  v_add_f32_dpp v241, v241, v241 row_ror:8 row_mask:0xf bank_mask:0xf
  v_add_f32_dpp v242, v242, v242 row_ror:8 row_mask:0xf bank_mask:0xf
  v_add_f32_dpp v243, v243, v243 row_ror:8 row_mask:0xf bank_mask:0xf
  v_add_f32_dpp v244, v244, v244 row_ror:8 row_mask:0xf bank_mask:0xf
  v_add_f32_dpp v245, v245, v245 row_ror:8 row_mask:0xf bank_mask:0xf
  v_add_f32_dpp v246, v246, v246 row_ror:8 row_mask:0xf bank_mask:0xf
  v_add_f32_dpp v247, v247, v247 row_ror:8 row_mask:0xf bank_mask:0xf
  ds_write_b128 v252, v[240:243]
  ds_write_b128 v252, v[244:247] offset:16
kva_kernel_noearly2_5:
  s_waitcnt vmcnt(6) lgkmcnt(0)
  s_barrier
  ds_read_b128 v[128:131], v6 offset:0
  ds_read_b128 v[132:135], v7 offset:0
  ds_read_b128 v[136:139], v8 offset:0
  ds_read_b128 v[140:143], v9 offset:0
  ds_read_b64_tr_b16 v[32:33], v10 offset:0
  ds_read_b64_tr_b16 v[34:35], v10 offset:1024
  ds_read_b64_tr_b16 v[36:37], v10 offset:256
  ds_read_b64_tr_b16 v[38:39], v10 offset:1280
  ds_read_b64_tr_b16 v[40:41], v10 offset:512
  ds_read_b64_tr_b16 v[42:43], v10 offset:1536
  ds_read_b64_tr_b16 v[44:45], v10 offset:768
  ds_read_b64_tr_b16 v[46:47], v10 offset:1792
  ds_read_b64_tr_b16 v[48:49], v10 offset:4096
  ds_read_b64_tr_b16 v[50:51], v10 offset:5120
  ds_read_b64_tr_b16 v[52:53], v10 offset:4352
  ds_read_b64_tr_b16 v[54:55], v10 offset:5376
  s_waitcnt lgkmcnt(10)
  v_mfma_f32_32x32x16_bf16 v[64:79], v[32:35], v[128:131], 0
  ds_read_b64_tr_b16 v[56:57], v10 offset:4608
  ds_read_b64_tr_b16 v[58:59], v10 offset:5632
  buffer_load_dword v16, v15, s[40:43], s100 offen offset:0
  buffer_load_dword v17, v15, s[40:43], s100 offen offset:256
  buffer_load_dword v18, v15, s[40:43], s100 offen offset:512
  buffer_load_dword v19, v15, s[40:43], s100 offen offset:768
  buffer_load_dword v20, v15, s[40:43], s100 offen offset:1024
  ds_read_b32 v240, v253 offset:0
  ds_read_b32 v241, v253 offset:64
  s_waitcnt lgkmcnt(12)
  v_mfma_f32_32x32x16_bf16 v[80:95], v[36:39], v[128:131], 0
  ds_read_b64_tr_b16 v[32:33], v10 offset:4864
  ds_read_b64_tr_b16 v[34:35], v10 offset:5888
  s_add_u32 m0, s97, 32768
  s_mov_b32 s94, 1048576
  buffer_load_dwordx4 v4, s[8:11], s94 offen lds
  ds_read_b32 v242, v253 offset:128
  ds_read_b32 v243, v253 offset:192
  s_waitcnt lgkmcnt(14)
  v_mfma_f32_32x32x16_bf16 v[96:111], v[40:43], v[128:131], 0
  ds_read_b64_tr_b16 v[36:37], v10 offset:8192
  ds_read_b64_tr_b16 v[38:39], v10 offset:9216
  s_add_u32 m0, s97, 33792
  s_mov_b32 s94, 1081344
  buffer_load_dwordx4 v4, s[8:11], s94 offen lds
  ds_read_b32 v244, v253 offset:256
  ds_read_b32 v245, v253 offset:320
  s_waitcnt lgkmcnt(15)
  v_mfma_f32_32x32x16_bf16 v[112:127], v[44:47], v[128:131], 0
  ds_read_b64_tr_b16 v[40:41], v10 offset:8448
  ds_read_b64_tr_b16 v[42:43], v10 offset:9472
  s_add_u32 m0, s96, 8192
  s_mov_b32 s94, 256
  buffer_load_dwordx4 v2, s[4:7], s94 offen lds
  ds_read_b32 v246, v253 offset:384
  ds_read_b32 v247, v253 offset:448
  s_waitcnt lgkmcnt(15)
  v_mfma_f32_32x32x16_bf16 v[64:79], v[48:51], v[132:135], v[64:79]
  ds_read_b64_tr_b16 v[44:45], v10 offset:8704
  ds_read_b64_tr_b16 v[46:47], v10 offset:9728
  s_add_u32 m0, s96, 9216
  s_mov_b32 s94, 8448
  buffer_load_dwordx4 v3, s[4:7], s94 offen lds
  v_mfma_f32_32x32x16_bf16 v[80:95], v[52:55], v[132:135], v[80:95]
  ds_read_b64_tr_b16 v[48:49], v10 offset:8960
  ds_read_b64_tr_b16 v[50:51], v10 offset:9984
  s_add_u32 m0, s96, 10240
  s_mov_b32 s94, 16640
  buffer_load_dwordx4 v2, s[4:7], s94 offen lds
  s_waitcnt lgkmcnt(4)
  v_add_f32 v240, v240, v241
  v_add_f32 v242, v242, v243
  v_mfma_f32_32x32x16_bf16 v[96:111], v[56:59], v[132:135], v[96:111]
  ds_read_b64_tr_b16 v[52:53], v10 offset:12288
  ds_read_b64_tr_b16 v[54:55], v10 offset:13312
  s_add_u32 m0, s96, 11264
  s_mov_b32 s94, 24832
  buffer_load_dwordx4 v3, s[4:7], s94 offen lds
  v_add_f32 v244, v244, v245
  v_add_f32 v246, v246, v247
  v_add_f32 v240, v240, v242
  v_add_f32 v244, v244, v246
  v_mfma_f32_32x32x16_bf16 v[112:127], v[32:35], v[132:135], v[112:127]
  ds_read_b64_tr_b16 v[56:57], v10 offset:12544
  ds_read_b64_tr_b16 v[58:59], v10 offset:13568
  s_add_u32 m0, s96, 0
  s_mov_b32 s94, 384
  buffer_load_dwordx4 v2, s[4:7], s94 offen lds
  v_add_f32 v240, v240, v244
  v_mov_b32 v241, v240
  s_nop 1
  v_permlane32_swap_b32 v240, v241
  v_add_f32 v240, v240, v241
  v_mfma_f32_32x32x16_bf16 v[64:79], v[36:39], v[136:139], v[64:79]
  ds_read_b64_tr_b16 v[32:33], v10 offset:12800
  ds_read_b64_tr_b16 v[34:35], v10 offset:13824
  s_add_u32 m0, s96, 1024
  s_mov_b32 s94, 8576
  buffer_load_dwordx4 v3, s[4:7], s94 offen lds
  v_mov_b32 v241, v240
  s_nop 1
  v_permlane16_swap_b32 v240, v241
  v_add_f32 v240, v240, v241
  v_cvt_pk_bf16_f32 v240, v240, v240
  v_mfma_f32_32x32x16_bf16 v[80:95], v[40:43], v[136:139], v[80:95]
  ds_read_b64_tr_b16 v[36:37], v10 offset:13056
  ds_read_b64_tr_b16 v[38:39], v10 offset:14080
  s_add_u32 m0, s96, 2048
  s_mov_b32 s94, 16768
  buffer_load_dwordx4 v2, s[4:7], s94 offen lds
  v_lshlrev_b32 v240, 16, v240
  v_add_f32 v241, s91, v240
  v_cvt_pk_bf16_f32 v241, v241, v241
  buffer_store_short v241, v254, s[84:87], 0 offen sc1
  s_lshl_b32 s94, s86, 1
  s_mov_b32 s91, s54
  s_mov_b32 s54, s94
  buffer_store_dword v240, v15, s[52:55], 0 offen
  s_sub_u32 s54, s91, s54
  s_waitcnt lgkmcnt(10)
  v_mfma_f32_32x32x16_bf16 v[96:111], v[44:47], v[136:139], v[96:111]
  s_add_u32 m0, s96, 3072
  s_mov_b32 s94, 24960
  buffer_load_dwordx4 v3, s[4:7], s94 offen lds
  s_waitcnt lgkmcnt(8)
  v_mfma_f32_32x32x16_bf16 v[112:127], v[48:51], v[136:139], v[112:127]
  s_waitcnt lgkmcnt(6)
  v_mfma_f32_32x32x16_bf16 v[64:79], v[52:55], v[140:143], v[64:79]
  s_waitcnt vmcnt(17) lgkmcnt(0)
  s_barrier
  ds_read_b128 v[144:147], v6 offset:4096
  ds_read_b128 v[148:151], v7 offset:4096
  ds_read_b128 v[152:155], v8 offset:4096
  ds_read_b128 v[156:159], v9 offset:4096
  ds_read_b64_tr_b16 v[40:41], v10 offset:16384
  ds_read_b64_tr_b16 v[42:43], v10 offset:17408
  ds_read_b64_tr_b16 v[44:45], v10 offset:16640
  ds_read_b64_tr_b16 v[46:47], v10 offset:17664
  ds_read_b64_tr_b16 v[48:49], v10 offset:16896
  ds_read_b64_tr_b16 v[50:51], v10 offset:17920
  s_mov_b32 s94, 0
  buffer_load_dwordx4 v[228:231], v250, s[28:31], s94 offen
  s_mov_b32 s94, 1966080
  buffer_load_dwordx4 v[232:235], v250, s[28:31], s94 offen
  s_mov_b32 s94, 3932160
  buffer_load_dwordx4 v[236:239], v250, s[28:31], s94 offen
  buffer_load_ushort v224, v251, s[24:27], 0 offen offset:0
  buffer_load_ushort v225, v251, s[24:27], 0 offen offset:512
  buffer_load_ushort v226, v251, s[24:27], 0 offen offset:1024
  v_mfma_f32_32x32x16_bf16 v[80:95], v[56:59], v[140:143], v[80:95]
  ds_read_b64_tr_b16 v[52:53], v10 offset:17152
  ds_read_b64_tr_b16 v[54:55], v10 offset:18176
  s_add_u32 m0, s97, 0
  s_mov_b32 s94, 1572864
  buffer_load_dwordx4 v4, s[8:11], s94 offen lds
  s_waitcnt vmcnt(19)
  v_lshlrev_b32 v208, 16, v16
  v_and_b32 v209, 0xffff0000, v16
  v_mfma_f32_32x32x16_bf16 v[96:111], v[32:35], v[140:143], v[96:111]
  ds_read_b64_tr_b16 v[56:57], v10 offset:20480
  ds_read_b64_tr_b16 v[58:59], v10 offset:21504
  s_add_u32 m0, s97, 1024
  s_mov_b32 s94, 1605632
  buffer_load_dwordx4 v4, s[8:11], s94 offen lds
  v_lshlrev_b32 v210, 16, v17
  v_and_b32 v211, 0xffff0000, v17
  v_lshlrev_b32 v212, 16, v18
  v_and_b32 v213, 0xffff0000, v18
  v_mfma_f32_32x32x16_bf16 v[112:127], v[36:39], v[140:143], v[112:127]
  ds_read_b64_tr_b16 v[32:33], v10 offset:20736
  ds_read_b64_tr_b16 v[34:35], v10 offset:21760
  v_lshlrev_b32 v214, 16, v19
  v_and_b32 v215, 0xffff0000, v19
  v_lshlrev_b32 v216, 16, v20
  v_and_b32 v217, 0xffff0000, v20
  s_waitcnt lgkmcnt(10)
  v_mfma_f32_32x32x16_bf16 v[64:79], v[40:43], v[144:147], v[64:79]
  ds_read_b64_tr_b16 v[36:37], v10 offset:20992
  ds_read_b64_tr_b16 v[38:39], v10 offset:22016
  s_add_u32 m0, s96, 4096
  s_mov_b32 s94, 512
  buffer_load_dwordx4 v2, s[4:7], s94 offen lds
  v_add_f32 v218, v208, v209
  v_add_f32 v219, v210, v211
  v_add_f32 v218, v218, v212
  v_add_f32 v219, v219, v213
  s_waitcnt lgkmcnt(10)
  v_mfma_f32_32x32x16_bf16 v[80:95], v[44:47], v[144:147], v[80:95]
  ds_read_b64_tr_b16 v[40:41], v10 offset:21248
  ds_read_b64_tr_b16 v[42:43], v10 offset:22272
  s_add_u32 m0, s96, 5120
  s_mov_b32 s94, 8704
  buffer_load_dwordx4 v3, s[4:7], s94 offen lds
  v_add_f32 v218, v218, v214
  v_add_f32 v219, v219, v215
  v_add_f32 v218, v218, v216
  v_add_f32 v219, v219, v217
  s_waitcnt lgkmcnt(10)
  v_mfma_f32_32x32x16_bf16 v[96:111], v[48:51], v[144:147], v[96:111]
  ds_read_b64_tr_b16 v[44:45], v10 offset:24576
  ds_read_b64_tr_b16 v[46:47], v10 offset:25600
  s_add_u32 m0, s96, 6144
  s_mov_b32 s94, 16896
  buffer_load_dwordx4 v2, s[4:7], s94 offen lds
  v_add_f32 v218, v218, v219
  s_nop 1
  v_add_f32_dpp v218, v218, v218 row_ror:1 row_mask:0xf bank_mask:0xf
  s_nop 1
  v_add_f32_dpp v218, v218, v218 row_ror:2 row_mask:0xf bank_mask:0xf
  s_nop 1
  v_add_f32_dpp v218, v218, v218 row_ror:4 row_mask:0xf bank_mask:0xf
  s_waitcnt lgkmcnt(10)
  v_mfma_f32_32x32x16_bf16 v[112:127], v[52:55], v[144:147], v[112:127]
  ds_read_b64_tr_b16 v[48:49], v10 offset:24832
  ds_read_b64_tr_b16 v[50:51], v10 offset:25856
  s_add_u32 m0, s96, 7168
  s_mov_b32 s94, 25088
  buffer_load_dwordx4 v3, s[4:7], s94 offen lds
  v_add_f32_dpp v218, v218, v218 row_ror:8 row_mask:0xf bank_mask:0xf
  v_mov_b32 v219, v218
  s_nop 1
  v_permlane32_swap_b32 v218, v219
  v_add_f32 v218, v218, v219
  s_waitcnt lgkmcnt(10)
  v_mfma_f32_32x32x16_bf16 v[64:79], v[56:59], v[148:151], v[64:79]
  ds_read_b64_tr_b16 v[52:53], v10 offset:25088
  ds_read_b64_tr_b16 v[54:55], v10 offset:26112
  v_mov_b32 v219, v218
  s_nop 1
  v_permlane16_swap_b32 v218, v219
  v_add_f32 v218, v218, v219
  v_mul_f32 v220, 0x3acccccd, v218
  s_waitcnt lgkmcnt(10)
  v_mfma_f32_32x32x16_bf16 v[80:95], v[32:35], v[148:151], v[80:95]
  ds_read_b64_tr_b16 v[56:57], v10 offset:25344
  ds_read_b64_tr_b16 v[58:59], v10 offset:26368
  v_sub_f32 v16, v208, v220
  v_mul_f32 v218, v16, v16
  v_sub_f32 v17, v209, v220
  v_mul_f32 v219, v17, v17
  s_waitcnt lgkmcnt(10)
  v_mfma_f32_32x32x16_bf16 v[96:111], v[36:39], v[148:151], v[96:111]
  ds_read_b64_tr_b16 v[32:33], v10 offset:28672
  ds_read_b64_tr_b16 v[34:35], v10 offset:29696
  v_sub_f32 v16, v210, v220
  v_fmac_f32 v218, v16, v16
  v_sub_f32 v17, v211, v220
  v_fmac_f32 v219, v17, v17
  s_waitcnt lgkmcnt(10)
  v_mfma_f32_32x32x16_bf16 v[112:127], v[40:43], v[148:151], v[112:127]
  ds_read_b64_tr_b16 v[36:37], v10 offset:28928
  ds_read_b64_tr_b16 v[38:39], v10 offset:29952
  v_sub_f32 v16, v212, v220
  v_fmac_f32 v218, v16, v16
  v_sub_f32 v17, v213, v220
  v_fmac_f32 v219, v17, v17
  s_waitcnt lgkmcnt(10)
  v_mfma_f32_32x32x16_bf16 v[64:79], v[44:47], v[152:155], v[64:79]
  ds_read_b64_tr_b16 v[40:41], v10 offset:29184
  ds_read_b64_tr_b16 v[42:43], v10 offset:30208
  v_sub_f32 v16, v214, v220
  v_fmac_f32 v218, v16, v16
  v_sub_f32 v17, v215, v220
  v_fmac_f32 v219, v17, v17
  s_waitcnt lgkmcnt(10)
  v_mfma_f32_32x32x16_bf16 v[80:95], v[48:51], v[152:155], v[80:95]
  ds_read_b64_tr_b16 v[44:45], v10 offset:29440
  ds_read_b64_tr_b16 v[46:47], v10 offset:30464
  v_sub_f32 v16, v216, v220
  v_fmac_f32 v218, v16, v16
  v_sub_f32 v17, v217, v220
  v_fmac_f32 v219, v17, v17
  s_waitcnt lgkmcnt(10)
  v_mfma_f32_32x32x16_bf16 v[96:111], v[52:55], v[152:155], v[96:111]
  v_add_f32 v218, v218, v219
  s_nop 1
  v_add_f32_dpp v218, v218, v218 row_ror:1 row_mask:0xf bank_mask:0xf
  s_nop 1
  v_add_f32_dpp v218, v218, v218 row_ror:2 row_mask:0xf bank_mask:0xf
  s_nop 1
  v_add_f32_dpp v218, v218, v218 row_ror:4 row_mask:0xf bank_mask:0xf
  s_waitcnt lgkmcnt(8)
  v_mfma_f32_32x32x16_bf16 v[112:127], v[56:59], v[152:155], v[112:127]
  v_add_f32_dpp v218, v218, v218 row_ror:8 row_mask:0xf bank_mask:0xf
  v_mov_b32 v219, v218
  s_nop 1
  v_permlane32_swap_b32 v218, v219
  v_add_f32 v218, v218, v219
  s_waitcnt lgkmcnt(6)
  v_mfma_f32_32x32x16_bf16 v[64:79], v[32:35], v[156:159], v[64:79]
  s_waitcnt vmcnt(18) lgkmcnt(0)
  s_barrier
  ds_read_b128 v[160:163], v6 offset:8192
  ds_read_b128 v[164:167], v7 offset:8192
  ds_read_b128 v[168:171], v8 offset:8192
  ds_read_b128 v[172:175], v9 offset:8192
  ds_read_b64_tr_b16 v[48:49], v10 offset:32768
  ds_read_b64_tr_b16 v[50:51], v10 offset:33792
  ds_read_b64_tr_b16 v[52:53], v10 offset:33024
  ds_read_b64_tr_b16 v[54:55], v10 offset:34048
  ds_read_b64_tr_b16 v[56:57], v10 offset:33280
  ds_read_b64_tr_b16 v[58:59], v10 offset:34304
  s_add_u32 m0, s97, 16384
  s_mov_b32 s94, 2097152
  buffer_load_dwordx4 v4, s[8:11], s94 offen lds
  v_mov_b32 v219, v218
  v_mfma_f32_32x32x16_bf16 v[80:95], v[36:39], v[156:159], v[80:95]
  ds_read_b64_tr_b16 v[32:33], v10 offset:33536
  ds_read_b64_tr_b16 v[34:35], v10 offset:34560
  s_add_u32 m0, s97, 17408
  s_mov_b32 s94, 2129920
  buffer_load_dwordx4 v4, s[8:11], s94 offen lds
  v_mfma_f32_32x32x16_bf16 v[96:111], v[40:43], v[156:159], v[96:111]
  ds_read_b64_tr_b16 v[36:37], v10 offset:36864
  ds_read_b64_tr_b16 v[38:39], v10 offset:37888
  s_waitcnt vmcnt(16)
  v_mov_b32 v22, 1
  buffer_store_byte v22, v60, s[56:59], 0 offen sc1
  s_cmp_eq_u32 s3, 0
  s_cselect_b32 s58, 256, 0
  v_permlane16_swap_b32 v218, v219
  v_add_f32 v218, v218, v219
  v_mfma_f32_32x32x16_bf16 v[112:127], v[44:47], v[156:159], v[112:127]
  ds_read_b64_tr_b16 v[40:41], v10 offset:37120
  ds_read_b64_tr_b16 v[42:43], v10 offset:38144
  v_mul_f32 v218, 0x3acccccd, v218
  v_cvt_pk_bf16_f32 v219, v218, v220
  v_lshlrev_b32 v218, 16, v219
  v_and_b32 v220, 0xffff0000, v219
  s_waitcnt lgkmcnt(10)
  v_mfma_f32_32x32x16_bf16 v[64:79], v[48:51], v[160:163], v[64:79]
  ds_read_b64_tr_b16 v[44:45], v10 offset:37376
  ds_read_b64_tr_b16 v[46:47], v10 offset:38400
  s_add_u32 m0, s96, 8192
  s_mov_b32 s94, 640
  buffer_load_dwordx4 v2, s[4:7], s94 offen lds
  v_add_f32 v218, 0x3727c5ac, v218
  v_cvt_pk_bf16_f32 v218, v218, v218
  v_lshlrev_b32 v218, 16, v218
  v_sqrt_f32 v218, v218
  s_waitcnt lgkmcnt(10)
  v_mfma_f32_32x32x16_bf16 v[80:95], v[52:55], v[160:163], v[80:95]
  ds_read_b64_tr_b16 v[48:49], v10 offset:37632
  ds_read_b64_tr_b16 v[50:51], v10 offset:38656
  s_add_u32 m0, s96, 9216
  s_mov_b32 s94, 8832
  buffer_load_dwordx4 v3, s[4:7], s94 offen lds
  v_cvt_pk_bf16_f32 v218, v218, v218
  v_lshlrev_b32 v218, 16, v218
  v_rcp_f32 v218, v218
  v_sub_f32 v208, v208, v220
  s_waitcnt lgkmcnt(10)
  v_mfma_f32_32x32x16_bf16 v[96:111], v[56:59], v[160:163], v[96:111]
  ds_read_b64_tr_b16 v[52:53], v10 offset:40960
  ds_read_b64_tr_b16 v[54:55], v10 offset:41984
  s_add_u32 m0, s96, 10240
  s_mov_b32 s94, 17024
  buffer_load_dwordx4 v2, s[4:7], s94 offen lds
  v_sub_f32 v209, v209, v220
  v_cvt_pk_bf16_f32 v16, v208, v209
  v_lshlrev_b32 v208, 16, v16
  v_and_b32 v209, 0xffff0000, v16
  s_waitcnt lgkmcnt(10)
  v_mfma_f32_32x32x16_bf16 v[112:127], v[32:35], v[160:163], v[112:127]
  ds_read_b64_tr_b16 v[56:57], v10 offset:41216
  ds_read_b64_tr_b16 v[58:59], v10 offset:42240
  s_add_u32 m0, s96, 11264
  s_mov_b32 s94, 25216
  buffer_load_dwordx4 v3, s[4:7], s94 offen lds
  v_mul_f32 v208, v208, v218
  v_mul_f32 v209, v209, v218
  v_cvt_pk_bf16_f32 v16, v208, v209
  v_sub_f32 v210, v210, v220
  s_waitcnt lgkmcnt(10)
  v_mfma_f32_32x32x16_bf16 v[64:79], v[36:39], v[164:167], v[64:79]
  ds_read_b64_tr_b16 v[32:33], v10 offset:41472
  ds_read_b64_tr_b16 v[34:35], v10 offset:42496
  v_sub_f32 v211, v211, v220
  v_cvt_pk_bf16_f32 v17, v210, v211
  v_lshlrev_b32 v210, 16, v17
  v_and_b32 v211, 0xffff0000, v17
  s_waitcnt lgkmcnt(10)
  v_mfma_f32_32x32x16_bf16 v[80:95], v[40:43], v[164:167], v[80:95]
  ds_read_b64_tr_b16 v[36:37], v10 offset:41728
  ds_read_b64_tr_b16 v[38:39], v10 offset:42752
  v_mul_f32 v210, v210, v218
  v_mul_f32 v211, v211, v218
  v_cvt_pk_bf16_f32 v17, v210, v211
  v_sub_f32 v212, v212, v220
  s_waitcnt lgkmcnt(10)
  v_mfma_f32_32x32x16_bf16 v[96:111], v[44:47], v[164:167], v[96:111]
  ds_read_b64_tr_b16 v[40:41], v10 offset:45056
  ds_read_b64_tr_b16 v[42:43], v10 offset:46080
  v_sub_f32 v213, v213, v220
  v_cvt_pk_bf16_f32 v18, v212, v213
  v_lshlrev_b32 v212, 16, v18
  v_and_b32 v213, 0xffff0000, v18
  s_waitcnt lgkmcnt(10)
  v_mfma_f32_32x32x16_bf16 v[112:127], v[48:51], v[164:167], v[112:127]
  ds_read_b64_tr_b16 v[44:45], v10 offset:45312
  ds_read_b64_tr_b16 v[46:47], v10 offset:46336
  v_mul_f32 v212, v212, v218
  v_mul_f32 v213, v213, v218
  v_cvt_pk_bf16_f32 v18, v212, v213
  v_sub_f32 v214, v214, v220
  s_waitcnt lgkmcnt(10)
  v_mfma_f32_32x32x16_bf16 v[64:79], v[52:55], v[168:171], v[64:79]
  ds_read_b64_tr_b16 v[48:49], v10 offset:45568
  ds_read_b64_tr_b16 v[50:51], v10 offset:46592
  v_sub_f32 v215, v215, v220
  v_cvt_pk_bf16_f32 v19, v214, v215
  v_lshlrev_b32 v214, 16, v19
  v_and_b32 v215, 0xffff0000, v19
  s_waitcnt lgkmcnt(10)
  v_mfma_f32_32x32x16_bf16 v[80:95], v[56:59], v[168:171], v[80:95]
  ds_read_b64_tr_b16 v[52:53], v10 offset:45824
  ds_read_b64_tr_b16 v[54:55], v10 offset:46848
  v_mul_f32 v214, v214, v218
  v_mul_f32 v215, v215, v218
  v_cvt_pk_bf16_f32 v19, v214, v215
  v_sub_f32 v216, v216, v220
  s_waitcnt lgkmcnt(10)
  v_mfma_f32_32x32x16_bf16 v[96:111], v[32:35], v[168:171], v[96:111]
  v_sub_f32 v217, v217, v220
  v_cvt_pk_bf16_f32 v20, v216, v217
  v_lshlrev_b32 v216, 16, v20
  v_and_b32 v217, 0xffff0000, v20
  s_waitcnt lgkmcnt(8)
  v_mfma_f32_32x32x16_bf16 v[112:127], v[36:39], v[168:171], v[112:127]
  v_mul_f32 v216, v216, v218
  v_mul_f32 v217, v217, v218
  v_cvt_pk_bf16_f32 v20, v216, v217
  v_lshrrev_b32 v23, 2, v0
  s_waitcnt lgkmcnt(6)
  v_mfma_f32_32x32x16_bf16 v[64:79], v[40:43], v[172:175], v[64:79]
  s_waitcnt vmcnt(11) lgkmcnt(0)
  s_barrier
  ds_read_b128 v[176:179], v6 offset:0
  ds_read_b128 v[180:183], v7 offset:0
  ds_read_b128 v[184:187], v8 offset:0
  ds_read_b128 v[188:191], v9 offset:0
  ds_read_b64_tr_b16 v[56:57], v10 offset:0
  ds_read_b64_tr_b16 v[58:59], v10 offset:1024
  ds_read_b64_tr_b16 v[32:33], v10 offset:256
  ds_read_b64_tr_b16 v[34:35], v10 offset:1280
  ds_read_b64_tr_b16 v[36:37], v10 offset:512
  ds_read_b64_tr_b16 v[38:39], v10 offset:1536
  s_lshl_b32 s94, s2, 15
  buffer_load_dword v61, v62, s[76:79], s94 offen
  v_mul_u32_u24 v23, 144, v23
  v_and_b32 v218, 3, v0
  v_lshl_add_u32 v23, v218, 2, v23
  s_lshl_b32 s94, s3, 4
  s_sub_u32 s101, s101, s94
  s_add_u32 s94, s94, 149504
  v_add_u32 v23, s94, v23
  v_mfma_f32_32x32x16_bf16 v[80:95], v[44:47], v[172:175], v[80:95]
  ds_read_b64_tr_b16 v[40:41], v10 offset:768
  ds_read_b64_tr_b16 v[42:43], v10 offset:1792
  s_add_u32 m0, s97, 32768
  s_mov_b32 s94, 2621440
  buffer_load_dwordx4 v4, s[8:11], s94 offen lds
  v_mfma_f32_32x32x16_bf16 v[96:111], v[48:51], v[172:175], v[96:111]
  ds_read_b64_tr_b16 v[44:45], v10 offset:4096
  ds_read_b64_tr_b16 v[46:47], v10 offset:5120
  s_add_u32 m0, s97, 33792
  s_mov_b32 s94, 2654208
  buffer_load_dwordx4 v4, s[8:11], s94 offen lds
  s_waitcnt vmcnt(16)
  s_mov_b32 s95, 1069066811
  v_lshlrev_b32 v224, 16, v224
  v_mfma_f32_32x32x16_bf16 v[112:127], v[52:55], v[172:175], v[112:127]
  ds_read_b64_tr_b16 v[48:49], v10 offset:4352
  ds_read_b64_tr_b16 v[50:51], v10 offset:5376
  v_mul_f32 v248, s95, v224
  v_exp_f32 v248, -v248
  s_nop 0
  v_add_f32 v248, 1.0, v248
  v_rcp_f32 v248, v248
  s_waitcnt lgkmcnt(10)
  v_mfma_f32_32x32x16_bf16 v[64:79], v[56:59], v[176:179], v[64:79]
  ds_read_b64_tr_b16 v[52:53], v10 offset:4608
  ds_read_b64_tr_b16 v[54:55], v10 offset:5632
  s_add_u32 m0, s96, 0
  s_mov_b32 s94, 768
  buffer_load_dwordx4 v2, s[4:7], s94 offen lds
  v_mul_f32 v224, v224, v248
  v_cvt_pk_bf16_f32 v224, v224, v224
  v_lshlrev_b32 v224, 16, v224
  v_lshlrev_b32 v225, 16, v225
  s_waitcnt lgkmcnt(10)
  v_mfma_f32_32x32x16_bf16 v[80:95], v[32:35], v[176:179], v[80:95]
  ds_read_b64_tr_b16 v[56:57], v10 offset:4864
  ds_read_b64_tr_b16 v[58:59], v10 offset:5888
  s_add_u32 m0, s96, 1024
  s_mov_b32 s94, 8960
  buffer_load_dwordx4 v3, s[4:7], s94 offen lds
  v_mul_f32 v249, s95, v225
  v_exp_f32 v249, -v249
  s_nop 0
  v_add_f32 v249, 1.0, v249
  v_rcp_f32 v249, v249
  s_waitcnt lgkmcnt(10)
  v_mfma_f32_32x32x16_bf16 v[96:111], v[36:39], v[176:179], v[96:111]
  ds_read_b64_tr_b16 v[32:33], v10 offset:8192
  ds_read_b64_tr_b16 v[34:35], v10 offset:9216
  s_add_u32 m0, s96, 2048
  s_mov_b32 s94, 17152
  buffer_load_dwordx4 v2, s[4:7], s94 offen lds
  v_mul_f32 v225, v225, v249
  v_cvt_pk_bf16_f32 v225, v225, v225
  v_lshlrev_b32 v225, 16, v225
  v_lshlrev_b32 v226, 16, v226
  s_waitcnt lgkmcnt(10)
  v_mfma_f32_32x32x16_bf16 v[112:127], v[40:43], v[176:179], v[112:127]
  ds_read_b64_tr_b16 v[36:37], v10 offset:8448
  ds_read_b64_tr_b16 v[38:39], v10 offset:9472
  s_add_u32 m0, s96, 3072
  s_mov_b32 s94, 25344
  buffer_load_dwordx4 v3, s[4:7], s94 offen lds
  v_mul_f32 v248, s95, v226
  v_exp_f32 v248, -v248
  s_nop 0
  v_add_f32 v248, 1.0, v248
  v_rcp_f32 v248, v248
  s_waitcnt lgkmcnt(10)
  v_mfma_f32_32x32x16_bf16 v[64:79], v[44:47], v[180:183], v[64:79]
  ds_read_b64_tr_b16 v[40:41], v10 offset:8704
  ds_read_b64_tr_b16 v[42:43], v10 offset:9728
  v_mul_f32 v226, v226, v248
  v_cvt_pk_bf16_f32 v226, v226, v226
  v_lshlrev_b32 v226, 16, v226
  s_waitcnt vmcnt(25)
  s_waitcnt lgkmcnt(10)
  v_mfma_f32_32x32x16_bf16 v[80:95], v[48:51], v[180:183], v[80:95]
  ds_read_b64_tr_b16 v[44:45], v10 offset:8960
  ds_read_b64_tr_b16 v[46:47], v10 offset:9984
  v_lshlrev_b32 v248, 16, v228
  v_and_b32 v249, 0xffff0000, v228
  v_mul_f32 v240, v248, v224
  v_mul_f32 v241, v249, v224
  s_waitcnt lgkmcnt(10)
  v_mfma_f32_32x32x16_bf16 v[96:111], v[52:55], v[180:183], v[96:111]
  ds_read_b64_tr_b16 v[48:49], v10 offset:12288
  ds_read_b64_tr_b16 v[50:51], v10 offset:13312
  v_lshlrev_b32 v248, 16, v229
  v_and_b32 v249, 0xffff0000, v229
  v_mul_f32 v242, v248, v224
  v_mul_f32 v243, v249, v224
  s_waitcnt lgkmcnt(10)
  v_mfma_f32_32x32x16_bf16 v[112:127], v[56:59], v[180:183], v[112:127]
  ds_read_b64_tr_b16 v[52:53], v10 offset:12544
  ds_read_b64_tr_b16 v[54:55], v10 offset:13568
  v_lshlrev_b32 v248, 16, v230
  v_and_b32 v249, 0xffff0000, v230
  v_mul_f32 v244, v248, v224
  v_mul_f32 v245, v249, v224
  s_waitcnt lgkmcnt(10)
  v_mfma_f32_32x32x16_bf16 v[64:79], v[32:35], v[184:187], v[64:79]
  ds_read_b64_tr_b16 v[56:57], v10 offset:12800
  ds_read_b64_tr_b16 v[58:59], v10 offset:13824
  v_lshlrev_b32 v248, 16, v231
  v_and_b32 v249, 0xffff0000, v231
  v_mul_f32 v246, v248, v224
  v_mul_f32 v247, v249, v224
  s_waitcnt lgkmcnt(10)
  v_mfma_f32_32x32x16_bf16 v[80:95], v[36:39], v[184:187], v[80:95]
  ds_read_b64_tr_b16 v[32:33], v10 offset:13056
  ds_read_b64_tr_b16 v[34:35], v10 offset:14080
  s_waitcnt vmcnt(24)
  v_lshlrev_b32 v248, 16, v232
  v_and_b32 v249, 0xffff0000, v232
  s_waitcnt lgkmcnt(10)
  v_mfma_f32_32x32x16_bf16 v[96:111], v[40:43], v[184:187], v[96:111]
  v_fmac_f32 v240, v248, v225
  v_fmac_f32 v241, v249, v225
  v_lshlrev_b32 v248, 16, v233
  v_and_b32 v249, 0xffff0000, v233
  s_waitcnt lgkmcnt(8)
  v_mfma_f32_32x32x16_bf16 v[112:127], v[44:47], v[184:187], v[112:127]
  v_fmac_f32 v242, v248, v225
  v_fmac_f32 v243, v249, v225
  v_lshlrev_b32 v248, 16, v234
  v_and_b32 v249, 0xffff0000, v234
  s_waitcnt lgkmcnt(6)
  v_mfma_f32_32x32x16_bf16 v[64:79], v[48:51], v[188:191], v[64:79]
  s_waitcnt vmcnt(12) lgkmcnt(0)
  s_barrier
  ds_read_b128 v[192:195], v6 offset:4096
  ds_read_b128 v[196:199], v7 offset:4096
  ds_read_b128 v[200:203], v8 offset:4096
  ds_read_b128 v[204:207], v9 offset:4096
  ds_read_b64_tr_b16 v[36:37], v10 offset:16384
  ds_read_b64_tr_b16 v[38:39], v10 offset:17408
  ds_read_b64_tr_b16 v[40:41], v10 offset:16640
  ds_read_b64_tr_b16 v[42:43], v10 offset:17664
  ds_read_b64_tr_b16 v[44:45], v10 offset:16896
  ds_read_b64_tr_b16 v[46:47], v10 offset:17920
  buffer_load_dword v21, v15, s[36:39], 0 offen sc1
  v_fmac_f32 v244, v248, v225
  v_fmac_f32 v245, v249, v225
  v_lshlrev_b32 v248, 16, v235
  v_and_b32 v249, 0xffff0000, v235
  v_mfma_f32_32x32x16_bf16 v[80:95], v[52:55], v[188:191], v[80:95]
  ds_read_b64_tr_b16 v[48:49], v10 offset:17152
  ds_read_b64_tr_b16 v[50:51], v10 offset:18176
  s_lshl_b32 s94, s2, 15
  buffer_load_dword v61, v62, s[80:83], s94 offen
  v_fmac_f32 v246, v248, v225
  v_fmac_f32 v247, v249, v225
  s_waitcnt vmcnt(25)
  v_mfma_f32_32x32x16_bf16 v[96:111], v[56:59], v[188:191], v[96:111]
  ds_read_b64_tr_b16 v[52:53], v10 offset:20480
  ds_read_b64_tr_b16 v[54:55], v10 offset:21504
  s_add_u32 m0, s97, 0
  s_mov_b32 s94, 3145728
  buffer_load_dwordx4 v4, s[8:11], s94 offen lds
  v_lshlrev_b32 v248, 16, v236
  v_and_b32 v249, 0xffff0000, v236
  v_fmac_f32 v240, v248, v226
  v_fmac_f32 v241, v249, v226
  v_mfma_f32_32x32x16_bf16 v[112:127], v[32:35], v[188:191], v[112:127]
  ds_read_b64_tr_b16 v[56:57], v10 offset:20736
  ds_read_b64_tr_b16 v[58:59], v10 offset:21760
  s_add_u32 m0, s97, 1024
  s_mov_b32 s94, 3178496
  buffer_load_dwordx4 v4, s[8:11], s94 offen lds
  v_lshlrev_b32 v248, 16, v237
  v_and_b32 v249, 0xffff0000, v237
  v_fmac_f32 v242, v248, v226
  v_fmac_f32 v243, v249, v226
  s_waitcnt lgkmcnt(10)
  v_mfma_f32_32x32x16_bf16 v[64:79], v[36:39], v[192:195], v[64:79]
  ds_read_b64_tr_b16 v[32:33], v10 offset:20992
  ds_read_b64_tr_b16 v[34:35], v10 offset:22016
  s_add_u32 m0, s96, 4096
  s_mov_b32 s94, 896
  buffer_load_dwordx4 v2, s[4:7], s94 offen lds
  v_lshlrev_b32 v248, 16, v238
  v_and_b32 v249, 0xffff0000, v238
  v_fmac_f32 v244, v248, v226
  v_fmac_f32 v245, v249, v226
  s_waitcnt lgkmcnt(10)
  v_mfma_f32_32x32x16_bf16 v[80:95], v[40:43], v[192:195], v[80:95]
  ds_read_b64_tr_b16 v[36:37], v10 offset:21248
  ds_read_b64_tr_b16 v[38:39], v10 offset:22272
  s_add_u32 m0, s96, 5120
  s_mov_b32 s94, 9088
  buffer_load_dwordx4 v3, s[4:7], s94 offen lds
  v_lshlrev_b32 v248, 16, v239
  v_and_b32 v249, 0xffff0000, v239
  v_fmac_f32 v246, v248, v226
  v_fmac_f32 v247, v249, v226
  s_waitcnt lgkmcnt(10)
  v_mfma_f32_32x32x16_bf16 v[96:111], v[44:47], v[192:195], v[96:111]
  ds_read_b64_tr_b16 v[40:41], v10 offset:24576
  ds_read_b64_tr_b16 v[42:43], v10 offset:25600
  s_add_u32 m0, s96, 6144
  s_mov_b32 s94, 17280
  buffer_load_dwordx4 v2, s[4:7], s94 offen lds
  v_add_f32_dpp v240, v240, v240 row_ror:2 row_mask:0xf bank_mask:0xf
  v_add_f32_dpp v241, v241, v241 row_ror:2 row_mask:0xf bank_mask:0xf
  v_add_f32_dpp v242, v242, v242 row_ror:2 row_mask:0xf bank_mask:0xf
  v_add_f32_dpp v243, v243, v243 row_ror:2 row_mask:0xf bank_mask:0xf
  s_waitcnt lgkmcnt(10)
  v_mfma_f32_32x32x16_bf16 v[112:127], v[48:51], v[192:195], v[112:127]
  ds_read_b64_tr_b16 v[44:45], v10 offset:24832
  ds_read_b64_tr_b16 v[46:47], v10 offset:25856
  s_add_u32 m0, s96, 7168
  s_mov_b32 s94, 25472
  buffer_load_dwordx4 v3, s[4:7], s94 offen lds
  v_add_f32_dpp v244, v244, v244 row_ror:2 row_mask:0xf bank_mask:0xf
  v_add_f32_dpp v245, v245, v245 row_ror:2 row_mask:0xf bank_mask:0xf
  v_add_f32_dpp v246, v246, v246 row_ror:2 row_mask:0xf bank_mask:0xf
  v_add_f32_dpp v247, v247, v247 row_ror:2 row_mask:0xf bank_mask:0xf
  s_waitcnt lgkmcnt(10)
  v_mfma_f32_32x32x16_bf16 v[64:79], v[52:55], v[196:199], v[64:79]
  ds_read_b64_tr_b16 v[48:49], v10 offset:25088
  ds_read_b64_tr_b16 v[50:51], v10 offset:26112
  v_add_f32_dpp v240, v240, v240 row_ror:4 row_mask:0xf bank_mask:0xf
  v_add_f32_dpp v241, v241, v241 row_ror:4 row_mask:0xf bank_mask:0xf
  v_add_f32_dpp v242, v242, v242 row_ror:4 row_mask:0xf bank_mask:0xf
  v_add_f32_dpp v243, v243, v243 row_ror:4 row_mask:0xf bank_mask:0xf
  s_waitcnt lgkmcnt(10)
  v_mfma_f32_32x32x16_bf16 v[80:95], v[56:59], v[196:199], v[80:95]
  ds_read_b64_tr_b16 v[52:53], v10 offset:25344
  ds_read_b64_tr_b16 v[54:55], v10 offset:26368
  v_add_f32_dpp v244, v244, v244 row_ror:4 row_mask:0xf bank_mask:0xf
  v_add_f32_dpp v245, v245, v245 row_ror:4 row_mask:0xf bank_mask:0xf
  v_add_f32_dpp v246, v246, v246 row_ror:4 row_mask:0xf bank_mask:0xf
  v_add_f32_dpp v247, v247, v247 row_ror:4 row_mask:0xf bank_mask:0xf
  s_waitcnt lgkmcnt(10)
  v_mfma_f32_32x32x16_bf16 v[96:111], v[32:35], v[196:199], v[96:111]
  ds_read_b64_tr_b16 v[56:57], v10 offset:28672
  ds_read_b64_tr_b16 v[58:59], v10 offset:29696
  v_add_f32_dpp v240, v240, v240 row_ror:8 row_mask:0xf bank_mask:0xf
  v_add_f32_dpp v241, v241, v241 row_ror:8 row_mask:0xf bank_mask:0xf
  v_add_f32_dpp v242, v242, v242 row_ror:8 row_mask:0xf bank_mask:0xf
  v_add_f32_dpp v243, v243, v243 row_ror:8 row_mask:0xf bank_mask:0xf
  s_waitcnt lgkmcnt(10)
  v_mfma_f32_32x32x16_bf16 v[112:127], v[36:39], v[196:199], v[112:127]
  ds_read_b64_tr_b16 v[32:33], v10 offset:28928
  ds_read_b64_tr_b16 v[34:35], v10 offset:29952
  v_add_f32_dpp v244, v244, v244 row_ror:8 row_mask:0xf bank_mask:0xf
  v_add_f32_dpp v245, v245, v245 row_ror:8 row_mask:0xf bank_mask:0xf
  v_add_f32_dpp v246, v246, v246 row_ror:8 row_mask:0xf bank_mask:0xf
  v_add_f32_dpp v247, v247, v247 row_ror:8 row_mask:0xf bank_mask:0xf
  s_waitcnt lgkmcnt(10)
  v_mfma_f32_32x32x16_bf16 v[64:79], v[40:43], v[200:203], v[64:79]
  ds_read_b64_tr_b16 v[36:37], v10 offset:29184
  ds_read_b64_tr_b16 v[38:39], v10 offset:30208
  ds_write_b128 v252, v[240:243]
  ds_write_b128 v252, v[244:247] offset:16
  s_waitcnt lgkmcnt(12)
  v_mfma_f32_32x32x16_bf16 v[80:95], v[44:47], v[200:203], v[80:95]
  ds_read_b64_tr_b16 v[40:41], v10 offset:29440
  ds_read_b64_tr_b16 v[42:43], v10 offset:30464
  s_waitcnt lgkmcnt(12)
  v_mfma_f32_32x32x16_bf16 v[96:111], v[48:51], v[200:203], v[96:111]
  s_waitcnt lgkmcnt(10)
  v_mfma_f32_32x32x16_bf16 v[112:127], v[52:55], v[200:203], v[112:127]
  s_waitcnt lgkmcnt(8)
  v_mfma_f32_32x32x16_bf16 v[64:79], v[56:59], v[204:207], v[64:79]
  s_waitcnt vmcnt(12) lgkmcnt(0)
  s_barrier
  ds_read_b128 v[208:211], v6 offset:8192
  ds_read_b128 v[212:215], v7 offset:8192
  ds_read_b128 v[216:219], v8 offset:8192
  ds_read_b128 v[220:223], v9 offset:8192
  ds_read_b64_tr_b16 v[44:45], v10 offset:32768
  ds_read_b64_tr_b16 v[46:47], v10 offset:33792
  ds_read_b64_tr_b16 v[48:49], v10 offset:33024
  ds_read_b64_tr_b16 v[50:51], v10 offset:34048
  ds_read_b64_tr_b16 v[52:53], v10 offset:33280
  ds_read_b64_tr_b16 v[54:55], v10 offset:34304
  s_add_u32 m0, s97, 16384
  s_mov_b32 s94, 3670016
  buffer_load_dwordx4 v4, s[8:11], s94 offen lds
  v_mfma_f32_32x32x16_bf16 v[80:95], v[32:35], v[204:207], v[80:95]
  ds_read_b64_tr_b16 v[56:57], v10 offset:33536
  ds_read_b64_tr_b16 v[58:59], v10 offset:34560
  s_add_u32 m0, s97, 17408
  s_mov_b32 s94, 3702784
  buffer_load_dwordx4 v4, s[8:11], s94 offen lds
  s_waitcnt vmcnt(9)
  v_and_b32 v21, v21, v63
  v_cmp_ne_u32 vcc, v21, v63
  s_cmp_lg_u64 vcc, 0
  s_cbranch_scc1 kva_kernel_lnw_6
kva_kernel_lnb_7:
  buffer_load_dword v24, v15, s[32:35], 0 offen offset:0 sc1
  buffer_load_dword v25, v15, s[32:35], 0 offen offset:256 sc1
  buffer_load_dword v26, v15, s[32:35], 0 offen offset:512 sc1
  buffer_load_dword v27, v15, s[32:35], 0 offen offset:768 sc1
  buffer_load_dword v28, v15, s[32:35], 0 offen offset:1024 sc1
  buffer_load_dword v29, v15, s[32:35], 0 offen offset:1280 sc1
  buffer_load_dword v30, v15, s[32:35], 0 offen offset:1536 sc1
  buffer_load_dword v31, v15, s[32:35], 0 offen offset:1792 sc1
  buffer_load_dword v21, v15, s[32:35], 0 offen offset:2048 sc1
  buffer_load_dword v22, v15, s[32:35], 0 offen offset:2304 sc1
kva_kernel_lnc_8:
  ds_read_b32 v240, v253 offset:0
  v_mfma_f32_32x32x16_bf16 v[96:111], v[36:39], v[204:207], v[96:111]
  ds_read_b64_tr_b16 v[32:33], v10 offset:36864
  ds_read_b64_tr_b16 v[34:35], v10 offset:37888
  ds_read_b32 v241, v253 offset:64
  ds_read_b32 v242, v253 offset:128
  v_mfma_f32_32x32x16_bf16 v[112:127], v[40:43], v[204:207], v[112:127]
  ds_read_b64_tr_b16 v[36:37], v10 offset:37120
  ds_read_b64_tr_b16 v[38:39], v10 offset:38144
  ds_read_b32 v243, v253 offset:192
  ds_read_b32 v244, v253 offset:256
  s_waitcnt lgkmcnt(15)
  v_mfma_f32_32x32x16_bf16 v[64:79], v[44:47], v[208:211], v[64:79]
  ds_read_b64_tr_b16 v[40:41], v10 offset:37376
  ds_read_b64_tr_b16 v[42:43], v10 offset:38400
  s_add_u32 m0, s96, 8192
  s_add_u32 s94, s98, 0
  buffer_load_dwordx4 v5, s[8:11], s94 offen lds
  ds_read_b32 v245, v253 offset:320
  ds_read_b32 v246, v253 offset:384
  s_waitcnt lgkmcnt(15)
  v_mfma_f32_32x32x16_bf16 v[80:95], v[48:51], v[208:211], v[80:95]
  ds_read_b64_tr_b16 v[44:45], v10 offset:37632
  ds_read_b64_tr_b16 v[46:47], v10 offset:38656
  s_add_u32 m0, s96, 9216
  s_add_u32 s94, s98, 65536
  buffer_load_dwordx4 v5, s[8:11], s94 offen lds
  ds_read_b32 v247, v253 offset:448
  v_mfma_f32_32x32x16_bf16 v[96:111], v[52:55], v[208:211], v[96:111]
  ds_read_b64_tr_b16 v[48:49], v10 offset:40960
  ds_read_b64_tr_b16 v[50:51], v10 offset:41984
  s_add_u32 m0, s96, 10240
  s_add_u32 s94, s98, 131072
  buffer_load_dwordx4 v5, s[8:11], s94 offen lds
  s_waitcnt lgkmcnt(2)
  v_add_f32 v240, v240, v241
  v_add_f32 v242, v242, v243
  v_mfma_f32_32x32x16_bf16 v[112:127], v[56:59], v[208:211], v[112:127]
  ds_read_b64_tr_b16 v[52:53], v10 offset:41216
  ds_read_b64_tr_b16 v[54:55], v10 offset:42240
  s_add_u32 m0, s96, 11264
  s_add_u32 s94, s98, 196608
  buffer_load_dwordx4 v5, s[8:11], s94 offen lds
  v_add_f32 v244, v244, v245
  v_add_f32 v246, v246, v247
  v_add_f32 v240, v240, v242
  v_add_f32 v244, v244, v246
  v_mfma_f32_32x32x16_bf16 v[64:79], v[32:35], v[212:215], v[64:79]
  ds_read_b64_tr_b16 v[56:57], v10 offset:41472
  ds_read_b64_tr_b16 v[58:59], v10 offset:42496
  v_add_f32 v240, v240, v244
  v_mov_b32 v241, v240
  s_nop 1
  v_permlane32_swap_b32 v240, v241
  v_add_f32 v240, v240, v241
  v_mfma_f32_32x32x16_bf16 v[80:95], v[36:39], v[212:215], v[80:95]
  ds_read_b64_tr_b16 v[32:33], v10 offset:41728
  ds_read_b64_tr_b16 v[34:35], v10 offset:42752
  v_mov_b32 v241, v240
  s_nop 1
  v_permlane16_swap_b32 v240, v241
  v_add_f32 v240, v240, v241
  v_cvt_pk_bf16_f32 v240, v240, v240
  v_mfma_f32_32x32x16_bf16 v[96:111], v[40:43], v[212:215], v[96:111]
  ds_read_b64_tr_b16 v[36:37], v10 offset:45056
  ds_read_b64_tr_b16 v[38:39], v10 offset:46080
  v_lshlrev_b32 v240, 16, v240
  buffer_store_dword v240, v15, s[52:55], 0 offen
  v_mfma_f32_32x32x16_bf16 v[112:127], v[44:47], v[212:215], v[112:127]
  ds_read_b64_tr_b16 v[40:41], v10 offset:45312
  ds_read_b64_tr_b16 v[42:43], v10 offset:46336
  s_waitcnt lgkmcnt(10)
  v_mfma_f32_32x32x16_bf16 v[64:79], v[48:51], v[216:219], v[64:79]
  ds_read_b64_tr_b16 v[44:45], v10 offset:45568
  ds_read_b64_tr_b16 v[46:47], v10 offset:46592
  s_waitcnt lgkmcnt(10)
  v_mfma_f32_32x32x16_bf16 v[80:95], v[52:55], v[216:219], v[80:95]
  ds_read_b64_tr_b16 v[48:49], v10 offset:45824
  ds_read_b64_tr_b16 v[50:51], v10 offset:46848
  s_waitcnt lgkmcnt(10)
  v_mfma_f32_32x32x16_bf16 v[96:111], v[56:59], v[216:219], v[96:111]
  s_waitcnt lgkmcnt(8)
  v_mfma_f32_32x32x16_bf16 v[112:127], v[32:35], v[216:219], v[112:127]
  s_waitcnt lgkmcnt(6)
  v_mfma_f32_32x32x16_bf16 v[64:79], v[36:39], v[220:223], v[64:79]
  s_waitcnt vmcnt(21) lgkmcnt(0)
  s_barrier
  ds_read_b128 v[224:227], v6 offset:0
  ds_read_b128 v[228:231], v7 offset:0
  ds_read_b128 v[232:235], v8 offset:0
  ds_read_b128 v[236:239], v9 offset:0
  ds_read_b64_tr_b16 v[52:53], v10 offset:0
  ds_read_b64_tr_b16 v[54:55], v10 offset:1024
  ds_read_b64_tr_b16 v[56:57], v10 offset:256
  ds_read_b64_tr_b16 v[58:59], v10 offset:1280
  ds_read_b64_tr_b16 v[32:33], v10 offset:512
  ds_read_b64_tr_b16 v[34:35], v10 offset:1536
  v_mfma_f32_32x32x16_bf16 v[80:95], v[40:43], v[220:223], v[80:95]
  ds_read_b64_tr_b16 v[36:37], v10 offset:768
  ds_read_b64_tr_b16 v[38:39], v10 offset:1792
  v_mfma_f32_32x32x16_bf16 v[96:111], v[44:47], v[220:223], v[96:111]
  ds_read_b64_tr_b16 v[40:41], v10 offset:4096
  ds_read_b64_tr_b16 v[42:43], v10 offset:5120
  v_mfma_f32_32x32x16_bf16 v[112:127], v[48:51], v[220:223], v[112:127]
  ds_read_b64_tr_b16 v[44:45], v10 offset:4352
  ds_read_b64_tr_b16 v[46:47], v10 offset:5376
  s_waitcnt lgkmcnt(10)
  v_mfma_f32_32x32x16_bf16 v[64:79], v[52:55], v[224:227], v[64:79]
  ds_read_b64_tr_b16 v[48:49], v10 offset:4608
  ds_read_b64_tr_b16 v[50:51], v10 offset:5632
  s_add_u32 m0, s96, 0
  s_add_u32 s94, s98, 2097152
  buffer_load_dwordx4 v5, s[8:11], s94 offen lds
  s_waitcnt vmcnt(6)
  v_lshlrev_b32 v1, 16, v16
  v_and_b32 v61, 0xffff0000, v16
  s_waitcnt lgkmcnt(10)
  v_mfma_f32_32x32x16_bf16 v[80:95], v[56:59], v[224:227], v[80:95]
  ds_read_b64_tr_b16 v[52:53], v10 offset:4864
  ds_read_b64_tr_b16 v[54:55], v10 offset:5888
  s_add_u32 m0, s96, 1024
  s_add_u32 s94, s98, 2162688
  buffer_load_dwordx4 v5, s[8:11], s94 offen lds
  v_lshlrev_b32 v62, 16, v29
  v_and_b32 v63, 0xffff0000, v29
  v_mul_f32 v1, v1, v62
  v_mul_f32 v61, v61, v63
  s_waitcnt lgkmcnt(10)
  v_mfma_f32_32x32x16_bf16 v[96:111], v[32:35], v[224:227], v[96:111]
  ds_read_b64_tr_b16 v[56:57], v10 offset:8192
  ds_read_b64_tr_b16 v[58:59], v10 offset:9216
  s_add_u32 m0, s96, 2048
  s_add_u32 s94, s98, 2228224
  buffer_load_dwordx4 v5, s[8:11], s94 offen lds
  v_cvt_pk_bf16_f32 v62, v1, v61
  v_lshlrev_b32 v1, 16, v62
  v_and_b32 v61, 0xffff0000, v62
  v_lshlrev_b32 v62, 16, v24
  s_waitcnt lgkmcnt(10)
  v_mfma_f32_32x32x16_bf16 v[112:127], v[36:39], v[224:227], v[112:127]
  ds_read_b64_tr_b16 v[32:33], v10 offset:8448
  ds_read_b64_tr_b16 v[34:35], v10 offset:9472
  s_add_u32 m0, s96, 3072
  s_add_u32 s94, s98, 2293760
  buffer_load_dwordx4 v5, s[8:11], s94 offen lds
  v_and_b32 v63, 0xffff0000, v24
  v_add_f32 v1, v1, v62
  v_add_f32 v61, v61, v63
  v_cvt_pk_bf16_f32 v16, v1, v61
  s_waitcnt lgkmcnt(10)
  v_mfma_f32_32x32x16_bf16 v[64:79], v[40:43], v[228:231], v[64:79]
  ds_read_b64_tr_b16 v[36:37], v10 offset:8704
  ds_read_b64_tr_b16 v[38:39], v10 offset:9728
  ds_write_b32 v23, v16 offset:0
  v_lshlrev_b32 v1, 16, v17
  v_and_b32 v61, 0xffff0000, v17
  s_waitcnt lgkmcnt(11)
  v_mfma_f32_32x32x16_bf16 v[80:95], v[44:47], v[228:231], v[80:95]
  ds_read_b64_tr_b16 v[40:41], v10 offset:8960
  ds_read_b64_tr_b16 v[42:43], v10 offset:9984
  v_lshlrev_b32 v62, 16, v30
  v_and_b32 v63, 0xffff0000, v30
  v_mul_f32 v1, v1, v62
  v_mul_f32 v61, v61, v63
  s_waitcnt lgkmcnt(11)
  v_mfma_f32_32x32x16_bf16 v[96:111], v[48:51], v[228:231], v[96:111]
  ds_read_b64_tr_b16 v[44:45], v10 offset:12288
  ds_read_b64_tr_b16 v[46:47], v10 offset:13312
  v_cvt_pk_bf16_f32 v62, v1, v61
  v_lshlrev_b32 v1, 16, v62
  v_and_b32 v61, 0xffff0000, v62
  v_lshlrev_b32 v62, 16, v25
  s_waitcnt lgkmcnt(11)
  v_mfma_f32_32x32x16_bf16 v[112:127], v[52:55], v[228:231], v[112:127]
  ds_read_b64_tr_b16 v[48:49], v10 offset:12544
  ds_read_b64_tr_b16 v[50:51], v10 offset:13568
  v_and_b32 v63, 0xffff0000, v25
  v_add_f32 v1, v1, v62
  v_add_f32 v61, v61, v63
  v_cvt_pk_bf16_f32 v17, v1, v61
  s_waitcnt lgkmcnt(11)
  v_mfma_f32_32x32x16_bf16 v[64:79], v[56:59], v[232:235], v[64:79]
  ds_read_b64_tr_b16 v[52:53], v10 offset:12800
  ds_read_b64_tr_b16 v[54:55], v10 offset:13824
  ds_write_b32 v23, v17 offset:2304
  v_lshlrev_b32 v1, 16, v18
  v_and_b32 v61, 0xffff0000, v18
  s_waitcnt lgkmcnt(12)
  v_mfma_f32_32x32x16_bf16 v[80:95], v[32:35], v[232:235], v[80:95]
  ds_read_b64_tr_b16 v[56:57], v10 offset:13056
  ds_read_b64_tr_b16 v[58:59], v10 offset:14080
  v_lshlrev_b32 v62, 16, v31
  v_and_b32 v63, 0xffff0000, v31
  v_mul_f32 v1, v1, v62
  v_mul_f32 v61, v61, v63
  s_waitcnt lgkmcnt(12)
  v_mfma_f32_32x32x16_bf16 v[96:111], v[36:39], v[232:235], v[96:111]
  v_cvt_pk_bf16_f32 v62, v1, v61
  v_lshlrev_b32 v1, 16, v62
  v_and_b32 v61, 0xffff0000, v62
  v_lshlrev_b32 v62, 16, v26
  s_waitcnt lgkmcnt(9)
  v_mfma_f32_32x32x16_bf16 v[112:127], v[40:43], v[232:235], v[112:127]
  v_and_b32 v63, 0xffff0000, v26
  v_add_f32 v1, v1, v62
  v_add_f32 v61, v61, v63
  v_cvt_pk_bf16_f32 v18, v1, v61
  s_waitcnt lgkmcnt(7)
  v_mfma_f32_32x32x16_bf16 v[64:79], v[44:47], v[236:239], v[64:79]
  s_waitcnt vmcnt(19) lgkmcnt(0)
  s_barrier
  ds_read_b128 v[240:243], v6 offset:4096
  ds_read_b128 v[244:247], v7 offset:4096
  ds_read_b128 v[248:251], v8 offset:4096
  ds_read_b128 v[252:255], v9 offset:4096
  ds_read_b64_tr_b16 v[32:33], v10 offset:16384
  ds_read_b64_tr_b16 v[34:35], v10 offset:17408
  ds_read_b64_tr_b16 v[36:37], v10 offset:16640
  ds_read_b64_tr_b16 v[38:39], v10 offset:17664
  ds_read_b64_tr_b16 v[40:41], v10 offset:16896
  ds_read_b64_tr_b16 v[42:43], v10 offset:17920
  ds_write_b32 v23, v18 offset:4608
  v_lshlrev_b32 v1, 16, v19
  v_and_b32 v61, 0xffff0000, v19
  v_mfma_f32_32x32x16_bf16 v[80:95], v[48:51], v[236:239], v[80:95]
  ds_read_b64_tr_b16 v[44:45], v10 offset:17152
  ds_read_b64_tr_b16 v[46:47], v10 offset:18176
  v_lshlrev_b32 v62, 16, v21
  v_and_b32 v63, 0xffff0000, v21
  v_mul_f32 v1, v1, v62
  v_mul_f32 v61, v61, v63
  v_mfma_f32_32x32x16_bf16 v[96:111], v[52:55], v[236:239], v[96:111]
  ds_read_b64_tr_b16 v[48:49], v10 offset:20480
  ds_read_b64_tr_b16 v[50:51], v10 offset:21504
  v_cvt_pk_bf16_f32 v62, v1, v61
  v_lshlrev_b32 v1, 16, v62
  v_and_b32 v61, 0xffff0000, v62
  v_lshlrev_b32 v62, 16, v27
  v_mfma_f32_32x32x16_bf16 v[112:127], v[56:59], v[236:239], v[112:127]
  ds_read_b64_tr_b16 v[52:53], v10 offset:20736
  ds_read_b64_tr_b16 v[54:55], v10 offset:21760
  v_and_b32 v63, 0xffff0000, v27
  v_add_f32 v1, v1, v62
  v_add_f32 v61, v61, v63
  v_cvt_pk_bf16_f32 v19, v1, v61
  s_waitcnt lgkmcnt(11)
  v_mfma_f32_32x32x16_bf16 v[64:79], v[32:35], v[240:243], v[64:79]
  ds_read_b64_tr_b16 v[56:57], v10 offset:20992
  ds_read_b64_tr_b16 v[58:59], v10 offset:22016
  s_add_u32 m0, s96, 4096
  s_add_u32 s94, s98, 128
  buffer_load_dwordx4 v5, s[8:11], s94 offen lds
  ds_write_b32 v23, v19 offset:6912
  v_lshlrev_b32 v1, 16, v20
  v_and_b32 v61, 0xffff0000, v20
  s_waitcnt lgkmcnt(12)
  v_mfma_f32_32x32x16_bf16 v[80:95], v[36:39], v[240:243], v[80:95]
  ds_read_b64_tr_b16 v[32:33], v10 offset:21248
  ds_read_b64_tr_b16 v[34:35], v10 offset:22272
  s_add_u32 m0, s96, 5120
  s_add_u32 s94, s98, 65664
  buffer_load_dwordx4 v5, s[8:11], s94 offen lds
  v_lshlrev_b32 v62, 16, v22
  v_and_b32 v63, 0xffff0000, v22
  v_mul_f32 v1, v1, v62
  v_mul_f32 v61, v61, v63
  s_waitcnt lgkmcnt(12)
  v_mfma_f32_32x32x16_bf16 v[96:111], v[40:43], v[240:243], v[96:111]
  ds_read_b64_tr_b16 v[36:37], v10 offset:24576
  ds_read_b64_tr_b16 v[38:39], v10 offset:25600
  s_add_u32 m0, s96, 6144
  s_add_u32 s94, s98, 131200
  buffer_load_dwordx4 v5, s[8:11], s94 offen lds
  v_cvt_pk_bf16_f32 v62, v1, v61
  v_lshlrev_b32 v1, 16, v62
  v_and_b32 v61, 0xffff0000, v62
  v_lshlrev_b32 v62, 16, v28
  s_waitcnt lgkmcnt(11)
  v_mfma_f32_32x32x16_bf16 v[112:127], v[44:47], v[240:243], v[112:127]
  ds_read_b64_tr_b16 v[40:41], v10 offset:24832
  ds_read_b64_tr_b16 v[42:43], v10 offset:25856
  s_add_u32 m0, s96, 7168
  s_add_u32 s94, s98, 196736
  buffer_load_dwordx4 v5, s[8:11], s94 offen lds
  v_and_b32 v63, 0xffff0000, v28
  v_add_f32 v1, v1, v62
  v_add_f32 v61, v61, v63
  v_cvt_pk_bf16_f32 v20, v1, v61
  s_waitcnt lgkmcnt(11)
  v_mfma_f32_32x32x16_bf16 v[64:79], v[48:51], v[244:247], v[64:79]
  ds_read_b64_tr_b16 v[44:45], v10 offset:25088
  ds_read_b64_tr_b16 v[46:47], v10 offset:26112
  ds_write_b32 v23, v20 offset:9216
  s_movk_i32 s91, 144
  v_lshrrev_b32 v16, 3, v0
  s_waitcnt lgkmcnt(12)
  v_mfma_f32_32x32x16_bf16 v[80:95], v[52:55], v[244:247], v[80:95]
  ds_read_b64_tr_b16 v[48:49], v10 offset:25344
  ds_read_b64_tr_b16 v[50:51], v10 offset:26368
  s_mul_i32 s95, s3, 10
  v_add_u32 v16, s95, v16
  v_and_b32 v17, 7, v0
  v_lshlrev_b32 v17, 4, v17
  s_waitcnt lgkmcnt(12)
  v_mfma_f32_32x32x16_bf16 v[96:111], v[56:59], v[244:247], v[96:111]
  ds_read_b64_tr_b16 v[52:53], v10 offset:28672
  ds_read_b64_tr_b16 v[54:55], v10 offset:29696
  v_mad_u32_u24 v18, v16, s91, v17
  v_add_u32 v18, 149504, v18
  v_lshl_add_u32 v17, v16, 9, v17
  v_cmp_gt_u32 vcc, 16, v0
  s_waitcnt lgkmcnt(11)
  v_mfma_f32_32x32x16_bf16 v[112:127], v[32:35], v[244:247], v[112:127]
  ds_read_b64_tr_b16 v[56:57], v10 offset:28928
  ds_read_b64_tr_b16 v[58:59], v10 offset:29952
  v_cndmask_b32 v19, 2.0, v17, vcc
  s_waitcnt lgkmcnt(11)
  v_mfma_f32_32x32x16_bf16 v[64:79], v[36:39], v[248:251], v[64:79]
  ds_read_b64_tr_b16 v[32:33], v10 offset:29184
  ds_read_b64_tr_b16 v[34:35], v10 offset:30208
  s_waitcnt lgkmcnt(11)
  v_mfma_f32_32x32x16_bf16 v[80:95], v[40:43], v[248:251], v[80:95]
  ds_read_b64_tr_b16 v[36:37], v10 offset:29440
  ds_read_b64_tr_b16 v[38:39], v10 offset:30464
  s_waitcnt lgkmcnt(11)
  v_mfma_f32_32x32x16_bf16 v[96:111], v[44:47], v[248:251], v[96:111]
  s_waitcnt lgkmcnt(8)
  v_mfma_f32_32x32x16_bf16 v[112:127], v[48:51], v[248:251], v[112:127]
  s_waitcnt lgkmcnt(6)
  v_mfma_f32_32x32x16_bf16 v[64:79], v[52:55], v[252:255], v[64:79]
  s_waitcnt vmcnt(9) lgkmcnt(0)
  s_barrier
  ds_read_b64_tr_b16 v[40:41], v11 offset:8192
  ds_read_b64_tr_b16 v[42:43], v11 offset:8704
  ds_read_b64_tr_b16 v[44:45], v11 offset:8448
  ds_read_b64_tr_b16 v[46:47], v11 offset:8960
  ds_read_b64_tr_b16 v[48:49], v11 offset:10240
  ds_read_b64_tr_b16 v[50:51], v11 offset:10752
  v_mfma_f32_32x32x16_bf16 v[80:95], v[56:59], v[252:255], v[80:95]
  ds_read_b64_tr_b16 v[52:53], v11 offset:10496
  ds_read_b64_tr_b16 v[54:55], v11 offset:11008
  v_mfma_f32_32x32x16_bf16 v[96:111], v[32:35], v[252:255], v[96:111]
  ds_read_b64_tr_b16 v[56:57], v11 offset:20480
  ds_read_b64_tr_b16 v[58:59], v11 offset:20992
  v_mfma_f32_32x32x16_bf16 v[112:127], v[36:39], v[252:255], v[112:127]
  ds_read_b64_tr_b16 v[32:33], v11 offset:20736
  ds_read_b64_tr_b16 v[34:35], v11 offset:21248
  v_cvt_pk_bf16_f32 v24, v64, v65
  v_cvt_pk_bf16_f32 v25, v66, v67
  v_cvt_pk_bf16_f32 v26, v68, v69
  v_cvt_pk_bf16_f32 v27, v70, v71
  v_cvt_pk_bf16_f32 v28, v72, v73
  v_cvt_pk_bf16_f32 v29, v74, v75
  v_cvt_pk_bf16_f32 v30, v76, v77
  v_cvt_pk_bf16_f32 v31, v78, v79
  s_waitcnt lgkmcnt(10)
  v_mfma_f32_32x32x16_bf16 v[64:79], v[40:43], v[128:131], 0
  ds_read_b64_tr_b16 v[36:37], v11 offset:22528
  ds_read_b64_tr_b16 v[38:39], v11 offset:23040
  v_cvt_pk_bf16_f32 v96, v96, v97
  v_cvt_pk_bf16_f32 v97, v98, v99
  v_cvt_pk_bf16_f32 v98, v100, v101
  v_cvt_pk_bf16_f32 v99, v102, v103
  v_cvt_pk_bf16_f32 v100, v104, v105
  v_cvt_pk_bf16_f32 v101, v106, v107
  v_cvt_pk_bf16_f32 v102, v108, v109
  v_cvt_pk_bf16_f32 v103, v110, v111
  v_cvt_pk_bf16_f32 v104, v80, v81
  v_cvt_pk_bf16_f32 v105, v82, v83
  v_cvt_pk_bf16_f32 v106, v84, v85
  v_cvt_pk_bf16_f32 v107, v86, v87
  v_cvt_pk_bf16_f32 v108, v88, v89
  v_cvt_pk_bf16_f32 v109, v90, v91
  v_cvt_pk_bf16_f32 v110, v92, v93
  v_cvt_pk_bf16_f32 v111, v94, v95
  s_waitcnt lgkmcnt(10)
  v_mfma_f32_32x32x16_bf16 v[80:95], v[44:47], v[128:131], 0
  ds_read_b64_tr_b16 v[40:41], v11 offset:22784
  ds_read_b64_tr_b16 v[42:43], v11 offset:23296
  v_cvt_pk_bf16_f32 v112, v112, v113
  v_cvt_pk_bf16_f32 v113, v114, v115
  v_cvt_pk_bf16_f32 v114, v116, v117
  v_cvt_pk_bf16_f32 v115, v118, v119
  v_cvt_pk_bf16_f32 v116, v120, v121
  v_cvt_pk_bf16_f32 v117, v122, v123
  v_cvt_pk_bf16_f32 v118, v124, v125
  v_cvt_pk_bf16_f32 v119, v126, v127
  s_waitcnt lgkmcnt(10)
  v_mfma_f32_32x32x16_bf16 v[64:79], v[48:51], v[132:135], v[64:79]
  ds_read_b64_tr_b16 v[44:45], v11 offset:32768
  ds_read_b64_tr_b16 v[46:47], v11 offset:33280
  s_waitcnt lgkmcnt(10)
  v_mfma_f32_32x32x16_bf16 v[80:95], v[52:55], v[132:135], v[80:95]
  ds_read_b64_tr_b16 v[48:49], v11 offset:33024
  ds_read_b64_tr_b16 v[50:51], v11 offset:33536
  s_add_u32 s94, s99, 0
  buffer_store_dwordx4 v[24:27], v14, s[16:19], s94 offen offset:0 sc1
  ds_read_b128 v[120:123], v18 offset:0
  ds_read_b128 v[124:127], v18 offset:1152
  s_waitcnt lgkmcnt(12)
  v_mfma_f32_32x32x16_bf16 v[64:79], v[56:59], v[136:139], v[64:79]
  ds_read_b64_tr_b16 v[52:53], v11 offset:34816
  ds_read_b64_tr_b16 v[54:55], v11 offset:35328
  s_waitcnt lgkmcnt(12)
  v_mfma_f32_32x32x16_bf16 v[80:95], v[32:35], v[136:139], v[80:95]
  ds_read_b64_tr_b16 v[56:57], v11 offset:35072
  ds_read_b64_tr_b16 v[58:59], v11 offset:35584
  s_waitcnt lgkmcnt(12)
  v_mfma_f32_32x32x16_bf16 v[64:79], v[36:39], v[140:143], v[64:79]
  ds_read_b64_tr_b16 v[32:33], v11 offset:45056
  ds_read_b64_tr_b16 v[34:35], v11 offset:45568
  s_waitcnt lgkmcnt(6)
  s_and_b32 s94, s2, 7
  v_lshlrev_b32 v18, 2, s94
  v_mov_b32 v16, 0
  s_cmp_eq_u32 s3, 0
  s_cselect_b64 exec, 1, 0
  s_bfe_u32 s94, s2, 0x20003
  s_lshl_b32 s94, s94, 4
  s_add_u32 s94, s94, s92
  s_mul_i32 s94, s94, 4352
  s_add_u32 s94, s94, 2621440
  buffer_store_dword v16, v18, s[44:47], s94 offen sc1
  s_bfe_u32 s94, s2, 0x20003
  s_lshl_b32 s94, s94, 4
  s_add_u32 s94, s94, 15
  s_sub_u32 s94, s94, s92
  s_mul_i32 s94, s94, 4352
  s_add_u32 s94, s94, 2621440
  buffer_store_dword v16, v18, s[44:47], s94 offen sc1
  s_mov_b64 exec, -1
  buffer_store_dwordx4 v[120:123], v17, s[44:47], s101 offen sc1
  s_add_u32 s94, s101, 4096
  buffer_store_dwordx4 v[124:127], v19, s[44:47], s94 offen sc1
  v_mfma_f32_32x32x16_bf16 v[80:95], v[40:43], v[140:143], v[80:95]
  ds_read_b64_tr_b16 v[36:37], v11 offset:45312
  ds_read_b64_tr_b16 v[38:39], v11 offset:45824
  v_mfma_f32_32x32x16_bf16 v[64:79], v[44:47], v[144:147], v[64:79]
  ds_read_b64_tr_b16 v[40:41], v11 offset:47104
  ds_read_b64_tr_b16 v[42:43], v11 offset:47616
  v_mfma_f32_32x32x16_bf16 v[80:95], v[48:51], v[144:147], v[80:95]
  ds_read_b64_tr_b16 v[44:45], v11 offset:47360
  ds_read_b64_tr_b16 v[46:47], v11 offset:47872
  s_add_u32 s94, s99, 0
  buffer_store_dwordx4 v[28:31], v14, s[16:19], s94 offen offset:1024 sc1
  s_waitcnt lgkmcnt(10)
  v_mfma_f32_32x32x16_bf16 v[64:79], v[52:55], v[148:151], v[64:79]
  ds_read_b64_tr_b16 v[48:49], v11 offset:57344
  ds_read_b64_tr_b16 v[50:51], v11 offset:57856
  s_waitcnt lgkmcnt(10)
  v_mfma_f32_32x32x16_bf16 v[80:95], v[56:59], v[148:151], v[80:95]
  ds_read_b64_tr_b16 v[52:53], v11 offset:57600
  ds_read_b64_tr_b16 v[54:55], v11 offset:58112
  s_waitcnt lgkmcnt(10)
  v_mfma_f32_32x32x16_bf16 v[64:79], v[32:35], v[152:155], v[64:79]
  ds_read_b64_tr_b16 v[56:57], v11 offset:59392
  ds_read_b64_tr_b16 v[58:59], v11 offset:59904
  s_waitcnt lgkmcnt(10)
  v_mfma_f32_32x32x16_bf16 v[80:95], v[36:39], v[152:155], v[80:95]
  ds_read_b64_tr_b16 v[32:33], v11 offset:59648
  ds_read_b64_tr_b16 v[34:35], v11 offset:60160
  s_waitcnt lgkmcnt(10)
  v_mfma_f32_32x32x16_bf16 v[64:79], v[40:43], v[156:159], v[64:79]
  ds_read_b64_tr_b16 v[36:37], v12 offset:4096
  ds_read_b64_tr_b16 v[38:39], v12 offset:4608
  s_waitcnt lgkmcnt(10)
  v_mfma_f32_32x32x16_bf16 v[80:95], v[44:47], v[156:159], v[80:95]
  ds_read_b64_tr_b16 v[40:41], v12 offset:4352
  ds_read_b64_tr_b16 v[42:43], v12 offset:4864
  s_add_u32 s94, s99, 0
  buffer_store_dwordx4 v[104:107], v14, s[16:19], s94 offen offset:2048 sc1
  s_waitcnt lgkmcnt(10)
  v_mfma_f32_32x32x16_bf16 v[64:79], v[48:51], v[160:163], v[64:79]
  ds_read_b64_tr_b16 v[44:45], v12 offset:6144
  ds_read_b64_tr_b16 v[46:47], v12 offset:6656
  s_waitcnt lgkmcnt(10)
  v_mfma_f32_32x32x16_bf16 v[80:95], v[52:55], v[160:163], v[80:95]
  ds_read_b64_tr_b16 v[48:49], v12 offset:6400
  ds_read_b64_tr_b16 v[50:51], v12 offset:6912
  s_waitcnt lgkmcnt(10)
  v_mfma_f32_32x32x16_bf16 v[64:79], v[56:59], v[164:167], v[64:79]
  ds_read_b64_tr_b16 v[52:53], v12 offset:16384
  ds_read_b64_tr_b16 v[54:55], v12 offset:16896
  s_waitcnt lgkmcnt(10)
  v_mfma_f32_32x32x16_bf16 v[80:95], v[32:35], v[164:167], v[80:95]
  ds_read_b64_tr_b16 v[56:57], v12 offset:16640
  ds_read_b64_tr_b16 v[58:59], v12 offset:17152
  s_waitcnt lgkmcnt(10)
  v_mfma_f32_32x32x16_bf16 v[64:79], v[36:39], v[168:171], v[64:79]
  ds_read_b64_tr_b16 v[32:33], v12 offset:18432
  ds_read_b64_tr_b16 v[34:35], v12 offset:18944
  s_waitcnt lgkmcnt(10)
  v_mfma_f32_32x32x16_bf16 v[80:95], v[40:43], v[168:171], v[80:95]
  ds_read_b64_tr_b16 v[36:37], v12 offset:18688
  ds_read_b64_tr_b16 v[38:39], v12 offset:19200
  s_add_u32 s94, s99, 0
  buffer_store_dwordx4 v[108:111], v14, s[16:19], s94 offen offset:3072 sc1
  s_waitcnt lgkmcnt(10)
  v_mfma_f32_32x32x16_bf16 v[64:79], v[44:47], v[172:175], v[64:79]
  ds_read_b64_tr_b16 v[40:41], v12 offset:28672
  ds_read_b64_tr_b16 v[42:43], v12 offset:29184
  v_mov_b32 v16, v60
  v_lshrrev_b32 v17, 2, v0
  v_mov_b32 v18, 0x02020202
  v_cmp_eq_u32 vcc, s92, v17
  s_nop 1
  v_cndmask_b32 v19, 0, v18, vcc
  s_sub_u32 s94, 15, s92
  v_cmp_eq_u32 vcc, s94, v17
  s_nop 1
  v_cndmask_b32 v19, v19, v18, vcc
  s_cmp_lt_u32 s3, 4
  s_cselect_b32 s74, s92, s94
  s_lshl_b32 s74, s74, 2
  s_and_b32 s94, s3, 3
  s_add_u32 s74, s74, s94
  s_lshl_b32 s75, s74, 2
  s_mul_i32 s74, s74, 40960
  s_waitcnt lgkmcnt(10)
  v_mfma_f32_32x32x16_bf16 v[80:95], v[48:51], v[172:175], v[80:95]
  ds_read_b64_tr_b16 v[44:45], v12 offset:28928
  ds_read_b64_tr_b16 v[46:47], v12 offset:29440
  s_lshr_b32 s94, s72, 4
  v_cmp_eq_u32 vcc, s94, v17
  v_add_u32 v18, v18, v18
  s_nop 0
  v_cndmask_b32 v20, 0, v18, vcc
  v_lshlrev_b32 v18, 2, v0
  s_mov_b32 s70, s58
  s_waitcnt lgkmcnt(10)
  v_mfma_f32_32x32x16_bf16 v[64:79], v[52:55], v[176:179], v[64:79]
  ds_read_b64_tr_b16 v[48:49], v12 offset:30720
  ds_read_b64_tr_b16 v[50:51], v12 offset:31232
  s_waitcnt lgkmcnt(10)
  v_mfma_f32_32x32x16_bf16 v[80:95], v[56:59], v[176:179], v[80:95]
  ds_read_b64_tr_b16 v[52:53], v12 offset:30976
  ds_read_b64_tr_b16 v[54:55], v12 offset:31488
  s_waitcnt lgkmcnt(10)
  v_mfma_f32_32x32x16_bf16 v[64:79], v[32:35], v[180:183], v[64:79]
  s_waitcnt lgkmcnt(8)
  v_mfma_f32_32x32x16_bf16 v[80:95], v[36:39], v[180:183], v[80:95]
  s_add_u32 s94, s99, 4096
  buffer_store_dwordx4 v[96:99], v14, s[16:19], s94 offen offset:0 sc1
  s_waitcnt lgkmcnt(6)
  v_mfma_f32_32x32x16_bf16 v[64:79], v[40:43], v[184:187], v[64:79]
  s_waitcnt vmcnt(4) lgkmcnt(0)
  s_barrier
  v_mov_b32 v21, 3
  buffer_store_byte v21, v60, s[56:59], 0 offen sc1
  ds_read_b64_tr_b16 v[56:57], v11 offset:0
  ds_read_b64_tr_b16 v[58:59], v11 offset:512
  ds_read_b64_tr_b16 v[32:33], v11 offset:256
  ds_read_b64_tr_b16 v[34:35], v11 offset:768
  ds_read_b64_tr_b16 v[36:37], v11 offset:2048
  ds_read_b64_tr_b16 v[38:39], v11 offset:2560
  s_lshl_b32 m0, s3, 12
  s_add_u32 m0, m0, 131072
  s_add_u32 s94, s98, 2097280
  buffer_load_dwordx4 v5, s[8:11], s94 offen lds
  v_mfma_f32_32x32x16_bf16 v[80:95], v[44:47], v[184:187], v[80:95]
  ds_read_b64_tr_b16 v[40:41], v11 offset:2304
  ds_read_b64_tr_b16 v[42:43], v11 offset:2816
  s_lshl_b32 m0, s3, 12
  s_add_u32 m0, m0, 132096
  s_add_u32 s94, s98, 2162816
  buffer_load_dwordx4 v5, s[8:11], s94 offen lds
  v_mfma_f32_32x32x16_bf16 v[64:79], v[48:51], v[188:191], v[64:79]
  ds_read_b64_tr_b16 v[44:45], v11 offset:12288
  ds_read_b64_tr_b16 v[46:47], v11 offset:12800
  s_lshl_b32 m0, s3, 12
  s_add_u32 m0, m0, 133120
  s_add_u32 s94, s98, 2228352
  buffer_load_dwordx4 v5, s[8:11], s94 offen lds
  v_mfma_f32_32x32x16_bf16 v[80:95], v[52:55], v[188:191], v[80:95]
  ds_read_b64_tr_b16 v[48:49], v11 offset:12544
  ds_read_b64_tr_b16 v[50:51], v11 offset:13056
  s_lshl_b32 m0, s3, 12
  s_add_u32 m0, m0, 134144
  s_add_u32 s94, s98, 2293888
  buffer_load_dwordx4 v5, s[8:11], s94 offen lds
  s_waitcnt lgkmcnt(10)
  v_mfma_f32_32x32x16_bf16 v[64:79], v[56:59], v[192:195], v[64:79]
  ds_read_b64_tr_b16 v[52:53], v11 offset:14336
  ds_read_b64_tr_b16 v[54:55], v11 offset:14848
  s_waitcnt lgkmcnt(10)
  v_mfma_f32_32x32x16_bf16 v[80:95], v[32:35], v[192:195], v[80:95]
  ds_read_b64_tr_b16 v[56:57], v11 offset:14592
  ds_read_b64_tr_b16 v[58:59], v11 offset:15104
  s_add_u32 s94, s99, 4096
  buffer_store_dwordx4 v[100:103], v14, s[16:19], s94 offen offset:1024 sc1
  s_waitcnt lgkmcnt(10)
  v_mfma_f32_32x32x16_bf16 v[64:79], v[36:39], v[196:199], v[64:79]
  ds_read_b64_tr_b16 v[32:33], v11 offset:24576
  ds_read_b64_tr_b16 v[34:35], v11 offset:25088
  s_waitcnt lgkmcnt(10)
  v_mfma_f32_32x32x16_bf16 v[80:95], v[40:43], v[196:199], v[80:95]
  ds_read_b64_tr_b16 v[36:37], v11 offset:24832
  ds_read_b64_tr_b16 v[38:39], v11 offset:25344
  s_waitcnt lgkmcnt(10)
  v_mfma_f32_32x32x16_bf16 v[64:79], v[44:47], v[200:203], v[64:79]
  ds_read_b64_tr_b16 v[40:41], v11 offset:26624
  ds_read_b64_tr_b16 v[42:43], v11 offset:27136
  s_waitcnt lgkmcnt(10)
  v_mfma_f32_32x32x16_bf16 v[80:95], v[48:51], v[200:203], v[80:95]
  ds_read_b64_tr_b16 v[44:45], v11 offset:26880
  ds_read_b64_tr_b16 v[46:47], v11 offset:27392
  s_waitcnt lgkmcnt(10)
  v_mfma_f32_32x32x16_bf16 v[64:79], v[52:55], v[204:207], v[64:79]
  ds_read_b64_tr_b16 v[48:49], v11 offset:36864
  ds_read_b64_tr_b16 v[50:51], v11 offset:37376
  s_waitcnt lgkmcnt(10)
  v_mfma_f32_32x32x16_bf16 v[80:95], v[56:59], v[204:207], v[80:95]
  ds_read_b64_tr_b16 v[52:53], v11 offset:37120
  ds_read_b64_tr_b16 v[54:55], v11 offset:37632
  s_add_u32 s94, s99, 4096
  buffer_store_dwordx4 v[112:115], v14, s[16:19], s94 offen offset:2048 sc1
  s_waitcnt lgkmcnt(10)
  v_mfma_f32_32x32x16_bf16 v[64:79], v[32:35], v[208:211], v[64:79]
  ds_read_b64_tr_b16 v[56:57], v11 offset:38912
  ds_read_b64_tr_b16 v[58:59], v11 offset:39424
  s_waitcnt lgkmcnt(10)
  v_mfma_f32_32x32x16_bf16 v[80:95], v[36:39], v[208:211], v[80:95]
  ds_read_b64_tr_b16 v[32:33], v11 offset:39168
  ds_read_b64_tr_b16 v[34:35], v11 offset:39680
  s_waitcnt lgkmcnt(10)
  v_mfma_f32_32x32x16_bf16 v[64:79], v[40:43], v[212:215], v[64:79]
  ds_read_b64_tr_b16 v[36:37], v11 offset:49152
  ds_read_b64_tr_b16 v[38:39], v11 offset:49664
  s_waitcnt lgkmcnt(10)
  v_mfma_f32_32x32x16_bf16 v[80:95], v[44:47], v[212:215], v[80:95]
  ds_read_b64_tr_b16 v[40:41], v11 offset:49408
  ds_read_b64_tr_b16 v[42:43], v11 offset:49920
  s_waitcnt lgkmcnt(10)
  v_mfma_f32_32x32x16_bf16 v[64:79], v[48:51], v[216:219], v[64:79]
  ds_read_b64_tr_b16 v[44:45], v11 offset:51200
  ds_read_b64_tr_b16 v[46:47], v11 offset:51712
  s_waitcnt lgkmcnt(10)
  v_mfma_f32_32x32x16_bf16 v[80:95], v[52:55], v[216:219], v[80:95]
  ds_read_b64_tr_b16 v[48:49], v11 offset:51456
  ds_read_b64_tr_b16 v[50:51], v11 offset:51968
  s_add_u32 s94, s99, 4096
  buffer_store_dwordx4 v[116:119], v14, s[16:19], s94 offen offset:3072 sc1
  s_waitcnt lgkmcnt(10)
  v_mfma_f32_32x32x16_bf16 v[64:79], v[56:59], v[220:223], v[64:79]
  ds_read_b64_tr_b16 v[52:53], v11 offset:61440
  ds_read_b64_tr_b16 v[54:55], v11 offset:61952
  s_waitcnt lgkmcnt(10)
  v_mfma_f32_32x32x16_bf16 v[80:95], v[32:35], v[220:223], v[80:95]
  ds_read_b64_tr_b16 v[56:57], v11 offset:61696
  ds_read_b64_tr_b16 v[58:59], v11 offset:62208
  s_waitcnt lgkmcnt(10)
  v_mfma_f32_32x32x16_bf16 v[64:79], v[36:39], v[224:227], v[64:79]
  ds_read_b64_tr_b16 v[32:33], v11 offset:63488
  ds_read_b64_tr_b16 v[34:35], v11 offset:64000
  s_waitcnt lgkmcnt(10)
  v_mfma_f32_32x32x16_bf16 v[80:95], v[40:43], v[224:227], v[80:95]
  ds_read_b64_tr_b16 v[36:37], v11 offset:63744
  ds_read_b64_tr_b16 v[38:39], v11 offset:64256
  s_waitcnt lgkmcnt(10)
  v_mfma_f32_32x32x16_bf16 v[64:79], v[44:47], v[228:231], v[64:79]
  ds_read_b64_tr_b16 v[40:41], v12 offset:8192
  ds_read_b64_tr_b16 v[42:43], v12 offset:8704
  s_waitcnt lgkmcnt(10)
  v_mfma_f32_32x32x16_bf16 v[80:95], v[48:51], v[228:231], v[80:95]
  ds_read_b64_tr_b16 v[44:45], v12 offset:8448
  ds_read_b64_tr_b16 v[46:47], v12 offset:8960
  s_waitcnt lgkmcnt(10)
  v_mfma_f32_32x32x16_bf16 v[64:79], v[52:55], v[232:235], v[64:79]
  ds_read_b64_tr_b16 v[48:49], v12 offset:10240
  ds_read_b64_tr_b16 v[50:51], v12 offset:10752
  s_waitcnt lgkmcnt(10)
  v_mfma_f32_32x32x16_bf16 v[80:95], v[56:59], v[232:235], v[80:95]
  ds_read_b64_tr_b16 v[52:53], v12 offset:10496
  ds_read_b64_tr_b16 v[54:55], v12 offset:11008
  s_waitcnt lgkmcnt(10)
  v_mfma_f32_32x32x16_bf16 v[64:79], v[32:35], v[236:239], v[64:79]
  ds_read_b64_tr_b16 v[56:57], v12 offset:20480
  ds_read_b64_tr_b16 v[58:59], v12 offset:20992
  s_waitcnt lgkmcnt(10)
  v_mfma_f32_32x32x16_bf16 v[80:95], v[36:39], v[236:239], v[80:95]
  ds_read_b64_tr_b16 v[32:33], v12 offset:20736
  ds_read_b64_tr_b16 v[34:35], v12 offset:21248
  s_waitcnt lgkmcnt(10)
  v_mfma_f32_32x32x16_bf16 v[64:79], v[40:43], v[240:243], v[64:79]
  ds_read_b64_tr_b16 v[36:37], v12 offset:22528
  ds_read_b64_tr_b16 v[38:39], v12 offset:23040
  s_waitcnt lgkmcnt(10)
  v_mfma_f32_32x32x16_bf16 v[80:95], v[44:47], v[240:243], v[80:95]
  ds_read_b64_tr_b16 v[40:41], v12 offset:22784
  ds_read_b64_tr_b16 v[42:43], v12 offset:23296
  s_waitcnt lgkmcnt(10)
  v_mfma_f32_32x32x16_bf16 v[64:79], v[48:51], v[244:247], v[64:79]
  s_waitcnt lgkmcnt(8)
  v_mfma_f32_32x32x16_bf16 v[80:95], v[52:55], v[244:247], v[80:95]
  s_waitcnt lgkmcnt(6)
  v_mfma_f32_32x32x16_bf16 v[64:79], v[56:59], v[248:251], v[64:79]
  s_waitcnt vmcnt(17)
  s_barrier
  ds_read_b64_tr_b16 v[44:45], v11 offset:4096
  ds_read_b64_tr_b16 v[46:47], v11 offset:4608
  ds_read_b64_tr_b16 v[48:49], v11 offset:4352
  ds_read_b64_tr_b16 v[50:51], v11 offset:4864
  ds_read_b64_tr_b16 v[52:53], v11 offset:6144
  ds_read_b64_tr_b16 v[54:55], v11 offset:6656
  s_waitcnt lgkmcnt(10)
  v_mfma_f32_32x32x16_bf16 v[80:95], v[32:35], v[248:251], v[80:95]
  ds_read_b64_tr_b16 v[56:57], v11 offset:6400
  ds_read_b64_tr_b16 v[58:59], v11 offset:6912
  s_waitcnt lgkmcnt(10)
  v_mfma_f32_32x32x16_bf16 v[64:79], v[36:39], v[252:255], v[64:79]
  ds_read_b64_tr_b16 v[32:33], v11 offset:16384
  ds_read_b64_tr_b16 v[34:35], v11 offset:16896
  s_waitcnt lgkmcnt(10)
  v_mfma_f32_32x32x16_bf16 v[80:95], v[40:43], v[252:255], v[80:95]
  ds_read_b64_tr_b16 v[36:37], v11 offset:16640
  ds_read_b64_tr_b16 v[38:39], v11 offset:17152
  s_waitcnt lgkmcnt(10)
  v_mfma_f32_32x32x16_bf16 v[96:111], v[44:47], v[128:131], 0
  ds_read_b64_tr_b16 v[40:41], v11 offset:18432
  ds_read_b64_tr_b16 v[42:43], v11 offset:18944
  s_waitcnt lgkmcnt(10)
  v_mfma_f32_32x32x16_bf16 v[112:127], v[48:51], v[128:131], 0
  ds_read_b64_tr_b16 v[44:45], v11 offset:18688
  ds_read_b64_tr_b16 v[46:47], v11 offset:19200
  s_waitcnt lgkmcnt(10)
  v_mfma_f32_32x32x16_bf16 v[96:111], v[52:55], v[132:135], v[96:111]
  ds_read_b64_tr_b16 v[48:49], v11 offset:28672
  ds_read_b64_tr_b16 v[50:51], v11 offset:29184
  v_cvt_pk_bf16_f32 v64, v64, v65
  v_cvt_pk_bf16_f32 v65, v66, v67
  v_cvt_pk_bf16_f32 v66, v68, v69
  v_cvt_pk_bf16_f32 v67, v70, v71
  s_waitcnt lgkmcnt(10)
  v_mfma_f32_32x32x16_bf16 v[112:127], v[56:59], v[132:135], v[112:127]
  ds_read_b64_tr_b16 v[52:53], v11 offset:28928
  ds_read_b64_tr_b16 v[54:55], v11 offset:29440
  v_cvt_pk_bf16_f32 v68, v72, v73
  v_cvt_pk_bf16_f32 v69, v74, v75
  v_cvt_pk_bf16_f32 v70, v76, v77
  v_cvt_pk_bf16_f32 v71, v78, v79
  s_waitcnt lgkmcnt(10)
  v_mfma_f32_32x32x16_bf16 v[96:111], v[32:35], v[136:139], v[96:111]
  ds_read_b64_tr_b16 v[56:57], v11 offset:30720
  ds_read_b64_tr_b16 v[58:59], v11 offset:31232
  v_cvt_pk_bf16_f32 v72, v80, v81
  v_cvt_pk_bf16_f32 v73, v82, v83
  v_cvt_pk_bf16_f32 v74, v84, v85
  v_cvt_pk_bf16_f32 v75, v86, v87
  s_waitcnt lgkmcnt(10)
  v_mfma_f32_32x32x16_bf16 v[112:127], v[36:39], v[136:139], v[112:127]
  ds_read_b64_tr_b16 v[32:33], v11 offset:30976
  ds_read_b64_tr_b16 v[34:35], v11 offset:31488
  v_cvt_pk_bf16_f32 v76, v88, v89
  v_cvt_pk_bf16_f32 v77, v90, v91
  v_cvt_pk_bf16_f32 v78, v92, v93
  v_cvt_pk_bf16_f32 v79, v94, v95
  s_waitcnt lgkmcnt(10)
  v_mfma_f32_32x32x16_bf16 v[96:111], v[40:43], v[140:143], v[96:111]
  ds_read_b64_tr_b16 v[36:37], v11 offset:40960
  ds_read_b64_tr_b16 v[38:39], v11 offset:41472
  s_waitcnt lgkmcnt(10)
  v_mfma_f32_32x32x16_bf16 v[112:127], v[44:47], v[140:143], v[112:127]
  ds_read_b64_tr_b16 v[40:41], v11 offset:41216
  ds_read_b64_tr_b16 v[42:43], v11 offset:41728
  s_add_u32 s94, s89, 0
  buffer_store_dwordx4 v[64:67], v14, s[16:19], s94 offen offset:0 sc1
  s_waitcnt lgkmcnt(10)
  v_mfma_f32_32x32x16_bf16 v[96:111], v[48:51], v[144:147], v[96:111]
  ds_read_b64_tr_b16 v[44:45], v11 offset:43008
  ds_read_b64_tr_b16 v[46:47], v11 offset:43520
  buffer_load_dword v17, v18, s[68:71], 0 offen sc1
  s_waitcnt lgkmcnt(10)
  v_mfma_f32_32x32x16_bf16 v[112:127], v[52:55], v[144:147], v[112:127]
  ds_read_b64_tr_b16 v[48:49], v11 offset:43264
  ds_read_b64_tr_b16 v[50:51], v11 offset:43776
  s_waitcnt lgkmcnt(10)
  v_mfma_f32_32x32x16_bf16 v[96:111], v[56:59], v[148:151], v[96:111]
  ds_read_b64_tr_b16 v[52:53], v11 offset:53248
  ds_read_b64_tr_b16 v[54:55], v11 offset:53760
  s_waitcnt lgkmcnt(10)
  v_mfma_f32_32x32x16_bf16 v[112:127], v[32:35], v[148:151], v[112:127]
  ds_read_b64_tr_b16 v[56:57], v11 offset:53504
  ds_read_b64_tr_b16 v[58:59], v11 offset:54016
  s_waitcnt lgkmcnt(10)
  v_mfma_f32_32x32x16_bf16 v[96:111], v[36:39], v[152:155], v[96:111]
  ds_read_b64_tr_b16 v[32:33], v11 offset:55296
  ds_read_b64_tr_b16 v[34:35], v11 offset:55808
  s_waitcnt lgkmcnt(10)
  v_mfma_f32_32x32x16_bf16 v[112:127], v[40:43], v[152:155], v[112:127]
  ds_read_b64_tr_b16 v[36:37], v11 offset:55552
  ds_read_b64_tr_b16 v[38:39], v11 offset:56064
  s_waitcnt lgkmcnt(10)
  v_mfma_f32_32x32x16_bf16 v[96:111], v[44:47], v[156:159], v[96:111]
  ds_read_b64_tr_b16 v[40:41], v12 offset:0
  ds_read_b64_tr_b16 v[42:43], v12 offset:512
  s_waitcnt lgkmcnt(10)
  v_mfma_f32_32x32x16_bf16 v[112:127], v[48:51], v[156:159], v[112:127]
  ds_read_b64_tr_b16 v[44:45], v12 offset:256
  ds_read_b64_tr_b16 v[46:47], v12 offset:768
  s_waitcnt lgkmcnt(10)
  v_mfma_f32_32x32x16_bf16 v[96:111], v[52:55], v[160:163], v[96:111]
  ds_read_b64_tr_b16 v[48:49], v12 offset:2048
  ds_read_b64_tr_b16 v[50:51], v12 offset:2560
  s_waitcnt lgkmcnt(10)
  v_mfma_f32_32x32x16_bf16 v[112:127], v[56:59], v[160:163], v[112:127]
  ds_read_b64_tr_b16 v[52:53], v12 offset:2304
  ds_read_b64_tr_b16 v[54:55], v12 offset:2816
  s_waitcnt lgkmcnt(10)
  v_mfma_f32_32x32x16_bf16 v[96:111], v[32:35], v[164:167], v[96:111]
  ds_read_b64_tr_b16 v[56:57], v12 offset:12288
  ds_read_b64_tr_b16 v[58:59], v12 offset:12800
  s_waitcnt lgkmcnt(10)
  v_mfma_f32_32x32x16_bf16 v[112:127], v[36:39], v[164:167], v[112:127]
  ds_read_b64_tr_b16 v[32:33], v12 offset:12544
  ds_read_b64_tr_b16 v[34:35], v12 offset:13056
  s_add_u32 s94, s89, 0
  buffer_store_dwordx4 v[68:71], v14, s[16:19], s94 offen offset:1024 sc1
  s_waitcnt lgkmcnt(10)
  v_mfma_f32_32x32x16_bf16 v[96:111], v[40:43], v[168:171], v[96:111]
  ds_read_b64_tr_b16 v[36:37], v12 offset:14336
  ds_read_b64_tr_b16 v[38:39], v12 offset:14848
  s_waitcnt lgkmcnt(10)
  v_mfma_f32_32x32x16_bf16 v[112:127], v[44:47], v[168:171], v[112:127]
  ds_read_b64_tr_b16 v[40:41], v12 offset:14592
  ds_read_b64_tr_b16 v[42:43], v12 offset:15104
  s_waitcnt lgkmcnt(10)
  v_mfma_f32_32x32x16_bf16 v[96:111], v[48:51], v[172:175], v[96:111]
  ds_read_b64_tr_b16 v[44:45], v12 offset:24576
  ds_read_b64_tr_b16 v[46:47], v12 offset:25088
  s_waitcnt lgkmcnt(10)
  v_mfma_f32_32x32x16_bf16 v[112:127], v[52:55], v[172:175], v[112:127]
  ds_read_b64_tr_b16 v[48:49], v12 offset:24832
  ds_read_b64_tr_b16 v[50:51], v12 offset:25344
  s_waitcnt lgkmcnt(10)
  v_mfma_f32_32x32x16_bf16 v[96:111], v[56:59], v[176:179], v[96:111]
  ds_read_b64_tr_b16 v[52:53], v12 offset:26624
  ds_read_b64_tr_b16 v[54:55], v12 offset:27136
  s_waitcnt lgkmcnt(10)
  v_mfma_f32_32x32x16_bf16 v[112:127], v[32:35], v[176:179], v[112:127]
  ds_read_b64_tr_b16 v[56:57], v12 offset:26880
  ds_read_b64_tr_b16 v[58:59], v12 offset:27392
  s_waitcnt lgkmcnt(10)
  v_mfma_f32_32x32x16_bf16 v[96:111], v[36:39], v[180:183], v[96:111]
  s_waitcnt lgkmcnt(8)
  v_mfma_f32_32x32x16_bf16 v[112:127], v[40:43], v[180:183], v[112:127]
  s_waitcnt lgkmcnt(6)
  v_mfma_f32_32x32x16_bf16 v[96:111], v[44:47], v[184:187], v[96:111]
  s_cmp_lg_u32 s3, 0
  s_cbranch_scc1 kva_kernel_hok_10
  s_waitcnt vmcnt(1)
  v_and_b32 v17, v17, v19
  v_cmp_ne_u32 vcc, v17, v19
  s_cbranch_vccnz kva_kernel_hsp_9
kva_kernel_hok_10:
  s_waitcnt vmcnt(6) lgkmcnt(0)
  s_barrier
  ds_read_b64_tr_b16 v[32:33], v13 offset:0
  ds_read_b64_tr_b16 v[34:35], v13 offset:512
  ds_read_b64_tr_b16 v[36:37], v13 offset:256
  ds_read_b64_tr_b16 v[38:39], v13 offset:768
  ds_read_b64_tr_b16 v[40:41], v13 offset:2048
  ds_read_b64_tr_b16 v[42:43], v13 offset:2560
  s_sub_u32 m0, s97, 65536
  s_mov_b32 s94, 0
  buffer_load_dwordx4 v4, s[76:79], s94 offen lds
  v_mfma_f32_32x32x16_bf16 v[112:127], v[48:51], v[184:187], v[112:127]
  ds_read_b64_tr_b16 v[44:45], v13 offset:2304
  ds_read_b64_tr_b16 v[46:47], v13 offset:2816
  s_sub_u32 m0, s97, 64512
  s_mov_b32 s94, 32768
  buffer_load_dwordx4 v4, s[76:79], s94 offen lds
  v_mfma_f32_32x32x16_bf16 v[96:111], v[52:55], v[188:191], v[96:111]
  ds_read_b64_tr_b16 v[48:49], v13 offset:4096
  ds_read_b64_tr_b16 v[50:51], v13 offset:4608
  s_add_u32 s94, s74, 0
  buffer_load_dwordx4 v[128:131], v14, s[44:47], s94 offen offset:0
  v_mfma_f32_32x32x16_bf16 v[112:127], v[56:59], v[188:191], v[112:127]
  ds_read_b64_tr_b16 v[52:53], v13 offset:4352
  ds_read_b64_tr_b16 v[54:55], v13 offset:4864
  s_add_u32 s94, s74, 0
  buffer_load_dwordx4 v[132:135], v14, s[44:47], s94 offen offset:1024
  s_add_u32 s94, s89, 0
  buffer_store_dwordx4 v[72:75], v14, s[16:19], s94 offen offset:2048 sc1
  s_waitcnt lgkmcnt(10)
  v_mfma_f32_32x32x16_bf16 v[96:111], v[32:35], v[192:195], v[96:111]
  ds_read_b64_tr_b16 v[56:57], v13 offset:6144
  ds_read_b64_tr_b16 v[58:59], v13 offset:6656
  s_add_u32 s94, s74, 0
  buffer_load_dwordx4 v[136:139], v14, s[44:47], s94 offen offset:2048
  s_waitcnt lgkmcnt(10)
  v_mfma_f32_32x32x16_bf16 v[112:127], v[36:39], v[192:195], v[112:127]
  ds_read_b64_tr_b16 v[32:33], v13 offset:6400
  ds_read_b64_tr_b16 v[34:35], v13 offset:6912
  s_add_u32 s94, s74, 0
  buffer_load_dwordx4 v[140:143], v14, s[44:47], s94 offen offset:3072
  s_waitcnt lgkmcnt(10)
  v_mfma_f32_32x32x16_bf16 v[96:111], v[40:43], v[196:199], v[96:111]
  ds_read_b64_tr_b16 v[36:37], v13 offset:8192
  ds_read_b64_tr_b16 v[38:39], v13 offset:8704
  s_sub_u32 m0, s97, 49152
  s_mov_b32 s94, 524288
  buffer_load_dwordx4 v4, s[76:79], s94 offen lds
  s_waitcnt lgkmcnt(10)
  v_mfma_f32_32x32x16_bf16 v[112:127], v[44:47], v[196:199], v[112:127]
  ds_read_b64_tr_b16 v[40:41], v13 offset:8448
  ds_read_b64_tr_b16 v[42:43], v13 offset:8960
  s_sub_u32 m0, s97, 48128
  s_mov_b32 s94, 557056
  buffer_load_dwordx4 v4, s[76:79], s94 offen lds
  s_waitcnt lgkmcnt(10)
  v_mfma_f32_32x32x16_bf16 v[96:111], v[48:51], v[200:203], v[96:111]
  ds_read_b64_tr_b16 v[44:45], v13 offset:10240
  ds_read_b64_tr_b16 v[46:47], v13 offset:10752
  s_add_u32 s94, s74, 4096
  buffer_load_dwordx4 v[144:147], v14, s[44:47], s94 offen offset:0
  s_waitcnt lgkmcnt(10)
  v_mfma_f32_32x32x16_bf16 v[112:127], v[52:55], v[200:203], v[112:127]
  ds_read_b64_tr_b16 v[48:49], v13 offset:10496
  ds_read_b64_tr_b16 v[50:51], v13 offset:11008
  s_add_u32 s94, s74, 4096
  buffer_load_dwordx4 v[148:151], v14, s[44:47], s94 offen offset:1024
  s_waitcnt lgkmcnt(10)
  v_mfma_f32_32x32x16_bf16 v[96:111], v[56:59], v[204:207], v[96:111]
  ds_read_b64_tr_b16 v[52:53], v13 offset:12288
  ds_read_b64_tr_b16 v[54:55], v13 offset:12800
  s_add_u32 s94, s74, 4096
  buffer_load_dwordx4 v[152:155], v14, s[44:47], s94 offen offset:2048
  s_waitcnt lgkmcnt(10)
  v_mfma_f32_32x32x16_bf16 v[112:127], v[32:35], v[204:207], v[112:127]
  ds_read_b64_tr_b16 v[56:57], v13 offset:12544
  ds_read_b64_tr_b16 v[58:59], v13 offset:13056
  s_add_u32 s94, s74, 4096
  buffer_load_dwordx4 v[156:159], v14, s[44:47], s94 offen offset:3072
  s_waitcnt lgkmcnt(10)
  v_mfma_f32_32x32x16_bf16 v[96:111], v[36:39], v[208:211], v[96:111]
  ds_read_b64_tr_b16 v[32:33], v13 offset:14336
  ds_read_b64_tr_b16 v[34:35], v13 offset:14848
  s_sub_u32 m0, s97, 32768
  s_mov_b32 s94, 1048576
  buffer_load_dwordx4 v4, s[76:79], s94 offen lds
  s_waitcnt lgkmcnt(10)
  v_mfma_f32_32x32x16_bf16 v[112:127], v[40:43], v[208:211], v[112:127]
  ds_read_b64_tr_b16 v[36:37], v13 offset:14592
  ds_read_b64_tr_b16 v[38:39], v13 offset:15104
  s_sub_u32 m0, s97, 31744
  s_mov_b32 s94, 1081344
  buffer_load_dwordx4 v4, s[76:79], s94 offen lds
  s_waitcnt lgkmcnt(10)
  v_mfma_f32_32x32x16_bf16 v[96:111], v[44:47], v[212:215], v[96:111]
  ds_read_b64_tr_b16 v[40:41], v13 offset:16384
  ds_read_b64_tr_b16 v[42:43], v13 offset:16896
  s_add_u32 s94, s74, 8192
  buffer_load_dwordx4 v[160:163], v14, s[44:47], s94 offen offset:0
  s_waitcnt lgkmcnt(10)
  v_mfma_f32_32x32x16_bf16 v[112:127], v[48:51], v[212:215], v[112:127]
  ds_read_b64_tr_b16 v[44:45], v13 offset:16640
  ds_read_b64_tr_b16 v[46:47], v13 offset:17152
  s_add_u32 s94, s74, 8192
  buffer_load_dwordx4 v[164:167], v14, s[44:47], s94 offen offset:1024
  s_add_u32 s94, s89, 0
  buffer_store_dwordx4 v[76:79], v14, s[16:19], s94 offen offset:3072 sc1
  s_waitcnt lgkmcnt(10)
  v_mfma_f32_32x32x16_bf16 v[96:111], v[52:55], v[216:219], v[96:111]
  ds_read_b64_tr_b16 v[48:49], v13 offset:18432
  ds_read_b64_tr_b16 v[50:51], v13 offset:18944
  s_add_u32 s94, s74, 8192
  buffer_load_dwordx4 v[168:171], v14, s[44:47], s94 offen offset:2048
  s_waitcnt lgkmcnt(10)
  v_mfma_f32_32x32x16_bf16 v[112:127], v[56:59], v[216:219], v[112:127]
  ds_read_b64_tr_b16 v[52:53], v13 offset:18688
  ds_read_b64_tr_b16 v[54:55], v13 offset:19200
  s_add_u32 s94, s74, 8192
  buffer_load_dwordx4 v[172:175], v14, s[44:47], s94 offen offset:3072
  s_waitcnt lgkmcnt(10)
  v_mfma_f32_32x32x16_bf16 v[96:111], v[32:35], v[220:223], v[96:111]
  ds_read_b64_tr_b16 v[56:57], v13 offset:20480
  ds_read_b64_tr_b16 v[58:59], v13 offset:20992
  s_waitcnt lgkmcnt(10)
  v_mfma_f32_32x32x16_bf16 v[112:127], v[36:39], v[220:223], v[112:127]
  ds_read_b64_tr_b16 v[32:33], v13 offset:20736
  ds_read_b64_tr_b16 v[34:35], v13 offset:21248
  s_waitcnt lgkmcnt(10)
  v_mfma_f32_32x32x16_bf16 v[96:111], v[40:43], v[224:227], v[96:111]
  ds_read_b64_tr_b16 v[36:37], v13 offset:22528
  ds_read_b64_tr_b16 v[38:39], v13 offset:23040
  s_waitcnt lgkmcnt(10)
  v_mfma_f32_32x32x16_bf16 v[112:127], v[44:47], v[224:227], v[112:127]
  ds_read_b64_tr_b16 v[40:41], v13 offset:22784
  ds_read_b64_tr_b16 v[42:43], v13 offset:23296
  s_waitcnt lgkmcnt(10)
  v_mfma_f32_32x32x16_bf16 v[96:111], v[48:51], v[228:231], v[96:111]
  ds_read_b64_tr_b16 v[44:45], v13 offset:24576
  ds_read_b64_tr_b16 v[46:47], v13 offset:25088
  s_waitcnt lgkmcnt(10)
  v_mfma_f32_32x32x16_bf16 v[112:127], v[52:55], v[228:231], v[112:127]
  ds_read_b64_tr_b16 v[48:49], v13 offset:24832
  ds_read_b64_tr_b16 v[50:51], v13 offset:25344
  s_waitcnt lgkmcnt(10)
  v_mfma_f32_32x32x16_bf16 v[96:111], v[56:59], v[232:235], v[96:111]
  ds_read_b64_tr_b16 v[52:53], v13 offset:26624
  ds_read_b64_tr_b16 v[54:55], v13 offset:27136
  s_waitcnt lgkmcnt(10)
  v_mfma_f32_32x32x16_bf16 v[112:127], v[32:35], v[232:235], v[112:127]
  ds_read_b64_tr_b16 v[56:57], v13 offset:26880
  ds_read_b64_tr_b16 v[58:59], v13 offset:27392
  s_waitcnt lgkmcnt(10)
  v_mfma_f32_32x32x16_bf16 v[96:111], v[36:39], v[236:239], v[96:111]
  ds_read_b64_tr_b16 v[32:33], v13 offset:28672
  ds_read_b64_tr_b16 v[34:35], v13 offset:29184
  s_waitcnt lgkmcnt(10)
  v_mfma_f32_32x32x16_bf16 v[112:127], v[40:43], v[236:239], v[112:127]
  ds_read_b64_tr_b16 v[36:37], v13 offset:28928
  ds_read_b64_tr_b16 v[38:39], v13 offset:29440
  s_waitcnt lgkmcnt(10)
  v_mfma_f32_32x32x16_bf16 v[96:111], v[44:47], v[240:243], v[96:111]
  ds_read_b64_tr_b16 v[40:41], v13 offset:30720
  ds_read_b64_tr_b16 v[42:43], v13 offset:31232
  s_waitcnt lgkmcnt(10)
  v_mfma_f32_32x32x16_bf16 v[112:127], v[48:51], v[240:243], v[112:127]
  ds_read_b64_tr_b16 v[44:45], v13 offset:30976
  ds_read_b64_tr_b16 v[46:47], v13 offset:31488
  s_waitcnt lgkmcnt(10)
  v_mfma_f32_32x32x16_bf16 v[96:111], v[52:55], v[244:247], v[96:111]
  s_waitcnt lgkmcnt(8)
  v_mfma_f32_32x32x16_bf16 v[112:127], v[56:59], v[244:247], v[112:127]
  s_waitcnt lgkmcnt(6)
  v_mfma_f32_32x32x16_bf16 v[96:111], v[32:35], v[248:251], v[96:111]
  s_waitcnt lgkmcnt(4)
  v_mfma_f32_32x32x16_bf16 v[112:127], v[36:39], v[248:251], v[112:127]
  s_waitcnt lgkmcnt(2)
  v_mfma_f32_32x32x16_bf16 v[96:111], v[40:43], v[252:255], v[96:111]
  s_waitcnt lgkmcnt(0)
  v_mfma_f32_32x32x16_bf16 v[112:127], v[44:47], v[252:255], v[112:127]
  s_nop 9
  v_cvt_pk_bf16_f32 v96, v96, v97
  v_cvt_pk_bf16_f32 v97, v98, v99
  v_cvt_pk_bf16_f32 v98, v100, v101
  v_cvt_pk_bf16_f32 v99, v102, v103
  v_cvt_pk_bf16_f32 v100, v104, v105
  v_cvt_pk_bf16_f32 v101, v106, v107
  v_cvt_pk_bf16_f32 v102, v108, v109
  v_cvt_pk_bf16_f32 v103, v110, v111
  s_add_u32 s94, s89, 4096
  buffer_store_dwordx4 v[96:99], v14, s[16:19], s94 offen offset:0 sc1
  s_add_u32 s94, s89, 4096
  buffer_store_dwordx4 v[100:103], v14, s[16:19], s94 offen offset:1024 sc1
  v_cvt_pk_bf16_f32 v112, v112, v113
  v_cvt_pk_bf16_f32 v113, v114, v115
  v_cvt_pk_bf16_f32 v114, v116, v117
  v_cvt_pk_bf16_f32 v115, v118, v119
  v_cvt_pk_bf16_f32 v116, v120, v121
  v_cvt_pk_bf16_f32 v117, v122, v123
  v_cvt_pk_bf16_f32 v118, v124, v125
  v_cvt_pk_bf16_f32 v119, v126, v127
  s_add_u32 s94, s89, 4096
  buffer_store_dwordx4 v[112:115], v14, s[16:19], s94 offen offset:2048 sc1
  s_add_u32 s94, s89, 4096
  buffer_store_dwordx4 v[116:119], v14, s[16:19], s94 offen offset:3072 sc1
  s_branch kva_kernel_att_1
kva_kernel_V_4:
  s_add_u32 m0, s97, 0
  s_mov_b32 s94, 0
  buffer_load_dwordx4 v4, s[12:15], s94 offen lds
  s_add_u32 m0, s97, 1024
  s_mov_b32 s94, 32768
  buffer_load_dwordx4 v4, s[12:15], s94 offen lds
  s_add_u32 m0, s96, 4096
  s_mov_b32 s94, 128
  buffer_load_dwordx4 v2, s[4:7], s94 offen lds
  s_add_u32 m0, s96, 5120
  s_mov_b32 s94, 8320
  buffer_load_dwordx4 v3, s[4:7], s94 offen lds
  s_add_u32 m0, s96, 6144
  s_mov_b32 s94, 16512
  buffer_load_dwordx4 v2, s[4:7], s94 offen lds
  s_add_u32 m0, s96, 7168
  s_mov_b32 s94, 24704
  buffer_load_dwordx4 v3, s[4:7], s94 offen lds
  s_add_u32 m0, s97, 16384
  s_mov_b32 s94, 524288
  buffer_load_dwordx4 v4, s[12:15], s94 offen lds
  s_add_u32 m0, s97, 17408
  s_mov_b32 s94, 557056
  buffer_load_dwordx4 v4, s[12:15], s94 offen lds
  s_lshl_b32 s94, s72, 3
  s_add_u32 s94, s94, s3
  s_mul_i32 s100, s94, 1280
  v_mov_b32 v63, s72
  v_cmp_eq_u32 vcc, 0, v0
  s_nop 1
  v_cndmask_b32 v60, 2.0, v63, vcc
  v_and_b32 v63, 3, v0
  v_lshlrev_b32 v63, 2, v63
  v_mov_b32 v61, 0x010101
  v_lshrrev_b32 v63, v63, v61
  v_and_b32 v63, 0x01010101, v63
  s_mov_b32 s68, s36
  s_mov_b32 s69, s37
  s_mov_b32 s70, s38
  s_mov_b32 s71, s39
  v_lshlrev_b32 v15, 2, v0
  s_lshr_b32 s101, s94, 5
  s_mul_i32 s101, s101, 40960
  s_and_b32 s94, s94, 31
  s_lshl_b32 s94, s94, 4
  s_add_u32 s101, s101, s94
  v_lshrrev_b32 v252, 3, v22
  v_lshlrev_b32 v252, 6, v252
  v_lshl_add_u32 v252, v23, 5, v252
  v_add_u32 v252, 147456, v252
  v_lshrrev_b32 v22, 5, v0
  v_bfe_u32 v23, v0, 1, 3
  v_xor_b32 v23, v23, v22
  v_and_b32 v6, 31, v0
  v_lshlrev_b32 v6, 7, v6
  v_lshl_add_u32 v6, v23, 4, v6
  v_xor_b32 v7, 32, v6
  v_xor_b32 v8, 64, v6
  v_xor_b32 v9, 96, v6
  v_add_u32 v6, s96, v6
  v_add_u32 v7, s96, v7
  v_add_u32 v8, s96, v8
  v_add_u32 v9, s96, v9
  v_bfe_u32 v23, v0, 4, 1
  v_lshl_add_u32 v5, v22, 2, v1
  v_lshlrev_b32 v5, 13, v5
  v_lshl_add_u32 v5, v23, 6, v5
  v_lshl_add_u32 v5, v10, 4, v5
  s_lshl_b32 s94, s88, 8
  v_add_u32 v5, s94, v5
  s_lshl_b32 s98, s3, 18
  v_lshlrev_b32 v10, 3, v10
  v_lshl_add_u32 v10, v1, 6, v10
  v_lshl_add_u32 v10, v23, 5, v10
  v_lshl_add_u32 v11, v22, 10, v10
  v_lshl_add_u32 v10, v22, 11, v10
  v_add_u32 v10, 98304, v10
  v_add_u32 v12, 0x10000, v11
  v_add_u32 v13, 0x20000, v11
  v_lshlrev_b32 v14, 4, v0
  s_lshl_b32 s99, s92, 3
  s_add_u32 s99, s99, s3
  s_lshl_b32 s99, s99, 13
  s_lshl_b32 s94, s88, 19
  s_add_u32 s89, s99, s94
  s_lshl_b32 s94, s93, 19
  s_add_u32 s99, s99, s94
  s_lshl_b32 s94, s90, 6
  s_add_u32 s52, s52, s94
  s_addc_u32 s53, s53, 0
  s_lshl_b32 s94, s90, 5
  s_add_u32 s84, s84, s94
  s_addc_u32 s85, s85, 0
  s_cmp_lt_u32 s2, 80
  s_cselect_b32 s58, 256, 0
  s_cselect_b32 s86, 32, 0
  s_cmp_eq_u32 s3, 0
  s_cselect_b32 s54, s54, 0
  s_cselect_b32 s58, s58, 0
  s_cselect_b32 s86, s86, 0
  s_cmp_lt_u32 s90, 40
  s_cselect_b32 s91, 0, 1.0
  v_lshrrev_b32 v253, 4, v0
  v_lshlrev_b32 v253, 9, v253
  v_and_b32 v249, 15, v0
  v_lshl_add_u32 v253, v249, 2, v253
  v_add_u32 v253, 147456, v253
  v_lshlrev_b32 v254, 1, v0
  s_cmp_ge_u32 s2, 80
  s_cbranch_scc1 kva_kernel_noearly2_11
  s_waitcnt vmcnt(12)
  s_mov_b32 s95, 1069066811
  v_lshlrev_b32 v224, 16, v224
  v_mul_f32 v248, s95, v224
  v_exp_f32 v248, -v248
  s_nop 0
  v_add_f32 v248, 1.0, v248
  v_rcp_f32 v248, v248
  s_nop 0
  v_mul_f32 v224, v224, v248
  v_cvt_pk_bf16_f32 v224, v224, v224
  v_lshlrev_b32 v224, 16, v224
  v_lshlrev_b32 v225, 16, v225
  v_mul_f32 v249, s95, v225
  v_exp_f32 v249, -v249
  s_nop 0
  v_add_f32 v249, 1.0, v249
  v_rcp_f32 v249, v249
  s_nop 0
  v_mul_f32 v225, v225, v249
  v_cvt_pk_bf16_f32 v225, v225, v225
  v_lshlrev_b32 v225, 16, v225
  v_lshlrev_b32 v226, 16, v226
  v_mul_f32 v248, s95, v226
  v_exp_f32 v248, -v248
  s_nop 0
  v_add_f32 v248, 1.0, v248
  v_rcp_f32 v248, v248
  s_nop 0
  v_mul_f32 v226, v226, v248
  v_cvt_pk_bf16_f32 v226, v226, v226
  v_lshlrev_b32 v226, 16, v226
  s_waitcnt vmcnt(17)
  v_lshlrev_b32 v248, 16, v228
  v_and_b32 v249, 0xffff0000, v228
  v_mul_f32 v240, v248, v224
  v_mul_f32 v241, v249, v224
  v_lshlrev_b32 v248, 16, v229
  v_and_b32 v249, 0xffff0000, v229
  v_mul_f32 v242, v248, v224
  v_mul_f32 v243, v249, v224
  v_lshlrev_b32 v248, 16, v230
  v_and_b32 v249, 0xffff0000, v230
  v_mul_f32 v244, v248, v224
  v_mul_f32 v245, v249, v224
  v_lshlrev_b32 v248, 16, v231
  v_and_b32 v249, 0xffff0000, v231
  v_mul_f32 v246, v248, v224
  v_mul_f32 v247, v249, v224
  s_waitcnt vmcnt(16)
  v_lshlrev_b32 v248, 16, v232
  v_and_b32 v249, 0xffff0000, v232
  v_fmac_f32 v240, v248, v225
  v_fmac_f32 v241, v249, v225
  v_lshlrev_b32 v248, 16, v233
  v_and_b32 v249, 0xffff0000, v233
  v_fmac_f32 v242, v248, v225
  v_fmac_f32 v243, v249, v225
  v_lshlrev_b32 v248, 16, v234
  v_and_b32 v249, 0xffff0000, v234
  v_fmac_f32 v244, v248, v225
  v_fmac_f32 v245, v249, v225
  v_lshlrev_b32 v248, 16, v235
  v_and_b32 v249, 0xffff0000, v235
  v_fmac_f32 v246, v248, v225
  v_fmac_f32 v247, v249, v225
  s_waitcnt vmcnt(15)
  v_lshlrev_b32 v248, 16, v236
  v_and_b32 v249, 0xffff0000, v236
  v_fmac_f32 v240, v248, v226
  v_fmac_f32 v241, v249, v226
  v_lshlrev_b32 v248, 16, v237
  v_and_b32 v249, 0xffff0000, v237
  v_fmac_f32 v242, v248, v226
  v_fmac_f32 v243, v249, v226
  v_lshlrev_b32 v248, 16, v238
  v_and_b32 v249, 0xffff0000, v238
  v_fmac_f32 v244, v248, v226
  v_fmac_f32 v245, v249, v226
  v_lshlrev_b32 v248, 16, v239
  v_and_b32 v249, 0xffff0000, v239
  v_fmac_f32 v246, v248, v226
  v_fmac_f32 v247, v249, v226
  v_add_f32_dpp v240, v240, v240 row_ror:2 row_mask:0xf bank_mask:0xf
  v_add_f32_dpp v241, v241, v241 row_ror:2 row_mask:0xf bank_mask:0xf
  v_add_f32_dpp v242, v242, v242 row_ror:2 row_mask:0xf bank_mask:0xf
  v_add_f32_dpp v243, v243, v243 row_ror:2 row_mask:0xf bank_mask:0xf
  v_add_f32_dpp v244, v244, v244 row_ror:2 row_mask:0xf bank_mask:0xf
  v_add_f32_dpp v245, v245, v245 row_ror:2 row_mask:0xf bank_mask:0xf
  v_add_f32_dpp v246, v246, v246 row_ror:2 row_mask:0xf bank_mask:0xf
  v_add_f32_dpp v247, v247, v247 row_ror:2 row_mask:0xf bank_mask:0xf
  v_add_f32_dpp v240, v240, v240 row_ror:4 row_mask:0xf bank_mask:0xf
  v_add_f32_dpp v241, v241, v241 row_ror:4 row_mask:0xf bank_mask:0xf
  v_add_f32_dpp v242, v242, v242 row_ror:4 row_mask:0xf bank_mask:0xf
  v_add_f32_dpp v243, v243, v243 row_ror:4 row_mask:0xf bank_mask:0xf
  v_add_f32_dpp v244, v244, v244 row_ror:4 row_mask:0xf bank_mask:0xf
  v_add_f32_dpp v245, v245, v245 row_ror:4 row_mask:0xf bank_mask:0xf
  v_add_f32_dpp v246, v246, v246 row_ror:4 row_mask:0xf bank_mask:0xf
  v_add_f32_dpp v247, v247, v247 row_ror:4 row_mask:0xf bank_mask:0xf
  v_add_f32_dpp v240, v240, v240 row_ror:8 row_mask:0xf bank_mask:0xf
  v_add_f32_dpp v241, v241, v241 row_ror:8 row_mask:0xf bank_mask:0xf
  v_add_f32_dpp v242, v242, v242 row_ror:8 row_mask:0xf bank_mask:0xf
  v_add_f32_dpp v243, v243, v243 row_ror:8 row_mask:0xf bank_mask:0xf
  v_add_f32_dpp v244, v244, v244 row_ror:8 row_mask:0xf bank_mask:0xf
  v_add_f32_dpp v245, v245, v245 row_ror:8 row_mask:0xf bank_mask:0xf
  v_add_f32_dpp v246, v246, v246 row_ror:8 row_mask:0xf bank_mask:0xf
  v_add_f32_dpp v247, v247, v247 row_ror:8 row_mask:0xf bank_mask:0xf
  ds_write_b128 v252, v[240:243]
  ds_write_b128 v252, v[244:247] offset:16
kva_kernel_noearly2_11:
  s_waitcnt vmcnt(6) lgkmcnt(0)
  s_barrier
  ds_read_b128 v[128:131], v6 offset:0
  ds_read_b128 v[132:135], v7 offset:0
  ds_read_b128 v[136:139], v8 offset:0
  ds_read_b128 v[140:143], v9 offset:0
  ds_read_b64_tr_b16 v[32:33], v10 offset:0
  ds_read_b64_tr_b16 v[34:35], v10 offset:1024
  ds_read_b64_tr_b16 v[36:37], v10 offset:256
  ds_read_b64_tr_b16 v[38:39], v10 offset:1280
  ds_read_b64_tr_b16 v[40:41], v10 offset:512
  ds_read_b64_tr_b16 v[42:43], v10 offset:1536
  ds_read_b64_tr_b16 v[44:45], v10 offset:768
  ds_read_b64_tr_b16 v[46:47], v10 offset:1792
  ds_read_b64_tr_b16 v[48:49], v10 offset:4096
  ds_read_b64_tr_b16 v[50:51], v10 offset:5120
  ds_read_b64_tr_b16 v[52:53], v10 offset:4352
  ds_read_b64_tr_b16 v[54:55], v10 offset:5376
  s_waitcnt lgkmcnt(10)
  v_mfma_f32_32x32x16_bf16 v[64:79], v[128:131], v[32:35], 0
  ds_read_b64_tr_b16 v[56:57], v10 offset:4608
  ds_read_b64_tr_b16 v[58:59], v10 offset:5632
  buffer_load_dword v16, v15, s[40:43], s100 offen offset:0
  buffer_load_dword v17, v15, s[40:43], s100 offen offset:256
  buffer_load_dword v18, v15, s[40:43], s100 offen offset:512
  buffer_load_dword v19, v15, s[40:43], s100 offen offset:768
  buffer_load_dword v20, v15, s[40:43], s100 offen offset:1024
  ds_read_b32 v240, v253 offset:0
  ds_read_b32 v241, v253 offset:64
  s_waitcnt lgkmcnt(12)
  v_mfma_f32_32x32x16_bf16 v[80:95], v[128:131], v[36:39], 0
  ds_read_b64_tr_b16 v[32:33], v10 offset:4864
  ds_read_b64_tr_b16 v[34:35], v10 offset:5888
  s_add_u32 m0, s97, 32768
  s_mov_b32 s94, 1048576
  buffer_load_dwordx4 v4, s[12:15], s94 offen lds
  ds_read_b32 v242, v253 offset:128
  ds_read_b32 v243, v253 offset:192
  s_waitcnt lgkmcnt(14)
  v_mfma_f32_32x32x16_bf16 v[96:111], v[128:131], v[40:43], 0
  ds_read_b64_tr_b16 v[36:37], v10 offset:8192
  ds_read_b64_tr_b16 v[38:39], v10 offset:9216
  s_add_u32 m0, s97, 33792
  s_mov_b32 s94, 1081344
  buffer_load_dwordx4 v4, s[12:15], s94 offen lds
  ds_read_b32 v244, v253 offset:256
  ds_read_b32 v245, v253 offset:320
  s_waitcnt lgkmcnt(15)
  v_mfma_f32_32x32x16_bf16 v[112:127], v[128:131], v[44:47], 0
  ds_read_b64_tr_b16 v[40:41], v10 offset:8448
  ds_read_b64_tr_b16 v[42:43], v10 offset:9472
  s_add_u32 m0, s96, 8192
  s_mov_b32 s94, 256
  buffer_load_dwordx4 v2, s[4:7], s94 offen lds
  ds_read_b32 v246, v253 offset:384
  ds_read_b32 v247, v253 offset:448
  s_waitcnt lgkmcnt(15)
  v_mfma_f32_32x32x16_bf16 v[64:79], v[132:135], v[48:51], v[64:79]
  ds_read_b64_tr_b16 v[44:45], v10 offset:8704
  ds_read_b64_tr_b16 v[46:47], v10 offset:9728
  s_add_u32 m0, s96, 9216
  s_mov_b32 s94, 8448
  buffer_load_dwordx4 v3, s[4:7], s94 offen lds
  v_mfma_f32_32x32x16_bf16 v[80:95], v[132:135], v[52:55], v[80:95]
  ds_read_b64_tr_b16 v[48:49], v10 offset:8960
  ds_read_b64_tr_b16 v[50:51], v10 offset:9984
  s_add_u32 m0, s96, 10240
  s_mov_b32 s94, 16640
  buffer_load_dwordx4 v2, s[4:7], s94 offen lds
  s_waitcnt lgkmcnt(4)
  v_add_f32 v240, v240, v241
  v_add_f32 v242, v242, v243
  v_mfma_f32_32x32x16_bf16 v[96:111], v[132:135], v[56:59], v[96:111]
  ds_read_b64_tr_b16 v[52:53], v10 offset:12288
  ds_read_b64_tr_b16 v[54:55], v10 offset:13312
  s_add_u32 m0, s96, 11264
  s_mov_b32 s94, 24832
  buffer_load_dwordx4 v3, s[4:7], s94 offen lds
  v_add_f32 v244, v244, v245
  v_add_f32 v246, v246, v247
  v_add_f32 v240, v240, v242
  v_add_f32 v244, v244, v246
  v_mfma_f32_32x32x16_bf16 v[112:127], v[132:135], v[32:35], v[112:127]
  ds_read_b64_tr_b16 v[56:57], v10 offset:12544
  ds_read_b64_tr_b16 v[58:59], v10 offset:13568
  s_add_u32 m0, s96, 0
  s_mov_b32 s94, 384
  buffer_load_dwordx4 v2, s[4:7], s94 offen lds
  v_add_f32 v240, v240, v244
  v_mov_b32 v241, v240
  s_nop 1
  v_permlane32_swap_b32 v240, v241
  v_add_f32 v240, v240, v241
  v_mfma_f32_32x32x16_bf16 v[64:79], v[136:139], v[36:39], v[64:79]
  ds_read_b64_tr_b16 v[32:33], v10 offset:12800
  ds_read_b64_tr_b16 v[34:35], v10 offset:13824
  s_add_u32 m0, s96, 1024
  s_mov_b32 s94, 8576
  buffer_load_dwordx4 v3, s[4:7], s94 offen lds
  v_mov_b32 v241, v240
  s_nop 1
  v_permlane16_swap_b32 v240, v241
  v_add_f32 v240, v240, v241
  v_cvt_pk_bf16_f32 v240, v240, v240
  v_mfma_f32_32x32x16_bf16 v[80:95], v[136:139], v[40:43], v[80:95]
  ds_read_b64_tr_b16 v[36:37], v10 offset:13056
  ds_read_b64_tr_b16 v[38:39], v10 offset:14080
  s_add_u32 m0, s96, 2048
  s_mov_b32 s94, 16768
  buffer_load_dwordx4 v2, s[4:7], s94 offen lds
  v_lshlrev_b32 v240, 16, v240
  v_add_f32 v241, s91, v240
  v_cvt_pk_bf16_f32 v241, v241, v241
  buffer_store_short v241, v254, s[84:87], 0 offen sc1
  s_lshl_b32 s94, s86, 1
  s_mov_b32 s91, s54
  s_mov_b32 s54, s94
  buffer_store_dword v240, v15, s[52:55], 0 offen
  s_sub_u32 s54, s91, s54
  s_waitcnt lgkmcnt(10)
  v_mfma_f32_32x32x16_bf16 v[96:111], v[136:139], v[44:47], v[96:111]
  s_add_u32 m0, s96, 3072
  s_mov_b32 s94, 24960
  buffer_load_dwordx4 v3, s[4:7], s94 offen lds
  s_waitcnt lgkmcnt(8)
  v_mfma_f32_32x32x16_bf16 v[112:127], v[136:139], v[48:51], v[112:127]
  s_waitcnt lgkmcnt(6)
  v_mfma_f32_32x32x16_bf16 v[64:79], v[140:143], v[52:55], v[64:79]
  s_waitcnt vmcnt(17) lgkmcnt(0)
  s_barrier
  ds_read_b128 v[144:147], v6 offset:4096
  ds_read_b128 v[148:151], v7 offset:4096
  ds_read_b128 v[152:155], v8 offset:4096
  ds_read_b128 v[156:159], v9 offset:4096
  ds_read_b64_tr_b16 v[40:41], v10 offset:16384
  ds_read_b64_tr_b16 v[42:43], v10 offset:17408
  ds_read_b64_tr_b16 v[44:45], v10 offset:16640
  ds_read_b64_tr_b16 v[46:47], v10 offset:17664
  ds_read_b64_tr_b16 v[48:49], v10 offset:16896
  ds_read_b64_tr_b16 v[50:51], v10 offset:17920
  s_mov_b32 s94, 0
  buffer_load_dwordx4 v[228:231], v250, s[28:31], s94 offen
  s_mov_b32 s94, 1966080
  buffer_load_dwordx4 v[232:235], v250, s[28:31], s94 offen
  s_mov_b32 s94, 3932160
  buffer_load_dwordx4 v[236:239], v250, s[28:31], s94 offen
  buffer_load_ushort v224, v251, s[24:27], 0 offen offset:0
  buffer_load_ushort v225, v251, s[24:27], 0 offen offset:512
  buffer_load_ushort v226, v251, s[24:27], 0 offen offset:1024
  v_mfma_f32_32x32x16_bf16 v[80:95], v[140:143], v[56:59], v[80:95]
  ds_read_b64_tr_b16 v[52:53], v10 offset:17152
  ds_read_b64_tr_b16 v[54:55], v10 offset:18176
  s_add_u32 m0, s97, 0
  s_mov_b32 s94, 1572864
  buffer_load_dwordx4 v4, s[12:15], s94 offen lds
  s_waitcnt vmcnt(19)
  v_lshlrev_b32 v208, 16, v16
  v_and_b32 v209, 0xffff0000, v16
  v_mfma_f32_32x32x16_bf16 v[96:111], v[140:143], v[32:35], v[96:111]
  ds_read_b64_tr_b16 v[56:57], v10 offset:20480
  ds_read_b64_tr_b16 v[58:59], v10 offset:21504
  s_add_u32 m0, s97, 1024
  s_mov_b32 s94, 1605632
  buffer_load_dwordx4 v4, s[12:15], s94 offen lds
  v_lshlrev_b32 v210, 16, v17
  v_and_b32 v211, 0xffff0000, v17
  v_lshlrev_b32 v212, 16, v18
  v_and_b32 v213, 0xffff0000, v18
  v_mfma_f32_32x32x16_bf16 v[112:127], v[140:143], v[36:39], v[112:127]
  ds_read_b64_tr_b16 v[32:33], v10 offset:20736
  ds_read_b64_tr_b16 v[34:35], v10 offset:21760
  v_lshlrev_b32 v214, 16, v19
  v_and_b32 v215, 0xffff0000, v19
  v_lshlrev_b32 v216, 16, v20
  v_and_b32 v217, 0xffff0000, v20
  s_waitcnt lgkmcnt(10)
  v_mfma_f32_32x32x16_bf16 v[64:79], v[144:147], v[40:43], v[64:79]
  ds_read_b64_tr_b16 v[36:37], v10 offset:20992
  ds_read_b64_tr_b16 v[38:39], v10 offset:22016
  s_add_u32 m0, s96, 4096
  s_mov_b32 s94, 512
  buffer_load_dwordx4 v2, s[4:7], s94 offen lds
  v_add_f32 v218, v208, v209
  v_add_f32 v219, v210, v211
  v_add_f32 v218, v218, v212
  v_add_f32 v219, v219, v213
  s_waitcnt lgkmcnt(10)
  v_mfma_f32_32x32x16_bf16 v[80:95], v[144:147], v[44:47], v[80:95]
  ds_read_b64_tr_b16 v[40:41], v10 offset:21248
  ds_read_b64_tr_b16 v[42:43], v10 offset:22272
  s_add_u32 m0, s96, 5120
  s_mov_b32 s94, 8704
  buffer_load_dwordx4 v3, s[4:7], s94 offen lds
  v_add_f32 v218, v218, v214
  v_add_f32 v219, v219, v215
  v_add_f32 v218, v218, v216
  v_add_f32 v219, v219, v217
  s_waitcnt lgkmcnt(10)
  v_mfma_f32_32x32x16_bf16 v[96:111], v[144:147], v[48:51], v[96:111]
  ds_read_b64_tr_b16 v[44:45], v10 offset:24576
  ds_read_b64_tr_b16 v[46:47], v10 offset:25600
  s_add_u32 m0, s96, 6144
  s_mov_b32 s94, 16896
  buffer_load_dwordx4 v2, s[4:7], s94 offen lds
  v_add_f32 v218, v218, v219
  s_nop 1
  v_add_f32_dpp v218, v218, v218 row_ror:1 row_mask:0xf bank_mask:0xf
  s_nop 1
  v_add_f32_dpp v218, v218, v218 row_ror:2 row_mask:0xf bank_mask:0xf
  s_nop 1
  v_add_f32_dpp v218, v218, v218 row_ror:4 row_mask:0xf bank_mask:0xf
  s_waitcnt lgkmcnt(10)
  v_mfma_f32_32x32x16_bf16 v[112:127], v[144:147], v[52:55], v[112:127]
  ds_read_b64_tr_b16 v[48:49], v10 offset:24832
  ds_read_b64_tr_b16 v[50:51], v10 offset:25856
  s_add_u32 m0, s96, 7168
  s_mov_b32 s94, 25088
  buffer_load_dwordx4 v3, s[4:7], s94 offen lds
  v_add_f32_dpp v218, v218, v218 row_ror:8 row_mask:0xf bank_mask:0xf
  v_mov_b32 v219, v218
  s_nop 1
  v_permlane32_swap_b32 v218, v219
  v_add_f32 v218, v218, v219
  s_waitcnt lgkmcnt(10)
  v_mfma_f32_32x32x16_bf16 v[64:79], v[148:151], v[56:59], v[64:79]
  ds_read_b64_tr_b16 v[52:53], v10 offset:25088
  ds_read_b64_tr_b16 v[54:55], v10 offset:26112
  v_mov_b32 v219, v218
  s_nop 1
  v_permlane16_swap_b32 v218, v219
  v_add_f32 v218, v218, v219
  v_mul_f32 v220, 0x3acccccd, v218
  s_waitcnt lgkmcnt(10)
  v_mfma_f32_32x32x16_bf16 v[80:95], v[148:151], v[32:35], v[80:95]
  ds_read_b64_tr_b16 v[56:57], v10 offset:25344
  ds_read_b64_tr_b16 v[58:59], v10 offset:26368
  v_sub_f32 v16, v208, v220
  v_mul_f32 v218, v16, v16
  v_sub_f32 v17, v209, v220
  v_mul_f32 v219, v17, v17
  s_waitcnt lgkmcnt(10)
  v_mfma_f32_32x32x16_bf16 v[96:111], v[148:151], v[36:39], v[96:111]
  ds_read_b64_tr_b16 v[32:33], v10 offset:28672
  ds_read_b64_tr_b16 v[34:35], v10 offset:29696
  v_sub_f32 v16, v210, v220
  v_fmac_f32 v218, v16, v16
  v_sub_f32 v17, v211, v220
  v_fmac_f32 v219, v17, v17
  s_waitcnt lgkmcnt(10)
  v_mfma_f32_32x32x16_bf16 v[112:127], v[148:151], v[40:43], v[112:127]
  ds_read_b64_tr_b16 v[36:37], v10 offset:28928
  ds_read_b64_tr_b16 v[38:39], v10 offset:29952
  v_sub_f32 v16, v212, v220
  v_fmac_f32 v218, v16, v16
  v_sub_f32 v17, v213, v220
  v_fmac_f32 v219, v17, v17
  s_waitcnt lgkmcnt(10)
  v_mfma_f32_32x32x16_bf16 v[64:79], v[152:155], v[44:47], v[64:79]
  ds_read_b64_tr_b16 v[40:41], v10 offset:29184
  ds_read_b64_tr_b16 v[42:43], v10 offset:30208
  v_sub_f32 v16, v214, v220
  v_fmac_f32 v218, v16, v16
  v_sub_f32 v17, v215, v220
  v_fmac_f32 v219, v17, v17
  s_waitcnt lgkmcnt(10)
  v_mfma_f32_32x32x16_bf16 v[80:95], v[152:155], v[48:51], v[80:95]
  ds_read_b64_tr_b16 v[44:45], v10 offset:29440
  ds_read_b64_tr_b16 v[46:47], v10 offset:30464
  v_sub_f32 v16, v216, v220
  v_fmac_f32 v218, v16, v16
  v_sub_f32 v17, v217, v220
  v_fmac_f32 v219, v17, v17
  s_waitcnt lgkmcnt(10)
  v_mfma_f32_32x32x16_bf16 v[96:111], v[152:155], v[52:55], v[96:111]
  v_add_f32 v218, v218, v219
  s_nop 1
  v_add_f32_dpp v218, v218, v218 row_ror:1 row_mask:0xf bank_mask:0xf
  s_nop 1
  v_add_f32_dpp v218, v218, v218 row_ror:2 row_mask:0xf bank_mask:0xf
  s_nop 1
  v_add_f32_dpp v218, v218, v218 row_ror:4 row_mask:0xf bank_mask:0xf
  s_waitcnt lgkmcnt(8)
  v_mfma_f32_32x32x16_bf16 v[112:127], v[152:155], v[56:59], v[112:127]
  v_add_f32_dpp v218, v218, v218 row_ror:8 row_mask:0xf bank_mask:0xf
  v_mov_b32 v219, v218
  s_nop 1
  v_permlane32_swap_b32 v218, v219
  v_add_f32 v218, v218, v219
  s_waitcnt lgkmcnt(6)
  v_mfma_f32_32x32x16_bf16 v[64:79], v[156:159], v[32:35], v[64:79]
  s_waitcnt vmcnt(18) lgkmcnt(0)
  s_barrier
  ds_read_b128 v[160:163], v6 offset:8192
  ds_read_b128 v[164:167], v7 offset:8192
  ds_read_b128 v[168:171], v8 offset:8192
  ds_read_b128 v[172:175], v9 offset:8192
  ds_read_b64_tr_b16 v[48:49], v10 offset:32768
  ds_read_b64_tr_b16 v[50:51], v10 offset:33792
  ds_read_b64_tr_b16 v[52:53], v10 offset:33024
  ds_read_b64_tr_b16 v[54:55], v10 offset:34048
  ds_read_b64_tr_b16 v[56:57], v10 offset:33280
  ds_read_b64_tr_b16 v[58:59], v10 offset:34304
  s_add_u32 m0, s97, 16384
  s_mov_b32 s94, 2097152
  buffer_load_dwordx4 v4, s[12:15], s94 offen lds
  v_mov_b32 v219, v218
  v_mfma_f32_32x32x16_bf16 v[80:95], v[156:159], v[36:39], v[80:95]
  ds_read_b64_tr_b16 v[32:33], v10 offset:33536
  ds_read_b64_tr_b16 v[34:35], v10 offset:34560
  s_add_u32 m0, s97, 17408
  s_mov_b32 s94, 2129920
  buffer_load_dwordx4 v4, s[12:15], s94 offen lds
  v_mfma_f32_32x32x16_bf16 v[96:111], v[156:159], v[40:43], v[96:111]
  ds_read_b64_tr_b16 v[36:37], v10 offset:36864
  ds_read_b64_tr_b16 v[38:39], v10 offset:37888
  s_waitcnt vmcnt(16)
  v_mov_b32 v22, 1
  buffer_store_byte v22, v60, s[56:59], 0 offen sc1
  s_cmp_eq_u32 s3, 0
  s_cselect_b32 s58, 256, 0
  v_permlane16_swap_b32 v218, v219
  v_add_f32 v218, v218, v219
  v_mfma_f32_32x32x16_bf16 v[112:127], v[156:159], v[44:47], v[112:127]
  ds_read_b64_tr_b16 v[40:41], v10 offset:37120
  ds_read_b64_tr_b16 v[42:43], v10 offset:38144
  v_mul_f32 v218, 0x3acccccd, v218
  v_cvt_pk_bf16_f32 v219, v218, v220
  v_lshlrev_b32 v218, 16, v219
  v_and_b32 v220, 0xffff0000, v219
  s_waitcnt lgkmcnt(10)
  v_mfma_f32_32x32x16_bf16 v[64:79], v[160:163], v[48:51], v[64:79]
  ds_read_b64_tr_b16 v[44:45], v10 offset:37376
  ds_read_b64_tr_b16 v[46:47], v10 offset:38400
  s_add_u32 m0, s96, 8192
  s_mov_b32 s94, 640
  buffer_load_dwordx4 v2, s[4:7], s94 offen lds
  v_add_f32 v218, 0x3727c5ac, v218
  v_cvt_pk_bf16_f32 v218, v218, v218
  v_lshlrev_b32 v218, 16, v218
  v_sqrt_f32 v218, v218
  s_waitcnt lgkmcnt(10)
  v_mfma_f32_32x32x16_bf16 v[80:95], v[160:163], v[52:55], v[80:95]
  ds_read_b64_tr_b16 v[48:49], v10 offset:37632
  ds_read_b64_tr_b16 v[50:51], v10 offset:38656
  s_add_u32 m0, s96, 9216
  s_mov_b32 s94, 8832
  buffer_load_dwordx4 v3, s[4:7], s94 offen lds
  v_cvt_pk_bf16_f32 v218, v218, v218
  v_lshlrev_b32 v218, 16, v218
  v_rcp_f32 v218, v218
  v_sub_f32 v208, v208, v220
  s_waitcnt lgkmcnt(10)
  v_mfma_f32_32x32x16_bf16 v[96:111], v[160:163], v[56:59], v[96:111]
  ds_read_b64_tr_b16 v[52:53], v10 offset:40960
  ds_read_b64_tr_b16 v[54:55], v10 offset:41984
  s_add_u32 m0, s96, 10240
  s_mov_b32 s94, 17024
  buffer_load_dwordx4 v2, s[4:7], s94 offen lds
  v_sub_f32 v209, v209, v220
  v_cvt_pk_bf16_f32 v16, v208, v209
  v_lshlrev_b32 v208, 16, v16
  v_and_b32 v209, 0xffff0000, v16
  s_waitcnt lgkmcnt(10)
  v_mfma_f32_32x32x16_bf16 v[112:127], v[160:163], v[32:35], v[112:127]
  ds_read_b64_tr_b16 v[56:57], v10 offset:41216
  ds_read_b64_tr_b16 v[58:59], v10 offset:42240
  s_add_u32 m0, s96, 11264
  s_mov_b32 s94, 25216
  buffer_load_dwordx4 v3, s[4:7], s94 offen lds
  v_mul_f32 v208, v208, v218
  v_mul_f32 v209, v209, v218
  v_cvt_pk_bf16_f32 v16, v208, v209
  v_sub_f32 v210, v210, v220
  s_waitcnt lgkmcnt(10)
  v_mfma_f32_32x32x16_bf16 v[64:79], v[164:167], v[36:39], v[64:79]
  ds_read_b64_tr_b16 v[32:33], v10 offset:41472
  ds_read_b64_tr_b16 v[34:35], v10 offset:42496
  v_sub_f32 v211, v211, v220
  v_cvt_pk_bf16_f32 v17, v210, v211
  v_lshlrev_b32 v210, 16, v17
  v_and_b32 v211, 0xffff0000, v17
  s_waitcnt lgkmcnt(10)
  v_mfma_f32_32x32x16_bf16 v[80:95], v[164:167], v[40:43], v[80:95]
  ds_read_b64_tr_b16 v[36:37], v10 offset:41728
  ds_read_b64_tr_b16 v[38:39], v10 offset:42752
  v_mul_f32 v210, v210, v218
  v_mul_f32 v211, v211, v218
  v_cvt_pk_bf16_f32 v17, v210, v211
  v_sub_f32 v212, v212, v220
  s_waitcnt lgkmcnt(10)
  v_mfma_f32_32x32x16_bf16 v[96:111], v[164:167], v[44:47], v[96:111]
  ds_read_b64_tr_b16 v[40:41], v10 offset:45056
  ds_read_b64_tr_b16 v[42:43], v10 offset:46080
  v_sub_f32 v213, v213, v220
  v_cvt_pk_bf16_f32 v18, v212, v213
  v_lshlrev_b32 v212, 16, v18
  v_and_b32 v213, 0xffff0000, v18
  s_waitcnt lgkmcnt(10)
  v_mfma_f32_32x32x16_bf16 v[112:127], v[164:167], v[48:51], v[112:127]
  ds_read_b64_tr_b16 v[44:45], v10 offset:45312
  ds_read_b64_tr_b16 v[46:47], v10 offset:46336
  v_mul_f32 v212, v212, v218
  v_mul_f32 v213, v213, v218
  v_cvt_pk_bf16_f32 v18, v212, v213
  v_sub_f32 v214, v214, v220
  s_waitcnt lgkmcnt(10)
  v_mfma_f32_32x32x16_bf16 v[64:79], v[168:171], v[52:55], v[64:79]
  ds_read_b64_tr_b16 v[48:49], v10 offset:45568
  ds_read_b64_tr_b16 v[50:51], v10 offset:46592
  v_sub_f32 v215, v215, v220
  v_cvt_pk_bf16_f32 v19, v214, v215
  v_lshlrev_b32 v214, 16, v19
  v_and_b32 v215, 0xffff0000, v19
  s_waitcnt lgkmcnt(10)
  v_mfma_f32_32x32x16_bf16 v[80:95], v[168:171], v[56:59], v[80:95]
  ds_read_b64_tr_b16 v[52:53], v10 offset:45824
  ds_read_b64_tr_b16 v[54:55], v10 offset:46848
  v_mul_f32 v214, v214, v218
  v_mul_f32 v215, v215, v218
  v_cvt_pk_bf16_f32 v19, v214, v215
  v_sub_f32 v216, v216, v220
  s_waitcnt lgkmcnt(10)
  v_mfma_f32_32x32x16_bf16 v[96:111], v[168:171], v[32:35], v[96:111]
  v_sub_f32 v217, v217, v220
  v_cvt_pk_bf16_f32 v20, v216, v217
  v_lshlrev_b32 v216, 16, v20
  v_and_b32 v217, 0xffff0000, v20
  s_waitcnt lgkmcnt(8)
  v_mfma_f32_32x32x16_bf16 v[112:127], v[168:171], v[36:39], v[112:127]
  v_mul_f32 v216, v216, v218
  v_mul_f32 v217, v217, v218
  v_cvt_pk_bf16_f32 v20, v216, v217
  v_lshrrev_b32 v23, 2, v0
  s_waitcnt lgkmcnt(6)
  v_mfma_f32_32x32x16_bf16 v[64:79], v[172:175], v[40:43], v[64:79]
  s_waitcnt vmcnt(11) lgkmcnt(0)
  s_barrier
  ds_read_b128 v[176:179], v6 offset:0
  ds_read_b128 v[180:183], v7 offset:0
  ds_read_b128 v[184:187], v8 offset:0
  ds_read_b128 v[188:191], v9 offset:0
  ds_read_b64_tr_b16 v[56:57], v10 offset:0
  ds_read_b64_tr_b16 v[58:59], v10 offset:1024
  ds_read_b64_tr_b16 v[32:33], v10 offset:256
  ds_read_b64_tr_b16 v[34:35], v10 offset:1280
  ds_read_b64_tr_b16 v[36:37], v10 offset:512
  ds_read_b64_tr_b16 v[38:39], v10 offset:1536
  s_lshl_b32 s94, s2, 15
  buffer_load_dword v61, v62, s[76:79], s94 offen
  v_mul_u32_u24 v23, 144, v23
  v_and_b32 v218, 3, v0
  v_lshl_add_u32 v23, v218, 2, v23
  s_lshl_b32 s94, s3, 4
  s_sub_u32 s101, s101, s94
  s_add_u32 s94, s94, 149504
  v_add_u32 v23, s94, v23
  v_mfma_f32_32x32x16_bf16 v[80:95], v[172:175], v[44:47], v[80:95]
  ds_read_b64_tr_b16 v[40:41], v10 offset:768
  ds_read_b64_tr_b16 v[42:43], v10 offset:1792
  s_add_u32 m0, s97, 32768
  s_mov_b32 s94, 2621440
  buffer_load_dwordx4 v4, s[12:15], s94 offen lds
  v_mfma_f32_32x32x16_bf16 v[96:111], v[172:175], v[48:51], v[96:111]
  ds_read_b64_tr_b16 v[44:45], v10 offset:4096
  ds_read_b64_tr_b16 v[46:47], v10 offset:5120
  s_add_u32 m0, s97, 33792
  s_mov_b32 s94, 2654208
  buffer_load_dwordx4 v4, s[12:15], s94 offen lds
  s_waitcnt vmcnt(16)
  s_mov_b32 s95, 1069066811
  v_lshlrev_b32 v224, 16, v224
  v_mfma_f32_32x32x16_bf16 v[112:127], v[172:175], v[52:55], v[112:127]
  ds_read_b64_tr_b16 v[48:49], v10 offset:4352
  ds_read_b64_tr_b16 v[50:51], v10 offset:5376
  v_mul_f32 v248, s95, v224
  v_exp_f32 v248, -v248
  s_nop 0
  v_add_f32 v248, 1.0, v248
  v_rcp_f32 v248, v248
  s_waitcnt lgkmcnt(10)
  v_mfma_f32_32x32x16_bf16 v[64:79], v[176:179], v[56:59], v[64:79]
  ds_read_b64_tr_b16 v[52:53], v10 offset:4608
  ds_read_b64_tr_b16 v[54:55], v10 offset:5632
  s_add_u32 m0, s96, 0
  s_mov_b32 s94, 768
  buffer_load_dwordx4 v2, s[4:7], s94 offen lds
  v_mul_f32 v224, v224, v248
  v_cvt_pk_bf16_f32 v224, v224, v224
  v_lshlrev_b32 v224, 16, v224
  v_lshlrev_b32 v225, 16, v225
  s_waitcnt lgkmcnt(10)
  v_mfma_f32_32x32x16_bf16 v[80:95], v[176:179], v[32:35], v[80:95]
  ds_read_b64_tr_b16 v[56:57], v10 offset:4864
  ds_read_b64_tr_b16 v[58:59], v10 offset:5888
  s_add_u32 m0, s96, 1024
  s_mov_b32 s94, 8960
  buffer_load_dwordx4 v3, s[4:7], s94 offen lds
  v_mul_f32 v249, s95, v225
  v_exp_f32 v249, -v249
  s_nop 0
  v_add_f32 v249, 1.0, v249
  v_rcp_f32 v249, v249
  s_waitcnt lgkmcnt(10)
  v_mfma_f32_32x32x16_bf16 v[96:111], v[176:179], v[36:39], v[96:111]
  ds_read_b64_tr_b16 v[32:33], v10 offset:8192
  ds_read_b64_tr_b16 v[34:35], v10 offset:9216
  s_add_u32 m0, s96, 2048
  s_mov_b32 s94, 17152
  buffer_load_dwordx4 v2, s[4:7], s94 offen lds
  v_mul_f32 v225, v225, v249
  v_cvt_pk_bf16_f32 v225, v225, v225
  v_lshlrev_b32 v225, 16, v225
  v_lshlrev_b32 v226, 16, v226
  s_waitcnt lgkmcnt(10)
  v_mfma_f32_32x32x16_bf16 v[112:127], v[176:179], v[40:43], v[112:127]
  ds_read_b64_tr_b16 v[36:37], v10 offset:8448
  ds_read_b64_tr_b16 v[38:39], v10 offset:9472
  s_add_u32 m0, s96, 3072
  s_mov_b32 s94, 25344
  buffer_load_dwordx4 v3, s[4:7], s94 offen lds
  v_mul_f32 v248, s95, v226
  v_exp_f32 v248, -v248
  s_nop 0
  v_add_f32 v248, 1.0, v248
  v_rcp_f32 v248, v248
  s_waitcnt lgkmcnt(10)
  v_mfma_f32_32x32x16_bf16 v[64:79], v[180:183], v[44:47], v[64:79]
  ds_read_b64_tr_b16 v[40:41], v10 offset:8704
  ds_read_b64_tr_b16 v[42:43], v10 offset:9728
  v_mul_f32 v226, v226, v248
  v_cvt_pk_bf16_f32 v226, v226, v226
  v_lshlrev_b32 v226, 16, v226
  s_waitcnt vmcnt(25)
  s_waitcnt lgkmcnt(10)
  v_mfma_f32_32x32x16_bf16 v[80:95], v[180:183], v[48:51], v[80:95]
  ds_read_b64_tr_b16 v[44:45], v10 offset:8960
  ds_read_b64_tr_b16 v[46:47], v10 offset:9984
  v_lshlrev_b32 v248, 16, v228
  v_and_b32 v249, 0xffff0000, v228
  v_mul_f32 v240, v248, v224
  v_mul_f32 v241, v249, v224
  s_waitcnt lgkmcnt(10)
  v_mfma_f32_32x32x16_bf16 v[96:111], v[180:183], v[52:55], v[96:111]
  ds_read_b64_tr_b16 v[48:49], v10 offset:12288
  ds_read_b64_tr_b16 v[50:51], v10 offset:13312
  v_lshlrev_b32 v248, 16, v229
  v_and_b32 v249, 0xffff0000, v229
  v_mul_f32 v242, v248, v224
  v_mul_f32 v243, v249, v224
  s_waitcnt lgkmcnt(10)
  v_mfma_f32_32x32x16_bf16 v[112:127], v[180:183], v[56:59], v[112:127]
  ds_read_b64_tr_b16 v[52:53], v10 offset:12544
  ds_read_b64_tr_b16 v[54:55], v10 offset:13568
  v_lshlrev_b32 v248, 16, v230
  v_and_b32 v249, 0xffff0000, v230
  v_mul_f32 v244, v248, v224
  v_mul_f32 v245, v249, v224
  s_waitcnt lgkmcnt(10)
  v_mfma_f32_32x32x16_bf16 v[64:79], v[184:187], v[32:35], v[64:79]
  ds_read_b64_tr_b16 v[56:57], v10 offset:12800
  ds_read_b64_tr_b16 v[58:59], v10 offset:13824
  v_lshlrev_b32 v248, 16, v231
  v_and_b32 v249, 0xffff0000, v231
  v_mul_f32 v246, v248, v224
  v_mul_f32 v247, v249, v224
  s_waitcnt lgkmcnt(10)
  v_mfma_f32_32x32x16_bf16 v[80:95], v[184:187], v[36:39], v[80:95]
  ds_read_b64_tr_b16 v[32:33], v10 offset:13056
  ds_read_b64_tr_b16 v[34:35], v10 offset:14080
  s_waitcnt vmcnt(24)
  v_lshlrev_b32 v248, 16, v232
  v_and_b32 v249, 0xffff0000, v232
  s_waitcnt lgkmcnt(10)
  v_mfma_f32_32x32x16_bf16 v[96:111], v[184:187], v[40:43], v[96:111]
  v_fmac_f32 v240, v248, v225
  v_fmac_f32 v241, v249, v225
  v_lshlrev_b32 v248, 16, v233
  v_and_b32 v249, 0xffff0000, v233
  s_waitcnt lgkmcnt(8)
  v_mfma_f32_32x32x16_bf16 v[112:127], v[184:187], v[44:47], v[112:127]
  v_fmac_f32 v242, v248, v225
  v_fmac_f32 v243, v249, v225
  v_lshlrev_b32 v248, 16, v234
  v_and_b32 v249, 0xffff0000, v234
  s_waitcnt lgkmcnt(6)
  v_mfma_f32_32x32x16_bf16 v[64:79], v[188:191], v[48:51], v[64:79]
  s_waitcnt vmcnt(12) lgkmcnt(0)
  s_barrier
  ds_read_b128 v[192:195], v6 offset:4096
  ds_read_b128 v[196:199], v7 offset:4096
  ds_read_b128 v[200:203], v8 offset:4096
  ds_read_b128 v[204:207], v9 offset:4096
  ds_read_b64_tr_b16 v[36:37], v10 offset:16384
  ds_read_b64_tr_b16 v[38:39], v10 offset:17408
  ds_read_b64_tr_b16 v[40:41], v10 offset:16640
  ds_read_b64_tr_b16 v[42:43], v10 offset:17664
  ds_read_b64_tr_b16 v[44:45], v10 offset:16896
  ds_read_b64_tr_b16 v[46:47], v10 offset:17920
  buffer_load_dword v21, v15, s[36:39], 0 offen sc1
  v_fmac_f32 v244, v248, v225
  v_fmac_f32 v245, v249, v225
  v_lshlrev_b32 v248, 16, v235
  v_and_b32 v249, 0xffff0000, v235
  v_mfma_f32_32x32x16_bf16 v[80:95], v[188:191], v[52:55], v[80:95]
  ds_read_b64_tr_b16 v[48:49], v10 offset:17152
  ds_read_b64_tr_b16 v[50:51], v10 offset:18176
  s_lshl_b32 s94, s2, 15
  buffer_load_dword v61, v62, s[80:83], s94 offen
  v_fmac_f32 v246, v248, v225
  v_fmac_f32 v247, v249, v225
  s_waitcnt vmcnt(25)
  v_mfma_f32_32x32x16_bf16 v[96:111], v[188:191], v[56:59], v[96:111]
  ds_read_b64_tr_b16 v[52:53], v10 offset:20480
  ds_read_b64_tr_b16 v[54:55], v10 offset:21504
  s_add_u32 m0, s97, 0
  s_mov_b32 s94, 3145728
  buffer_load_dwordx4 v4, s[12:15], s94 offen lds
  v_lshlrev_b32 v248, 16, v236
  v_and_b32 v249, 0xffff0000, v236
  v_fmac_f32 v240, v248, v226
  v_fmac_f32 v241, v249, v226
  v_mfma_f32_32x32x16_bf16 v[112:127], v[188:191], v[32:35], v[112:127]
  ds_read_b64_tr_b16 v[56:57], v10 offset:20736
  ds_read_b64_tr_b16 v[58:59], v10 offset:21760
  s_add_u32 m0, s97, 1024
  s_mov_b32 s94, 3178496
  buffer_load_dwordx4 v4, s[12:15], s94 offen lds
  v_lshlrev_b32 v248, 16, v237
  v_and_b32 v249, 0xffff0000, v237
  v_fmac_f32 v242, v248, v226
  v_fmac_f32 v243, v249, v226
  s_waitcnt lgkmcnt(10)
  v_mfma_f32_32x32x16_bf16 v[64:79], v[192:195], v[36:39], v[64:79]
  ds_read_b64_tr_b16 v[32:33], v10 offset:20992
  ds_read_b64_tr_b16 v[34:35], v10 offset:22016
  s_add_u32 m0, s96, 4096
  s_mov_b32 s94, 896
  buffer_load_dwordx4 v2, s[4:7], s94 offen lds
  v_lshlrev_b32 v248, 16, v238
  v_and_b32 v249, 0xffff0000, v238
  v_fmac_f32 v244, v248, v226
  v_fmac_f32 v245, v249, v226
  s_waitcnt lgkmcnt(10)
  v_mfma_f32_32x32x16_bf16 v[80:95], v[192:195], v[40:43], v[80:95]
  ds_read_b64_tr_b16 v[36:37], v10 offset:21248
  ds_read_b64_tr_b16 v[38:39], v10 offset:22272
  s_add_u32 m0, s96, 5120
  s_mov_b32 s94, 9088
  buffer_load_dwordx4 v3, s[4:7], s94 offen lds
  v_lshlrev_b32 v248, 16, v239
  v_and_b32 v249, 0xffff0000, v239
  v_fmac_f32 v246, v248, v226
  v_fmac_f32 v247, v249, v226
  s_waitcnt lgkmcnt(10)
  v_mfma_f32_32x32x16_bf16 v[96:111], v[192:195], v[44:47], v[96:111]
  ds_read_b64_tr_b16 v[40:41], v10 offset:24576
  ds_read_b64_tr_b16 v[42:43], v10 offset:25600
  s_add_u32 m0, s96, 6144
  s_mov_b32 s94, 17280
  buffer_load_dwordx4 v2, s[4:7], s94 offen lds
  v_add_f32_dpp v240, v240, v240 row_ror:2 row_mask:0xf bank_mask:0xf
  v_add_f32_dpp v241, v241, v241 row_ror:2 row_mask:0xf bank_mask:0xf
  v_add_f32_dpp v242, v242, v242 row_ror:2 row_mask:0xf bank_mask:0xf
  v_add_f32_dpp v243, v243, v243 row_ror:2 row_mask:0xf bank_mask:0xf
  s_waitcnt lgkmcnt(10)
  v_mfma_f32_32x32x16_bf16 v[112:127], v[192:195], v[48:51], v[112:127]
  ds_read_b64_tr_b16 v[44:45], v10 offset:24832
  ds_read_b64_tr_b16 v[46:47], v10 offset:25856
  s_add_u32 m0, s96, 7168
  s_mov_b32 s94, 25472
  buffer_load_dwordx4 v3, s[4:7], s94 offen lds
  v_add_f32_dpp v244, v244, v244 row_ror:2 row_mask:0xf bank_mask:0xf
  v_add_f32_dpp v245, v245, v245 row_ror:2 row_mask:0xf bank_mask:0xf
  v_add_f32_dpp v246, v246, v246 row_ror:2 row_mask:0xf bank_mask:0xf
  v_add_f32_dpp v247, v247, v247 row_ror:2 row_mask:0xf bank_mask:0xf
  s_waitcnt lgkmcnt(10)
  v_mfma_f32_32x32x16_bf16 v[64:79], v[196:199], v[52:55], v[64:79]
  ds_read_b64_tr_b16 v[48:49], v10 offset:25088
  ds_read_b64_tr_b16 v[50:51], v10 offset:26112
  v_add_f32_dpp v240, v240, v240 row_ror:4 row_mask:0xf bank_mask:0xf
  v_add_f32_dpp v241, v241, v241 row_ror:4 row_mask:0xf bank_mask:0xf
  v_add_f32_dpp v242, v242, v242 row_ror:4 row_mask:0xf bank_mask:0xf
  v_add_f32_dpp v243, v243, v243 row_ror:4 row_mask:0xf bank_mask:0xf
  s_waitcnt lgkmcnt(10)
  v_mfma_f32_32x32x16_bf16 v[80:95], v[196:199], v[56:59], v[80:95]
  ds_read_b64_tr_b16 v[52:53], v10 offset:25344
  ds_read_b64_tr_b16 v[54:55], v10 offset:26368
  v_add_f32_dpp v244, v244, v244 row_ror:4 row_mask:0xf bank_mask:0xf
  v_add_f32_dpp v245, v245, v245 row_ror:4 row_mask:0xf bank_mask:0xf
  v_add_f32_dpp v246, v246, v246 row_ror:4 row_mask:0xf bank_mask:0xf
  v_add_f32_dpp v247, v247, v247 row_ror:4 row_mask:0xf bank_mask:0xf
  s_waitcnt lgkmcnt(10)
  v_mfma_f32_32x32x16_bf16 v[96:111], v[196:199], v[32:35], v[96:111]
  ds_read_b64_tr_b16 v[56:57], v10 offset:28672
  ds_read_b64_tr_b16 v[58:59], v10 offset:29696
  v_add_f32_dpp v240, v240, v240 row_ror:8 row_mask:0xf bank_mask:0xf
  v_add_f32_dpp v241, v241, v241 row_ror:8 row_mask:0xf bank_mask:0xf
  v_add_f32_dpp v242, v242, v242 row_ror:8 row_mask:0xf bank_mask:0xf
  v_add_f32_dpp v243, v243, v243 row_ror:8 row_mask:0xf bank_mask:0xf
  s_waitcnt lgkmcnt(10)
  v_mfma_f32_32x32x16_bf16 v[112:127], v[196:199], v[36:39], v[112:127]
  ds_read_b64_tr_b16 v[32:33], v10 offset:28928
  ds_read_b64_tr_b16 v[34:35], v10 offset:29952
  v_add_f32_dpp v244, v244, v244 row_ror:8 row_mask:0xf bank_mask:0xf
  v_add_f32_dpp v245, v245, v245 row_ror:8 row_mask:0xf bank_mask:0xf
  v_add_f32_dpp v246, v246, v246 row_ror:8 row_mask:0xf bank_mask:0xf
  v_add_f32_dpp v247, v247, v247 row_ror:8 row_mask:0xf bank_mask:0xf
  s_waitcnt lgkmcnt(10)
  v_mfma_f32_32x32x16_bf16 v[64:79], v[200:203], v[40:43], v[64:79]
  ds_read_b64_tr_b16 v[36:37], v10 offset:29184
  ds_read_b64_tr_b16 v[38:39], v10 offset:30208
  ds_write_b128 v252, v[240:243]
  ds_write_b128 v252, v[244:247] offset:16
  s_waitcnt lgkmcnt(12)
  v_mfma_f32_32x32x16_bf16 v[80:95], v[200:203], v[44:47], v[80:95]
  ds_read_b64_tr_b16 v[40:41], v10 offset:29440
  ds_read_b64_tr_b16 v[42:43], v10 offset:30464
  s_waitcnt lgkmcnt(12)
  v_mfma_f32_32x32x16_bf16 v[96:111], v[200:203], v[48:51], v[96:111]
  s_waitcnt lgkmcnt(10)
  v_mfma_f32_32x32x16_bf16 v[112:127], v[200:203], v[52:55], v[112:127]
  s_waitcnt lgkmcnt(8)
  v_mfma_f32_32x32x16_bf16 v[64:79], v[204:207], v[56:59], v[64:79]
  s_waitcnt vmcnt(12) lgkmcnt(0)
  s_barrier
  ds_read_b128 v[208:211], v6 offset:8192
  ds_read_b128 v[212:215], v7 offset:8192
  ds_read_b128 v[216:219], v8 offset:8192
  ds_read_b128 v[220:223], v9 offset:8192
  ds_read_b64_tr_b16 v[44:45], v10 offset:32768
  ds_read_b64_tr_b16 v[46:47], v10 offset:33792
  ds_read_b64_tr_b16 v[48:49], v10 offset:33024
  ds_read_b64_tr_b16 v[50:51], v10 offset:34048
  ds_read_b64_tr_b16 v[52:53], v10 offset:33280
  ds_read_b64_tr_b16 v[54:55], v10 offset:34304
  s_add_u32 m0, s97, 16384
  s_mov_b32 s94, 3670016
  buffer_load_dwordx4 v4, s[12:15], s94 offen lds
  v_mfma_f32_32x32x16_bf16 v[80:95], v[204:207], v[32:35], v[80:95]
  ds_read_b64_tr_b16 v[56:57], v10 offset:33536
  ds_read_b64_tr_b16 v[58:59], v10 offset:34560
  s_add_u32 m0, s97, 17408
  s_mov_b32 s94, 3702784
  buffer_load_dwordx4 v4, s[12:15], s94 offen lds
  s_waitcnt vmcnt(9)
  v_and_b32 v21, v21, v63
  v_cmp_ne_u32 vcc, v21, v63
  s_cmp_lg_u64 vcc, 0
  s_cbranch_scc1 kva_kernel_lnw_12
kva_kernel_lnb_13:
  buffer_load_dword v24, v15, s[32:35], 0 offen offset:0 sc1
  buffer_load_dword v25, v15, s[32:35], 0 offen offset:256 sc1
  buffer_load_dword v26, v15, s[32:35], 0 offen offset:512 sc1
  buffer_load_dword v27, v15, s[32:35], 0 offen offset:768 sc1
  buffer_load_dword v28, v15, s[32:35], 0 offen offset:1024 sc1
  buffer_load_dword v29, v15, s[32:35], 0 offen offset:1280 sc1
  buffer_load_dword v30, v15, s[32:35], 0 offen offset:1536 sc1
  buffer_load_dword v31, v15, s[32:35], 0 offen offset:1792 sc1
  buffer_load_dword v21, v15, s[32:35], 0 offen offset:2048 sc1
  buffer_load_dword v22, v15, s[32:35], 0 offen offset:2304 sc1
kva_kernel_lnc_14:
  ds_read_b32 v240, v253 offset:0
  v_mfma_f32_32x32x16_bf16 v[96:111], v[204:207], v[36:39], v[96:111]
  ds_read_b64_tr_b16 v[32:33], v10 offset:36864
  ds_read_b64_tr_b16 v[34:35], v10 offset:37888
  ds_read_b32 v241, v253 offset:64
  ds_read_b32 v242, v253 offset:128
  v_mfma_f32_32x32x16_bf16 v[112:127], v[204:207], v[40:43], v[112:127]
  ds_read_b64_tr_b16 v[36:37], v10 offset:37120
  ds_read_b64_tr_b16 v[38:39], v10 offset:38144
  ds_read_b32 v243, v253 offset:192
  ds_read_b32 v244, v253 offset:256
  s_waitcnt lgkmcnt(15)
  v_mfma_f32_32x32x16_bf16 v[64:79], v[208:211], v[44:47], v[64:79]
  ds_read_b64_tr_b16 v[40:41], v10 offset:37376
  ds_read_b64_tr_b16 v[42:43], v10 offset:38400
  s_add_u32 m0, s96, 8192
  s_add_u32 s94, s98, 0
  buffer_load_dwordx4 v5, s[12:15], s94 offen lds
  ds_read_b32 v245, v253 offset:320
  ds_read_b32 v246, v253 offset:384
  s_waitcnt lgkmcnt(15)
  v_mfma_f32_32x32x16_bf16 v[80:95], v[208:211], v[48:51], v[80:95]
  ds_read_b64_tr_b16 v[44:45], v10 offset:37632
  ds_read_b64_tr_b16 v[46:47], v10 offset:38656
  s_add_u32 m0, s96, 9216
  s_add_u32 s94, s98, 65536
  buffer_load_dwordx4 v5, s[12:15], s94 offen lds
  ds_read_b32 v247, v253 offset:448
  v_mfma_f32_32x32x16_bf16 v[96:111], v[208:211], v[52:55], v[96:111]
  ds_read_b64_tr_b16 v[48:49], v10 offset:40960
  ds_read_b64_tr_b16 v[50:51], v10 offset:41984
  s_add_u32 m0, s96, 10240
  s_add_u32 s94, s98, 131072
  buffer_load_dwordx4 v5, s[12:15], s94 offen lds
  s_waitcnt lgkmcnt(2)
  v_add_f32 v240, v240, v241
  v_add_f32 v242, v242, v243
  v_mfma_f32_32x32x16_bf16 v[112:127], v[208:211], v[56:59], v[112:127]
  ds_read_b64_tr_b16 v[52:53], v10 offset:41216
  ds_read_b64_tr_b16 v[54:55], v10 offset:42240
  s_add_u32 m0, s96, 11264
  s_add_u32 s94, s98, 196608
  buffer_load_dwordx4 v5, s[12:15], s94 offen lds
  v_add_f32 v244, v244, v245
  v_add_f32 v246, v246, v247
  v_add_f32 v240, v240, v242
  v_add_f32 v244, v244, v246
  v_mfma_f32_32x32x16_bf16 v[64:79], v[212:215], v[32:35], v[64:79]
  ds_read_b64_tr_b16 v[56:57], v10 offset:41472
  ds_read_b64_tr_b16 v[58:59], v10 offset:42496
  v_add_f32 v240, v240, v244
  v_mov_b32 v241, v240
  s_nop 1
  v_permlane32_swap_b32 v240, v241
  v_add_f32 v240, v240, v241
  v_mfma_f32_32x32x16_bf16 v[80:95], v[212:215], v[36:39], v[80:95]
  ds_read_b64_tr_b16 v[32:33], v10 offset:41728
  ds_read_b64_tr_b16 v[34:35], v10 offset:42752
  v_mov_b32 v241, v240
  s_nop 1
  v_permlane16_swap_b32 v240, v241
  v_add_f32 v240, v240, v241
  v_cvt_pk_bf16_f32 v240, v240, v240
  v_mfma_f32_32x32x16_bf16 v[96:111], v[212:215], v[40:43], v[96:111]
  ds_read_b64_tr_b16 v[36:37], v10 offset:45056
  ds_read_b64_tr_b16 v[38:39], v10 offset:46080
  v_lshlrev_b32 v240, 16, v240
  buffer_store_dword v240, v15, s[52:55], 0 offen
  v_mfma_f32_32x32x16_bf16 v[112:127], v[212:215], v[44:47], v[112:127]
  ds_read_b64_tr_b16 v[40:41], v10 offset:45312
  ds_read_b64_tr_b16 v[42:43], v10 offset:46336
  s_waitcnt lgkmcnt(10)
  v_mfma_f32_32x32x16_bf16 v[64:79], v[216:219], v[48:51], v[64:79]
  ds_read_b64_tr_b16 v[44:45], v10 offset:45568
  ds_read_b64_tr_b16 v[46:47], v10 offset:46592
  s_waitcnt lgkmcnt(10)
  v_mfma_f32_32x32x16_bf16 v[80:95], v[216:219], v[52:55], v[80:95]
  ds_read_b64_tr_b16 v[48:49], v10 offset:45824
  ds_read_b64_tr_b16 v[50:51], v10 offset:46848
  s_waitcnt lgkmcnt(10)
  v_mfma_f32_32x32x16_bf16 v[96:111], v[216:219], v[56:59], v[96:111]
  s_waitcnt lgkmcnt(8)
  v_mfma_f32_32x32x16_bf16 v[112:127], v[216:219], v[32:35], v[112:127]
  s_waitcnt lgkmcnt(6)
  v_mfma_f32_32x32x16_bf16 v[64:79], v[220:223], v[36:39], v[64:79]
  s_waitcnt vmcnt(21) lgkmcnt(0)
  s_barrier
  ds_read_b128 v[224:227], v6 offset:0
  ds_read_b128 v[228:231], v7 offset:0
  ds_read_b128 v[232:235], v8 offset:0
  ds_read_b128 v[236:239], v9 offset:0
  ds_read_b64_tr_b16 v[52:53], v10 offset:0
  ds_read_b64_tr_b16 v[54:55], v10 offset:1024
  ds_read_b64_tr_b16 v[56:57], v10 offset:256
  ds_read_b64_tr_b16 v[58:59], v10 offset:1280
  ds_read_b64_tr_b16 v[32:33], v10 offset:512
  ds_read_b64_tr_b16 v[34:35], v10 offset:1536
  v_mfma_f32_32x32x16_bf16 v[80:95], v[220:223], v[40:43], v[80:95]
  ds_read_b64_tr_b16 v[36:37], v10 offset:768
  ds_read_b64_tr_b16 v[38:39], v10 offset:1792
  v_mfma_f32_32x32x16_bf16 v[96:111], v[220:223], v[44:47], v[96:111]
  ds_read_b64_tr_b16 v[40:41], v10 offset:4096
  ds_read_b64_tr_b16 v[42:43], v10 offset:5120
  v_mfma_f32_32x32x16_bf16 v[112:127], v[220:223], v[48:51], v[112:127]
  ds_read_b64_tr_b16 v[44:45], v10 offset:4352
  ds_read_b64_tr_b16 v[46:47], v10 offset:5376
  s_waitcnt lgkmcnt(10)
  v_mfma_f32_32x32x16_bf16 v[64:79], v[224:227], v[52:55], v[64:79]
  ds_read_b64_tr_b16 v[48:49], v10 offset:4608
  ds_read_b64_tr_b16 v[50:51], v10 offset:5632
  s_add_u32 m0, s96, 0
  s_add_u32 s94, s98, 2097152
  buffer_load_dwordx4 v5, s[12:15], s94 offen lds
  s_waitcnt vmcnt(6)
  v_lshlrev_b32 v1, 16, v16
  v_and_b32 v61, 0xffff0000, v16
  s_waitcnt lgkmcnt(10)
  v_mfma_f32_32x32x16_bf16 v[80:95], v[224:227], v[56:59], v[80:95]
  ds_read_b64_tr_b16 v[52:53], v10 offset:4864
  ds_read_b64_tr_b16 v[54:55], v10 offset:5888
  s_add_u32 m0, s96, 1024
  s_add_u32 s94, s98, 2162688
  buffer_load_dwordx4 v5, s[12:15], s94 offen lds
  v_lshlrev_b32 v62, 16, v29
  v_and_b32 v63, 0xffff0000, v29
  v_mul_f32 v1, v1, v62
  v_mul_f32 v61, v61, v63
  s_waitcnt lgkmcnt(10)
  v_mfma_f32_32x32x16_bf16 v[96:111], v[224:227], v[32:35], v[96:111]
  ds_read_b64_tr_b16 v[56:57], v10 offset:8192
  ds_read_b64_tr_b16 v[58:59], v10 offset:9216
  s_add_u32 m0, s96, 2048
  s_add_u32 s94, s98, 2228224
  buffer_load_dwordx4 v5, s[12:15], s94 offen lds
  v_cvt_pk_bf16_f32 v62, v1, v61
  v_lshlrev_b32 v1, 16, v62
  v_and_b32 v61, 0xffff0000, v62
  v_lshlrev_b32 v62, 16, v24
  s_waitcnt lgkmcnt(10)
  v_mfma_f32_32x32x16_bf16 v[112:127], v[224:227], v[36:39], v[112:127]
  ds_read_b64_tr_b16 v[32:33], v10 offset:8448
  ds_read_b64_tr_b16 v[34:35], v10 offset:9472
  s_add_u32 m0, s96, 3072
  s_add_u32 s94, s98, 2293760
  buffer_load_dwordx4 v5, s[12:15], s94 offen lds
  v_and_b32 v63, 0xffff0000, v24
  v_add_f32 v1, v1, v62
  v_add_f32 v61, v61, v63
  v_cvt_pk_bf16_f32 v16, v1, v61
  s_waitcnt lgkmcnt(10)
  v_mfma_f32_32x32x16_bf16 v[64:79], v[228:231], v[40:43], v[64:79]
  ds_read_b64_tr_b16 v[36:37], v10 offset:8704
  ds_read_b64_tr_b16 v[38:39], v10 offset:9728
  ds_write_b32 v23, v16 offset:0
  v_lshlrev_b32 v1, 16, v17
  v_and_b32 v61, 0xffff0000, v17
  s_waitcnt lgkmcnt(11)
  v_mfma_f32_32x32x16_bf16 v[80:95], v[228:231], v[44:47], v[80:95]
  ds_read_b64_tr_b16 v[40:41], v10 offset:8960
  ds_read_b64_tr_b16 v[42:43], v10 offset:9984
  v_lshlrev_b32 v62, 16, v30
  v_and_b32 v63, 0xffff0000, v30
  v_mul_f32 v1, v1, v62
  v_mul_f32 v61, v61, v63
  s_waitcnt lgkmcnt(11)
  v_mfma_f32_32x32x16_bf16 v[96:111], v[228:231], v[48:51], v[96:111]
  ds_read_b64_tr_b16 v[44:45], v10 offset:12288
  ds_read_b64_tr_b16 v[46:47], v10 offset:13312
  v_cvt_pk_bf16_f32 v62, v1, v61
  v_lshlrev_b32 v1, 16, v62
  v_and_b32 v61, 0xffff0000, v62
  v_lshlrev_b32 v62, 16, v25
  s_waitcnt lgkmcnt(11)
  v_mfma_f32_32x32x16_bf16 v[112:127], v[228:231], v[52:55], v[112:127]
  ds_read_b64_tr_b16 v[48:49], v10 offset:12544
  ds_read_b64_tr_b16 v[50:51], v10 offset:13568
  v_and_b32 v63, 0xffff0000, v25
  v_add_f32 v1, v1, v62
  v_add_f32 v61, v61, v63
  v_cvt_pk_bf16_f32 v17, v1, v61
  s_waitcnt lgkmcnt(11)
  v_mfma_f32_32x32x16_bf16 v[64:79], v[232:235], v[56:59], v[64:79]
  ds_read_b64_tr_b16 v[52:53], v10 offset:12800
  ds_read_b64_tr_b16 v[54:55], v10 offset:13824
  ds_write_b32 v23, v17 offset:2304
  v_lshlrev_b32 v1, 16, v18
  v_and_b32 v61, 0xffff0000, v18
  s_waitcnt lgkmcnt(12)
  v_mfma_f32_32x32x16_bf16 v[80:95], v[232:235], v[32:35], v[80:95]
  ds_read_b64_tr_b16 v[56:57], v10 offset:13056
  ds_read_b64_tr_b16 v[58:59], v10 offset:14080
  v_lshlrev_b32 v62, 16, v31
  v_and_b32 v63, 0xffff0000, v31
  v_mul_f32 v1, v1, v62
  v_mul_f32 v61, v61, v63
  s_waitcnt lgkmcnt(12)
  v_mfma_f32_32x32x16_bf16 v[96:111], v[232:235], v[36:39], v[96:111]
  v_cvt_pk_bf16_f32 v62, v1, v61
  v_lshlrev_b32 v1, 16, v62
  v_and_b32 v61, 0xffff0000, v62
  v_lshlrev_b32 v62, 16, v26
  s_waitcnt lgkmcnt(9)
  v_mfma_f32_32x32x16_bf16 v[112:127], v[232:235], v[40:43], v[112:127]
  v_and_b32 v63, 0xffff0000, v26
  v_add_f32 v1, v1, v62
  v_add_f32 v61, v61, v63
  v_cvt_pk_bf16_f32 v18, v1, v61
  s_waitcnt lgkmcnt(7)
  v_mfma_f32_32x32x16_bf16 v[64:79], v[236:239], v[44:47], v[64:79]
  s_waitcnt vmcnt(19) lgkmcnt(0)
  s_barrier
  ds_read_b128 v[240:243], v6 offset:4096
  ds_read_b128 v[244:247], v7 offset:4096
  ds_read_b128 v[248:251], v8 offset:4096
  ds_read_b128 v[252:255], v9 offset:4096
  ds_read_b64_tr_b16 v[32:33], v10 offset:16384
  ds_read_b64_tr_b16 v[34:35], v10 offset:17408
  ds_read_b64_tr_b16 v[36:37], v10 offset:16640
  ds_read_b64_tr_b16 v[38:39], v10 offset:17664
  ds_read_b64_tr_b16 v[40:41], v10 offset:16896
  ds_read_b64_tr_b16 v[42:43], v10 offset:17920
  ds_write_b32 v23, v18 offset:4608
  v_lshlrev_b32 v1, 16, v19
  v_and_b32 v61, 0xffff0000, v19
  v_mfma_f32_32x32x16_bf16 v[80:95], v[236:239], v[48:51], v[80:95]
  ds_read_b64_tr_b16 v[44:45], v10 offset:17152
  ds_read_b64_tr_b16 v[46:47], v10 offset:18176
  v_lshlrev_b32 v62, 16, v21
  v_and_b32 v63, 0xffff0000, v21
  v_mul_f32 v1, v1, v62
  v_mul_f32 v61, v61, v63
  v_mfma_f32_32x32x16_bf16 v[96:111], v[236:239], v[52:55], v[96:111]
  ds_read_b64_tr_b16 v[48:49], v10 offset:20480
  ds_read_b64_tr_b16 v[50:51], v10 offset:21504
  v_cvt_pk_bf16_f32 v62, v1, v61
  v_lshlrev_b32 v1, 16, v62
  v_and_b32 v61, 0xffff0000, v62
  v_lshlrev_b32 v62, 16, v27
  v_mfma_f32_32x32x16_bf16 v[112:127], v[236:239], v[56:59], v[112:127]
  ds_read_b64_tr_b16 v[52:53], v10 offset:20736
  ds_read_b64_tr_b16 v[54:55], v10 offset:21760
  v_and_b32 v63, 0xffff0000, v27
  v_add_f32 v1, v1, v62
  v_add_f32 v61, v61, v63
  v_cvt_pk_bf16_f32 v19, v1, v61
  s_waitcnt lgkmcnt(11)
  v_mfma_f32_32x32x16_bf16 v[64:79], v[240:243], v[32:35], v[64:79]
  ds_read_b64_tr_b16 v[56:57], v10 offset:20992
  ds_read_b64_tr_b16 v[58:59], v10 offset:22016
  s_add_u32 m0, s96, 4096
  s_add_u32 s94, s98, 128
  buffer_load_dwordx4 v5, s[12:15], s94 offen lds
  ds_write_b32 v23, v19 offset:6912
  v_lshlrev_b32 v1, 16, v20
  v_and_b32 v61, 0xffff0000, v20
  s_waitcnt lgkmcnt(12)
  v_mfma_f32_32x32x16_bf16 v[80:95], v[240:243], v[36:39], v[80:95]
  ds_read_b64_tr_b16 v[32:33], v10 offset:21248
  ds_read_b64_tr_b16 v[34:35], v10 offset:22272
  s_add_u32 m0, s96, 5120
  s_add_u32 s94, s98, 65664
  buffer_load_dwordx4 v5, s[12:15], s94 offen lds
  v_lshlrev_b32 v62, 16, v22
  v_and_b32 v63, 0xffff0000, v22
  v_mul_f32 v1, v1, v62
  v_mul_f32 v61, v61, v63
  s_waitcnt lgkmcnt(12)
  v_mfma_f32_32x32x16_bf16 v[96:111], v[240:243], v[40:43], v[96:111]
  ds_read_b64_tr_b16 v[36:37], v10 offset:24576
  ds_read_b64_tr_b16 v[38:39], v10 offset:25600
  s_add_u32 m0, s96, 6144
  s_add_u32 s94, s98, 131200
  buffer_load_dwordx4 v5, s[12:15], s94 offen lds
  v_cvt_pk_bf16_f32 v62, v1, v61
  v_lshlrev_b32 v1, 16, v62
  v_and_b32 v61, 0xffff0000, v62
  v_lshlrev_b32 v62, 16, v28
  s_waitcnt lgkmcnt(11)
  v_mfma_f32_32x32x16_bf16 v[112:127], v[240:243], v[44:47], v[112:127]
  ds_read_b64_tr_b16 v[40:41], v10 offset:24832
  ds_read_b64_tr_b16 v[42:43], v10 offset:25856
  s_add_u32 m0, s96, 7168
  s_add_u32 s94, s98, 196736
  buffer_load_dwordx4 v5, s[12:15], s94 offen lds
  v_and_b32 v63, 0xffff0000, v28
  v_add_f32 v1, v1, v62
  v_add_f32 v61, v61, v63
  v_cvt_pk_bf16_f32 v20, v1, v61
  s_waitcnt lgkmcnt(11)
  v_mfma_f32_32x32x16_bf16 v[64:79], v[244:247], v[48:51], v[64:79]
  ds_read_b64_tr_b16 v[44:45], v10 offset:25088
  ds_read_b64_tr_b16 v[46:47], v10 offset:26112
  ds_write_b32 v23, v20 offset:9216
  s_movk_i32 s91, 144
  v_lshrrev_b32 v16, 3, v0
  s_waitcnt lgkmcnt(12)
  v_mfma_f32_32x32x16_bf16 v[80:95], v[244:247], v[52:55], v[80:95]
  ds_read_b64_tr_b16 v[48:49], v10 offset:25344
  ds_read_b64_tr_b16 v[50:51], v10 offset:26368
  s_mul_i32 s95, s3, 10
  v_add_u32 v16, s95, v16
  v_and_b32 v17, 7, v0
  v_lshlrev_b32 v17, 4, v17
  s_waitcnt lgkmcnt(12)
  v_mfma_f32_32x32x16_bf16 v[96:111], v[244:247], v[56:59], v[96:111]
  ds_read_b64_tr_b16 v[52:53], v10 offset:28672
  ds_read_b64_tr_b16 v[54:55], v10 offset:29696
  v_mad_u32_u24 v18, v16, s91, v17
  v_add_u32 v18, 149504, v18
  v_lshl_add_u32 v17, v16, 9, v17
  v_cmp_gt_u32 vcc, 16, v0
  s_waitcnt lgkmcnt(11)
  v_mfma_f32_32x32x16_bf16 v[112:127], v[244:247], v[32:35], v[112:127]
  ds_read_b64_tr_b16 v[56:57], v10 offset:28928
  ds_read_b64_tr_b16 v[58:59], v10 offset:29952
  v_cndmask_b32 v19, 2.0, v17, vcc
  s_waitcnt lgkmcnt(11)
  v_mfma_f32_32x32x16_bf16 v[64:79], v[248:251], v[36:39], v[64:79]
  ds_read_b64_tr_b16 v[32:33], v10 offset:29184
  ds_read_b64_tr_b16 v[34:35], v10 offset:30208
  s_waitcnt lgkmcnt(11)
  v_mfma_f32_32x32x16_bf16 v[80:95], v[248:251], v[40:43], v[80:95]
  ds_read_b64_tr_b16 v[36:37], v10 offset:29440
  ds_read_b64_tr_b16 v[38:39], v10 offset:30464
  s_waitcnt lgkmcnt(11)
  v_mfma_f32_32x32x16_bf16 v[96:111], v[248:251], v[44:47], v[96:111]
  s_waitcnt lgkmcnt(8)
  v_mfma_f32_32x32x16_bf16 v[112:127], v[248:251], v[48:51], v[112:127]
  s_waitcnt lgkmcnt(6)
  v_mfma_f32_32x32x16_bf16 v[64:79], v[252:255], v[52:55], v[64:79]
  s_waitcnt vmcnt(9) lgkmcnt(0)
  s_barrier
  ds_read_b64_tr_b16 v[40:41], v11 offset:8192
  ds_read_b64_tr_b16 v[42:43], v11 offset:8704
  ds_read_b64_tr_b16 v[44:45], v11 offset:8448
  ds_read_b64_tr_b16 v[46:47], v11 offset:8960
  ds_read_b64_tr_b16 v[48:49], v11 offset:10240
  ds_read_b64_tr_b16 v[50:51], v11 offset:10752
  v_mfma_f32_32x32x16_bf16 v[80:95], v[252:255], v[56:59], v[80:95]
  ds_read_b64_tr_b16 v[52:53], v11 offset:10496
  ds_read_b64_tr_b16 v[54:55], v11 offset:11008
  v_mfma_f32_32x32x16_bf16 v[96:111], v[252:255], v[32:35], v[96:111]
  ds_read_b64_tr_b16 v[56:57], v11 offset:20480
  ds_read_b64_tr_b16 v[58:59], v11 offset:20992
  v_mfma_f32_32x32x16_bf16 v[112:127], v[252:255], v[36:39], v[112:127]
  ds_read_b64_tr_b16 v[32:33], v11 offset:20736
  ds_read_b64_tr_b16 v[34:35], v11 offset:21248
  v_cvt_pk_bf16_f32 v24, v64, v65
  v_cvt_pk_bf16_f32 v25, v66, v67
  v_cvt_pk_bf16_f32 v26, v68, v69
  v_cvt_pk_bf16_f32 v27, v70, v71
  v_cvt_pk_bf16_f32 v28, v72, v73
  v_cvt_pk_bf16_f32 v29, v74, v75
  v_cvt_pk_bf16_f32 v30, v76, v77
  v_cvt_pk_bf16_f32 v31, v78, v79
  s_waitcnt lgkmcnt(10)
  v_mfma_f32_32x32x16_bf16 v[64:79], v[128:131], v[40:43], 0
  ds_read_b64_tr_b16 v[36:37], v11 offset:22528
  ds_read_b64_tr_b16 v[38:39], v11 offset:23040
  v_cvt_pk_bf16_f32 v96, v96, v97
  v_cvt_pk_bf16_f32 v97, v98, v99
  v_cvt_pk_bf16_f32 v98, v100, v101
  v_cvt_pk_bf16_f32 v99, v102, v103
  v_cvt_pk_bf16_f32 v100, v104, v105
  v_cvt_pk_bf16_f32 v101, v106, v107
  v_cvt_pk_bf16_f32 v102, v108, v109
  v_cvt_pk_bf16_f32 v103, v110, v111
  v_cvt_pk_bf16_f32 v104, v80, v81
  v_cvt_pk_bf16_f32 v105, v82, v83
  v_cvt_pk_bf16_f32 v106, v84, v85
  v_cvt_pk_bf16_f32 v107, v86, v87
  v_cvt_pk_bf16_f32 v108, v88, v89
  v_cvt_pk_bf16_f32 v109, v90, v91
  v_cvt_pk_bf16_f32 v110, v92, v93
  v_cvt_pk_bf16_f32 v111, v94, v95
  s_waitcnt lgkmcnt(10)
  v_mfma_f32_32x32x16_bf16 v[80:95], v[128:131], v[44:47], 0
  ds_read_b64_tr_b16 v[40:41], v11 offset:22784
  ds_read_b64_tr_b16 v[42:43], v11 offset:23296
  v_cvt_pk_bf16_f32 v112, v112, v113
  v_cvt_pk_bf16_f32 v113, v114, v115
  v_cvt_pk_bf16_f32 v114, v116, v117
  v_cvt_pk_bf16_f32 v115, v118, v119
  v_cvt_pk_bf16_f32 v116, v120, v121
  v_cvt_pk_bf16_f32 v117, v122, v123
  v_cvt_pk_bf16_f32 v118, v124, v125
  v_cvt_pk_bf16_f32 v119, v126, v127
  s_waitcnt lgkmcnt(10)
  v_mfma_f32_32x32x16_bf16 v[64:79], v[132:135], v[48:51], v[64:79]
  ds_read_b64_tr_b16 v[44:45], v11 offset:32768
  ds_read_b64_tr_b16 v[46:47], v11 offset:33280
  s_waitcnt lgkmcnt(10)
  v_mfma_f32_32x32x16_bf16 v[80:95], v[132:135], v[52:55], v[80:95]
  ds_read_b64_tr_b16 v[48:49], v11 offset:33024
  ds_read_b64_tr_b16 v[50:51], v11 offset:33536
  s_add_u32 s94, s99, 0
  buffer_store_dwordx4 v[24:27], v14, s[20:23], s94 offen offset:0 sc1
  ds_read_b128 v[120:123], v18 offset:0
  ds_read_b128 v[124:127], v18 offset:1152
  s_waitcnt lgkmcnt(12)
  v_mfma_f32_32x32x16_bf16 v[64:79], v[136:139], v[56:59], v[64:79]
  ds_read_b64_tr_b16 v[52:53], v11 offset:34816
  ds_read_b64_tr_b16 v[54:55], v11 offset:35328
  s_waitcnt lgkmcnt(12)
  v_mfma_f32_32x32x16_bf16 v[80:95], v[136:139], v[32:35], v[80:95]
  ds_read_b64_tr_b16 v[56:57], v11 offset:35072
  ds_read_b64_tr_b16 v[58:59], v11 offset:35584
  s_waitcnt lgkmcnt(12)
  v_mfma_f32_32x32x16_bf16 v[64:79], v[140:143], v[36:39], v[64:79]
  ds_read_b64_tr_b16 v[32:33], v11 offset:45056
  ds_read_b64_tr_b16 v[34:35], v11 offset:45568
  s_waitcnt lgkmcnt(6)
  s_and_b32 s94, s2, 7
  v_lshlrev_b32 v18, 2, s94
  v_mov_b32 v16, 0
  s_cmp_eq_u32 s3, 0
  s_cselect_b64 exec, 1, 0
  s_bfe_u32 s94, s2, 0x20003
  s_lshl_b32 s94, s94, 4
  s_add_u32 s94, s94, s92
  s_mul_i32 s94, s94, 4352
  s_add_u32 s94, s94, 2621440
  buffer_store_dword v16, v18, s[44:47], s94 offen sc1
  s_bfe_u32 s94, s2, 0x20003
  s_lshl_b32 s94, s94, 4
  s_add_u32 s94, s94, 15
  s_sub_u32 s94, s94, s92
  s_mul_i32 s94, s94, 4352
  s_add_u32 s94, s94, 2621440
  buffer_store_dword v16, v18, s[44:47], s94 offen sc1
  s_mov_b64 exec, -1
  buffer_store_dwordx4 v[120:123], v17, s[44:47], s101 offen sc1
  s_add_u32 s94, s101, 4096
  buffer_store_dwordx4 v[124:127], v19, s[44:47], s94 offen sc1
  v_mfma_f32_32x32x16_bf16 v[80:95], v[140:143], v[40:43], v[80:95]
  ds_read_b64_tr_b16 v[36:37], v11 offset:45312
  ds_read_b64_tr_b16 v[38:39], v11 offset:45824
  v_mfma_f32_32x32x16_bf16 v[64:79], v[144:147], v[44:47], v[64:79]
  ds_read_b64_tr_b16 v[40:41], v11 offset:47104
  ds_read_b64_tr_b16 v[42:43], v11 offset:47616
  v_mfma_f32_32x32x16_bf16 v[80:95], v[144:147], v[48:51], v[80:95]
  ds_read_b64_tr_b16 v[44:45], v11 offset:47360
  ds_read_b64_tr_b16 v[46:47], v11 offset:47872
  s_add_u32 s94, s99, 4096
  buffer_store_dwordx4 v[28:31], v14, s[20:23], s94 offen offset:0 sc1
  s_waitcnt lgkmcnt(10)
  v_mfma_f32_32x32x16_bf16 v[64:79], v[148:151], v[52:55], v[64:79]
  ds_read_b64_tr_b16 v[48:49], v11 offset:57344
  ds_read_b64_tr_b16 v[50:51], v11 offset:57856
  s_waitcnt lgkmcnt(10)
  v_mfma_f32_32x32x16_bf16 v[80:95], v[148:151], v[56:59], v[80:95]
  ds_read_b64_tr_b16 v[52:53], v11 offset:57600
  ds_read_b64_tr_b16 v[54:55], v11 offset:58112
  s_waitcnt lgkmcnt(10)
  v_mfma_f32_32x32x16_bf16 v[64:79], v[152:155], v[32:35], v[64:79]
  ds_read_b64_tr_b16 v[56:57], v11 offset:59392
  ds_read_b64_tr_b16 v[58:59], v11 offset:59904
  s_waitcnt lgkmcnt(10)
  v_mfma_f32_32x32x16_bf16 v[80:95], v[152:155], v[36:39], v[80:95]
  ds_read_b64_tr_b16 v[32:33], v11 offset:59648
  ds_read_b64_tr_b16 v[34:35], v11 offset:60160
  s_waitcnt lgkmcnt(10)
  v_mfma_f32_32x32x16_bf16 v[64:79], v[156:159], v[40:43], v[64:79]
  ds_read_b64_tr_b16 v[36:37], v12 offset:4096
  ds_read_b64_tr_b16 v[38:39], v12 offset:4608
  s_waitcnt lgkmcnt(10)
  v_mfma_f32_32x32x16_bf16 v[80:95], v[156:159], v[44:47], v[80:95]
  ds_read_b64_tr_b16 v[40:41], v12 offset:4352
  ds_read_b64_tr_b16 v[42:43], v12 offset:4864
  s_add_u32 s94, s99, 0
  buffer_store_dwordx4 v[104:107], v14, s[20:23], s94 offen offset:1024 sc1
  s_waitcnt lgkmcnt(10)
  v_mfma_f32_32x32x16_bf16 v[64:79], v[160:163], v[48:51], v[64:79]
  ds_read_b64_tr_b16 v[44:45], v12 offset:6144
  ds_read_b64_tr_b16 v[46:47], v12 offset:6656
  s_waitcnt lgkmcnt(10)
  v_mfma_f32_32x32x16_bf16 v[80:95], v[160:163], v[52:55], v[80:95]
  ds_read_b64_tr_b16 v[48:49], v12 offset:6400
  ds_read_b64_tr_b16 v[50:51], v12 offset:6912
  s_waitcnt lgkmcnt(10)
  v_mfma_f32_32x32x16_bf16 v[64:79], v[164:167], v[56:59], v[64:79]
  ds_read_b64_tr_b16 v[52:53], v12 offset:16384
  ds_read_b64_tr_b16 v[54:55], v12 offset:16896
  s_waitcnt lgkmcnt(10)
  v_mfma_f32_32x32x16_bf16 v[80:95], v[164:167], v[32:35], v[80:95]
  ds_read_b64_tr_b16 v[56:57], v12 offset:16640
  ds_read_b64_tr_b16 v[58:59], v12 offset:17152
  s_waitcnt lgkmcnt(10)
  v_mfma_f32_32x32x16_bf16 v[64:79], v[168:171], v[36:39], v[64:79]
  ds_read_b64_tr_b16 v[32:33], v12 offset:18432
  ds_read_b64_tr_b16 v[34:35], v12 offset:18944
  s_waitcnt lgkmcnt(10)
  v_mfma_f32_32x32x16_bf16 v[80:95], v[168:171], v[40:43], v[80:95]
  ds_read_b64_tr_b16 v[36:37], v12 offset:18688
  ds_read_b64_tr_b16 v[38:39], v12 offset:19200
  s_add_u32 s94, s99, 4096
  buffer_store_dwordx4 v[108:111], v14, s[20:23], s94 offen offset:1024 sc1
  s_waitcnt lgkmcnt(10)
  v_mfma_f32_32x32x16_bf16 v[64:79], v[172:175], v[44:47], v[64:79]
  ds_read_b64_tr_b16 v[40:41], v12 offset:28672
  ds_read_b64_tr_b16 v[42:43], v12 offset:29184
  v_mov_b32 v16, v60
  v_lshrrev_b32 v17, 2, v0
  v_mov_b32 v18, 0x02020202
  v_cmp_eq_u32 vcc, s92, v17
  s_nop 1
  v_cndmask_b32 v19, 0, v18, vcc
  s_sub_u32 s94, 15, s92
  v_cmp_eq_u32 vcc, s94, v17
  s_nop 1
  v_cndmask_b32 v19, v19, v18, vcc
  s_cmp_lt_u32 s3, 4
  s_cselect_b32 s74, s92, s94
  s_lshl_b32 s74, s74, 2
  s_and_b32 s94, s3, 3
  s_add_u32 s74, s74, s94
  s_lshl_b32 s75, s74, 2
  s_mul_i32 s74, s74, 40960
  s_waitcnt lgkmcnt(10)
  v_mfma_f32_32x32x16_bf16 v[80:95], v[172:175], v[48:51], v[80:95]
  ds_read_b64_tr_b16 v[44:45], v12 offset:28928
  ds_read_b64_tr_b16 v[46:47], v12 offset:29440
  s_lshr_b32 s94, s72, 4
  v_cmp_eq_u32 vcc, s94, v17
  v_add_u32 v18, v18, v18
  s_nop 0
  v_cndmask_b32 v20, 0, v18, vcc
  v_lshlrev_b32 v18, 2, v0
  s_mov_b32 s70, s58
  s_waitcnt lgkmcnt(10)
  v_mfma_f32_32x32x16_bf16 v[64:79], v[176:179], v[52:55], v[64:79]
  ds_read_b64_tr_b16 v[48:49], v12 offset:30720
  ds_read_b64_tr_b16 v[50:51], v12 offset:31232
  s_waitcnt lgkmcnt(10)
  v_mfma_f32_32x32x16_bf16 v[80:95], v[176:179], v[56:59], v[80:95]
  ds_read_b64_tr_b16 v[52:53], v12 offset:30976
  ds_read_b64_tr_b16 v[54:55], v12 offset:31488
  s_waitcnt lgkmcnt(10)
  v_mfma_f32_32x32x16_bf16 v[64:79], v[180:183], v[32:35], v[64:79]
  s_waitcnt lgkmcnt(8)
  v_mfma_f32_32x32x16_bf16 v[80:95], v[180:183], v[36:39], v[80:95]
  s_add_u32 s94, s99, 0
  buffer_store_dwordx4 v[96:99], v14, s[20:23], s94 offen offset:2048 sc1
  s_waitcnt lgkmcnt(6)
  v_mfma_f32_32x32x16_bf16 v[64:79], v[184:187], v[40:43], v[64:79]
  s_waitcnt vmcnt(4) lgkmcnt(0)
  s_barrier
  v_mov_b32 v21, 3
  buffer_store_byte v21, v60, s[56:59], 0 offen sc1
  ds_read_b64_tr_b16 v[56:57], v11 offset:0
  ds_read_b64_tr_b16 v[58:59], v11 offset:512
  ds_read_b64_tr_b16 v[32:33], v11 offset:256
  ds_read_b64_tr_b16 v[34:35], v11 offset:768
  ds_read_b64_tr_b16 v[36:37], v11 offset:2048
  ds_read_b64_tr_b16 v[38:39], v11 offset:2560
  s_lshl_b32 m0, s3, 12
  s_add_u32 m0, m0, 131072
  s_add_u32 s94, s98, 2097280
  buffer_load_dwordx4 v5, s[12:15], s94 offen lds
  v_mfma_f32_32x32x16_bf16 v[80:95], v[184:187], v[44:47], v[80:95]
  ds_read_b64_tr_b16 v[40:41], v11 offset:2304
  ds_read_b64_tr_b16 v[42:43], v11 offset:2816
  s_lshl_b32 m0, s3, 12
  s_add_u32 m0, m0, 132096
  s_add_u32 s94, s98, 2162816
  buffer_load_dwordx4 v5, s[12:15], s94 offen lds
  v_mfma_f32_32x32x16_bf16 v[64:79], v[188:191], v[48:51], v[64:79]
  ds_read_b64_tr_b16 v[44:45], v11 offset:12288
  ds_read_b64_tr_b16 v[46:47], v11 offset:12800
  s_lshl_b32 m0, s3, 12
  s_add_u32 m0, m0, 133120
  s_add_u32 s94, s98, 2228352
  buffer_load_dwordx4 v5, s[12:15], s94 offen lds
  v_mfma_f32_32x32x16_bf16 v[80:95], v[188:191], v[52:55], v[80:95]
  ds_read_b64_tr_b16 v[48:49], v11 offset:12544
  ds_read_b64_tr_b16 v[50:51], v11 offset:13056
  s_lshl_b32 m0, s3, 12
  s_add_u32 m0, m0, 134144
  s_add_u32 s94, s98, 2293888
  buffer_load_dwordx4 v5, s[12:15], s94 offen lds
  s_waitcnt lgkmcnt(10)
  v_mfma_f32_32x32x16_bf16 v[64:79], v[192:195], v[56:59], v[64:79]
  ds_read_b64_tr_b16 v[52:53], v11 offset:14336
  ds_read_b64_tr_b16 v[54:55], v11 offset:14848
  s_waitcnt lgkmcnt(10)
  v_mfma_f32_32x32x16_bf16 v[80:95], v[192:195], v[32:35], v[80:95]
  ds_read_b64_tr_b16 v[56:57], v11 offset:14592
  ds_read_b64_tr_b16 v[58:59], v11 offset:15104
  s_add_u32 s94, s99, 4096
  buffer_store_dwordx4 v[100:103], v14, s[20:23], s94 offen offset:2048 sc1
  s_waitcnt lgkmcnt(10)
  v_mfma_f32_32x32x16_bf16 v[64:79], v[196:199], v[36:39], v[64:79]
  ds_read_b64_tr_b16 v[32:33], v11 offset:24576
  ds_read_b64_tr_b16 v[34:35], v11 offset:25088
  s_waitcnt lgkmcnt(10)
  v_mfma_f32_32x32x16_bf16 v[80:95], v[196:199], v[40:43], v[80:95]
  ds_read_b64_tr_b16 v[36:37], v11 offset:24832
  ds_read_b64_tr_b16 v[38:39], v11 offset:25344
  s_waitcnt lgkmcnt(10)
  v_mfma_f32_32x32x16_bf16 v[64:79], v[200:203], v[44:47], v[64:79]
  ds_read_b64_tr_b16 v[40:41], v11 offset:26624
  ds_read_b64_tr_b16 v[42:43], v11 offset:27136
  s_waitcnt lgkmcnt(10)
  v_mfma_f32_32x32x16_bf16 v[80:95], v[200:203], v[48:51], v[80:95]
  ds_read_b64_tr_b16 v[44:45], v11 offset:26880
  ds_read_b64_tr_b16 v[46:47], v11 offset:27392
  s_waitcnt lgkmcnt(10)
  v_mfma_f32_32x32x16_bf16 v[64:79], v[204:207], v[52:55], v[64:79]
  ds_read_b64_tr_b16 v[48:49], v11 offset:36864
  ds_read_b64_tr_b16 v[50:51], v11 offset:37376
  s_waitcnt lgkmcnt(10)
  v_mfma_f32_32x32x16_bf16 v[80:95], v[204:207], v[56:59], v[80:95]
  ds_read_b64_tr_b16 v[52:53], v11 offset:37120
  ds_read_b64_tr_b16 v[54:55], v11 offset:37632
  s_add_u32 s94, s99, 0
  buffer_store_dwordx4 v[112:115], v14, s[20:23], s94 offen offset:3072 sc1
  s_waitcnt lgkmcnt(10)
  v_mfma_f32_32x32x16_bf16 v[64:79], v[208:211], v[32:35], v[64:79]
  ds_read_b64_tr_b16 v[56:57], v11 offset:38912
  ds_read_b64_tr_b16 v[58:59], v11 offset:39424
  s_waitcnt lgkmcnt(10)
  v_mfma_f32_32x32x16_bf16 v[80:95], v[208:211], v[36:39], v[80:95]
  ds_read_b64_tr_b16 v[32:33], v11 offset:39168
  ds_read_b64_tr_b16 v[34:35], v11 offset:39680
  s_waitcnt lgkmcnt(10)
  v_mfma_f32_32x32x16_bf16 v[64:79], v[212:215], v[40:43], v[64:79]
  ds_read_b64_tr_b16 v[36:37], v11 offset:49152
  ds_read_b64_tr_b16 v[38:39], v11 offset:49664
  s_waitcnt lgkmcnt(10)
  v_mfma_f32_32x32x16_bf16 v[80:95], v[212:215], v[44:47], v[80:95]
  ds_read_b64_tr_b16 v[40:41], v11 offset:49408
  ds_read_b64_tr_b16 v[42:43], v11 offset:49920
  s_waitcnt lgkmcnt(10)
  v_mfma_f32_32x32x16_bf16 v[64:79], v[216:219], v[48:51], v[64:79]
  ds_read_b64_tr_b16 v[44:45], v11 offset:51200
  ds_read_b64_tr_b16 v[46:47], v11 offset:51712
  s_waitcnt lgkmcnt(10)
  v_mfma_f32_32x32x16_bf16 v[80:95], v[216:219], v[52:55], v[80:95]
  ds_read_b64_tr_b16 v[48:49], v11 offset:51456
  ds_read_b64_tr_b16 v[50:51], v11 offset:51968
  s_add_u32 s94, s99, 4096
  buffer_store_dwordx4 v[116:119], v14, s[20:23], s94 offen offset:3072 sc1
  s_waitcnt lgkmcnt(10)
  v_mfma_f32_32x32x16_bf16 v[64:79], v[220:223], v[56:59], v[64:79]
  ds_read_b64_tr_b16 v[52:53], v11 offset:61440
  ds_read_b64_tr_b16 v[54:55], v11 offset:61952
  s_waitcnt lgkmcnt(10)
  v_mfma_f32_32x32x16_bf16 v[80:95], v[220:223], v[32:35], v[80:95]
  ds_read_b64_tr_b16 v[56:57], v11 offset:61696
  ds_read_b64_tr_b16 v[58:59], v11 offset:62208
  s_waitcnt lgkmcnt(10)
  v_mfma_f32_32x32x16_bf16 v[64:79], v[224:227], v[36:39], v[64:79]
  ds_read_b64_tr_b16 v[32:33], v11 offset:63488
  ds_read_b64_tr_b16 v[34:35], v11 offset:64000
  s_waitcnt lgkmcnt(10)
  v_mfma_f32_32x32x16_bf16 v[80:95], v[224:227], v[40:43], v[80:95]
  ds_read_b64_tr_b16 v[36:37], v11 offset:63744
  ds_read_b64_tr_b16 v[38:39], v11 offset:64256
  s_waitcnt lgkmcnt(10)
  v_mfma_f32_32x32x16_bf16 v[64:79], v[228:231], v[44:47], v[64:79]
  ds_read_b64_tr_b16 v[40:41], v12 offset:8192
  ds_read_b64_tr_b16 v[42:43], v12 offset:8704
  s_waitcnt lgkmcnt(10)
  v_mfma_f32_32x32x16_bf16 v[80:95], v[228:231], v[48:51], v[80:95]
  ds_read_b64_tr_b16 v[44:45], v12 offset:8448
  ds_read_b64_tr_b16 v[46:47], v12 offset:8960
  s_waitcnt lgkmcnt(10)
  v_mfma_f32_32x32x16_bf16 v[64:79], v[232:235], v[52:55], v[64:79]
  ds_read_b64_tr_b16 v[48:49], v12 offset:10240
  ds_read_b64_tr_b16 v[50:51], v12 offset:10752
  s_waitcnt lgkmcnt(10)
  v_mfma_f32_32x32x16_bf16 v[80:95], v[232:235], v[56:59], v[80:95]
  ds_read_b64_tr_b16 v[52:53], v12 offset:10496
  ds_read_b64_tr_b16 v[54:55], v12 offset:11008
  s_waitcnt lgkmcnt(10)
  v_mfma_f32_32x32x16_bf16 v[64:79], v[236:239], v[32:35], v[64:79]
  ds_read_b64_tr_b16 v[56:57], v12 offset:20480
  ds_read_b64_tr_b16 v[58:59], v12 offset:20992
  s_waitcnt lgkmcnt(10)
  v_mfma_f32_32x32x16_bf16 v[80:95], v[236:239], v[36:39], v[80:95]
  ds_read_b64_tr_b16 v[32:33], v12 offset:20736
  ds_read_b64_tr_b16 v[34:35], v12 offset:21248
  s_waitcnt lgkmcnt(10)
  v_mfma_f32_32x32x16_bf16 v[64:79], v[240:243], v[40:43], v[64:79]
  ds_read_b64_tr_b16 v[36:37], v12 offset:22528
  ds_read_b64_tr_b16 v[38:39], v12 offset:23040
  s_waitcnt lgkmcnt(10)
  v_mfma_f32_32x32x16_bf16 v[80:95], v[240:243], v[44:47], v[80:95]
  ds_read_b64_tr_b16 v[40:41], v12 offset:22784
  ds_read_b64_tr_b16 v[42:43], v12 offset:23296
  s_waitcnt lgkmcnt(10)
  v_mfma_f32_32x32x16_bf16 v[64:79], v[244:247], v[48:51], v[64:79]
  s_waitcnt lgkmcnt(8)
  v_mfma_f32_32x32x16_bf16 v[80:95], v[244:247], v[52:55], v[80:95]
  s_waitcnt lgkmcnt(6)
  v_mfma_f32_32x32x16_bf16 v[64:79], v[248:251], v[56:59], v[64:79]
  s_waitcnt vmcnt(17)
  s_barrier
  ds_read_b64_tr_b16 v[44:45], v11 offset:4096
  ds_read_b64_tr_b16 v[46:47], v11 offset:4608
  ds_read_b64_tr_b16 v[48:49], v11 offset:4352
  ds_read_b64_tr_b16 v[50:51], v11 offset:4864
  ds_read_b64_tr_b16 v[52:53], v11 offset:6144
  ds_read_b64_tr_b16 v[54:55], v11 offset:6656
  s_waitcnt lgkmcnt(10)
  v_mfma_f32_32x32x16_bf16 v[80:95], v[248:251], v[32:35], v[80:95]
  ds_read_b64_tr_b16 v[56:57], v11 offset:6400
  ds_read_b64_tr_b16 v[58:59], v11 offset:6912
  s_waitcnt lgkmcnt(10)
  v_mfma_f32_32x32x16_bf16 v[64:79], v[252:255], v[36:39], v[64:79]
  ds_read_b64_tr_b16 v[32:33], v11 offset:16384
  ds_read_b64_tr_b16 v[34:35], v11 offset:16896
  s_waitcnt lgkmcnt(10)
  v_mfma_f32_32x32x16_bf16 v[80:95], v[252:255], v[40:43], v[80:95]
  ds_read_b64_tr_b16 v[36:37], v11 offset:16640
  ds_read_b64_tr_b16 v[38:39], v11 offset:17152
  s_waitcnt lgkmcnt(10)
  v_mfma_f32_32x32x16_bf16 v[96:111], v[128:131], v[44:47], 0
  ds_read_b64_tr_b16 v[40:41], v11 offset:18432
  ds_read_b64_tr_b16 v[42:43], v11 offset:18944
  s_waitcnt lgkmcnt(10)
  v_mfma_f32_32x32x16_bf16 v[112:127], v[128:131], v[48:51], 0
  ds_read_b64_tr_b16 v[44:45], v11 offset:18688
  ds_read_b64_tr_b16 v[46:47], v11 offset:19200
  s_waitcnt lgkmcnt(10)
  v_mfma_f32_32x32x16_bf16 v[96:111], v[132:135], v[52:55], v[96:111]
  ds_read_b64_tr_b16 v[48:49], v11 offset:28672
  ds_read_b64_tr_b16 v[50:51], v11 offset:29184
  v_cvt_pk_bf16_f32 v64, v64, v65
  v_cvt_pk_bf16_f32 v65, v66, v67
  v_cvt_pk_bf16_f32 v66, v68, v69
  v_cvt_pk_bf16_f32 v67, v70, v71
  s_waitcnt lgkmcnt(10)
  v_mfma_f32_32x32x16_bf16 v[112:127], v[132:135], v[56:59], v[112:127]
  ds_read_b64_tr_b16 v[52:53], v11 offset:28928
  ds_read_b64_tr_b16 v[54:55], v11 offset:29440
  v_cvt_pk_bf16_f32 v68, v72, v73
  v_cvt_pk_bf16_f32 v69, v74, v75
  v_cvt_pk_bf16_f32 v70, v76, v77
  v_cvt_pk_bf16_f32 v71, v78, v79
  s_waitcnt lgkmcnt(10)
  v_mfma_f32_32x32x16_bf16 v[96:111], v[136:139], v[32:35], v[96:111]
  ds_read_b64_tr_b16 v[56:57], v11 offset:30720
  ds_read_b64_tr_b16 v[58:59], v11 offset:31232
  v_cvt_pk_bf16_f32 v72, v80, v81
  v_cvt_pk_bf16_f32 v73, v82, v83
  v_cvt_pk_bf16_f32 v74, v84, v85
  v_cvt_pk_bf16_f32 v75, v86, v87
  s_waitcnt lgkmcnt(10)
  v_mfma_f32_32x32x16_bf16 v[112:127], v[136:139], v[36:39], v[112:127]
  ds_read_b64_tr_b16 v[32:33], v11 offset:30976
  ds_read_b64_tr_b16 v[34:35], v11 offset:31488
  v_cvt_pk_bf16_f32 v76, v88, v89
  v_cvt_pk_bf16_f32 v77, v90, v91
  v_cvt_pk_bf16_f32 v78, v92, v93
  v_cvt_pk_bf16_f32 v79, v94, v95
  s_waitcnt lgkmcnt(10)
  v_mfma_f32_32x32x16_bf16 v[96:111], v[140:143], v[40:43], v[96:111]
  ds_read_b64_tr_b16 v[36:37], v11 offset:40960
  ds_read_b64_tr_b16 v[38:39], v11 offset:41472
  s_waitcnt lgkmcnt(10)
  v_mfma_f32_32x32x16_bf16 v[112:127], v[140:143], v[44:47], v[112:127]
  ds_read_b64_tr_b16 v[40:41], v11 offset:41216
  ds_read_b64_tr_b16 v[42:43], v11 offset:41728
  s_add_u32 s94, s89, 0
  buffer_store_dwordx4 v[64:67], v14, s[20:23], s94 offen offset:0 sc1
  s_waitcnt lgkmcnt(10)
  v_mfma_f32_32x32x16_bf16 v[96:111], v[144:147], v[48:51], v[96:111]
  ds_read_b64_tr_b16 v[44:45], v11 offset:43008
  ds_read_b64_tr_b16 v[46:47], v11 offset:43520
  buffer_load_dword v17, v18, s[68:71], 0 offen sc1
  s_waitcnt lgkmcnt(10)
  v_mfma_f32_32x32x16_bf16 v[112:127], v[144:147], v[52:55], v[112:127]
  ds_read_b64_tr_b16 v[48:49], v11 offset:43264
  ds_read_b64_tr_b16 v[50:51], v11 offset:43776
  s_waitcnt lgkmcnt(10)
  v_mfma_f32_32x32x16_bf16 v[96:111], v[148:151], v[56:59], v[96:111]
  ds_read_b64_tr_b16 v[52:53], v11 offset:53248
  ds_read_b64_tr_b16 v[54:55], v11 offset:53760
  s_waitcnt lgkmcnt(10)
  v_mfma_f32_32x32x16_bf16 v[112:127], v[148:151], v[32:35], v[112:127]
  ds_read_b64_tr_b16 v[56:57], v11 offset:53504
  ds_read_b64_tr_b16 v[58:59], v11 offset:54016
  s_waitcnt lgkmcnt(10)
  v_mfma_f32_32x32x16_bf16 v[96:111], v[152:155], v[36:39], v[96:111]
  ds_read_b64_tr_b16 v[32:33], v11 offset:55296
  ds_read_b64_tr_b16 v[34:35], v11 offset:55808
  s_waitcnt lgkmcnt(10)
  v_mfma_f32_32x32x16_bf16 v[112:127], v[152:155], v[40:43], v[112:127]
  ds_read_b64_tr_b16 v[36:37], v11 offset:55552
  ds_read_b64_tr_b16 v[38:39], v11 offset:56064
  s_waitcnt lgkmcnt(10)
  v_mfma_f32_32x32x16_bf16 v[96:111], v[156:159], v[44:47], v[96:111]
  ds_read_b64_tr_b16 v[40:41], v12 offset:0
  ds_read_b64_tr_b16 v[42:43], v12 offset:512
  s_waitcnt lgkmcnt(10)
  v_mfma_f32_32x32x16_bf16 v[112:127], v[156:159], v[48:51], v[112:127]
  ds_read_b64_tr_b16 v[44:45], v12 offset:256
  ds_read_b64_tr_b16 v[46:47], v12 offset:768
  s_waitcnt lgkmcnt(10)
  v_mfma_f32_32x32x16_bf16 v[96:111], v[160:163], v[52:55], v[96:111]
  ds_read_b64_tr_b16 v[48:49], v12 offset:2048
  ds_read_b64_tr_b16 v[50:51], v12 offset:2560
  s_waitcnt lgkmcnt(10)
  v_mfma_f32_32x32x16_bf16 v[112:127], v[160:163], v[56:59], v[112:127]
  ds_read_b64_tr_b16 v[52:53], v12 offset:2304
  ds_read_b64_tr_b16 v[54:55], v12 offset:2816
  s_waitcnt lgkmcnt(10)
  v_mfma_f32_32x32x16_bf16 v[96:111], v[164:167], v[32:35], v[96:111]
  ds_read_b64_tr_b16 v[56:57], v12 offset:12288
  ds_read_b64_tr_b16 v[58:59], v12 offset:12800
  s_waitcnt lgkmcnt(10)
  v_mfma_f32_32x32x16_bf16 v[112:127], v[164:167], v[36:39], v[112:127]
  ds_read_b64_tr_b16 v[32:33], v12 offset:12544
  ds_read_b64_tr_b16 v[34:35], v12 offset:13056
  s_add_u32 s94, s89, 4096
  buffer_store_dwordx4 v[68:71], v14, s[20:23], s94 offen offset:0 sc1
  s_waitcnt lgkmcnt(10)
  v_mfma_f32_32x32x16_bf16 v[96:111], v[168:171], v[40:43], v[96:111]
  ds_read_b64_tr_b16 v[36:37], v12 offset:14336
  ds_read_b64_tr_b16 v[38:39], v12 offset:14848
  s_waitcnt lgkmcnt(10)
  v_mfma_f32_32x32x16_bf16 v[112:127], v[168:171], v[44:47], v[112:127]
  ds_read_b64_tr_b16 v[40:41], v12 offset:14592
  ds_read_b64_tr_b16 v[42:43], v12 offset:15104
  s_waitcnt lgkmcnt(10)
  v_mfma_f32_32x32x16_bf16 v[96:111], v[172:175], v[48:51], v[96:111]
  ds_read_b64_tr_b16 v[44:45], v12 offset:24576
  ds_read_b64_tr_b16 v[46:47], v12 offset:25088
  s_waitcnt lgkmcnt(10)
  v_mfma_f32_32x32x16_bf16 v[112:127], v[172:175], v[52:55], v[112:127]
  ds_read_b64_tr_b16 v[48:49], v12 offset:24832
  ds_read_b64_tr_b16 v[50:51], v12 offset:25344
  s_waitcnt lgkmcnt(10)
  v_mfma_f32_32x32x16_bf16 v[96:111], v[176:179], v[56:59], v[96:111]
  ds_read_b64_tr_b16 v[52:53], v12 offset:26624
  ds_read_b64_tr_b16 v[54:55], v12 offset:27136
  s_waitcnt lgkmcnt(10)
  v_mfma_f32_32x32x16_bf16 v[112:127], v[176:179], v[32:35], v[112:127]
  ds_read_b64_tr_b16 v[56:57], v12 offset:26880
  ds_read_b64_tr_b16 v[58:59], v12 offset:27392
  s_waitcnt lgkmcnt(10)
  v_mfma_f32_32x32x16_bf16 v[96:111], v[180:183], v[36:39], v[96:111]
  s_waitcnt lgkmcnt(8)
  v_mfma_f32_32x32x16_bf16 v[112:127], v[180:183], v[40:43], v[112:127]
  s_waitcnt lgkmcnt(6)
  v_mfma_f32_32x32x16_bf16 v[96:111], v[184:187], v[44:47], v[96:111]
  s_cmp_lg_u32 s3, 0
  s_cbranch_scc1 kva_kernel_hok_16
  s_waitcnt vmcnt(1)
  v_and_b32 v17, v17, v19
  v_cmp_ne_u32 vcc, v17, v19
  s_cbranch_vccnz kva_kernel_hsp_15
kva_kernel_hok_16:
  s_waitcnt vmcnt(6) lgkmcnt(0)
  s_barrier
  ds_read_b64_tr_b16 v[32:33], v13 offset:0
  ds_read_b64_tr_b16 v[34:35], v13 offset:512
  ds_read_b64_tr_b16 v[36:37], v13 offset:256
  ds_read_b64_tr_b16 v[38:39], v13 offset:768
  ds_read_b64_tr_b16 v[40:41], v13 offset:2048
  ds_read_b64_tr_b16 v[42:43], v13 offset:2560
  s_sub_u32 m0, s97, 65536
  s_mov_b32 s94, 0
  buffer_load_dwordx4 v4, s[76:79], s94 offen lds
  v_mfma_f32_32x32x16_bf16 v[112:127], v[184:187], v[48:51], v[112:127]
  ds_read_b64_tr_b16 v[44:45], v13 offset:2304
  ds_read_b64_tr_b16 v[46:47], v13 offset:2816
  s_sub_u32 m0, s97, 64512
  s_mov_b32 s94, 32768
  buffer_load_dwordx4 v4, s[76:79], s94 offen lds
  v_mfma_f32_32x32x16_bf16 v[96:111], v[188:191], v[52:55], v[96:111]
  ds_read_b64_tr_b16 v[48:49], v13 offset:4096
  ds_read_b64_tr_b16 v[50:51], v13 offset:4608
  s_add_u32 s94, s74, 0
  buffer_load_dwordx4 v[128:131], v14, s[44:47], s94 offen offset:0
  v_mfma_f32_32x32x16_bf16 v[112:127], v[188:191], v[56:59], v[112:127]
  ds_read_b64_tr_b16 v[52:53], v13 offset:4352
  ds_read_b64_tr_b16 v[54:55], v13 offset:4864
  s_add_u32 s94, s74, 0
  buffer_load_dwordx4 v[132:135], v14, s[44:47], s94 offen offset:1024
  s_add_u32 s94, s89, 0
  buffer_store_dwordx4 v[72:75], v14, s[20:23], s94 offen offset:1024 sc1
  s_waitcnt lgkmcnt(10)
  v_mfma_f32_32x32x16_bf16 v[96:111], v[192:195], v[32:35], v[96:111]
  ds_read_b64_tr_b16 v[56:57], v13 offset:6144
  ds_read_b64_tr_b16 v[58:59], v13 offset:6656
  s_add_u32 s94, s74, 0
  buffer_load_dwordx4 v[136:139], v14, s[44:47], s94 offen offset:2048
  s_waitcnt lgkmcnt(10)
  v_mfma_f32_32x32x16_bf16 v[112:127], v[192:195], v[36:39], v[112:127]
  ds_read_b64_tr_b16 v[32:33], v13 offset:6400
  ds_read_b64_tr_b16 v[34:35], v13 offset:6912
  s_add_u32 s94, s74, 0
  buffer_load_dwordx4 v[140:143], v14, s[44:47], s94 offen offset:3072
  s_waitcnt lgkmcnt(10)
  v_mfma_f32_32x32x16_bf16 v[96:111], v[196:199], v[40:43], v[96:111]
  ds_read_b64_tr_b16 v[36:37], v13 offset:8192
  ds_read_b64_tr_b16 v[38:39], v13 offset:8704
  s_sub_u32 m0, s97, 49152
  s_mov_b32 s94, 524288
  buffer_load_dwordx4 v4, s[76:79], s94 offen lds
  s_waitcnt lgkmcnt(10)
  v_mfma_f32_32x32x16_bf16 v[112:127], v[196:199], v[44:47], v[112:127]
  ds_read_b64_tr_b16 v[40:41], v13 offset:8448
  ds_read_b64_tr_b16 v[42:43], v13 offset:8960
  s_sub_u32 m0, s97, 48128
  s_mov_b32 s94, 557056
  buffer_load_dwordx4 v4, s[76:79], s94 offen lds
  s_waitcnt lgkmcnt(10)
  v_mfma_f32_32x32x16_bf16 v[96:111], v[200:203], v[48:51], v[96:111]
  ds_read_b64_tr_b16 v[44:45], v13 offset:10240
  ds_read_b64_tr_b16 v[46:47], v13 offset:10752
  s_add_u32 s94, s74, 4096
  buffer_load_dwordx4 v[144:147], v14, s[44:47], s94 offen offset:0
  s_waitcnt lgkmcnt(10)
  v_mfma_f32_32x32x16_bf16 v[112:127], v[200:203], v[52:55], v[112:127]
  ds_read_b64_tr_b16 v[48:49], v13 offset:10496
  ds_read_b64_tr_b16 v[50:51], v13 offset:11008
  s_add_u32 s94, s74, 4096
  buffer_load_dwordx4 v[148:151], v14, s[44:47], s94 offen offset:1024
  s_waitcnt lgkmcnt(10)
  v_mfma_f32_32x32x16_bf16 v[96:111], v[204:207], v[56:59], v[96:111]
  ds_read_b64_tr_b16 v[52:53], v13 offset:12288
  ds_read_b64_tr_b16 v[54:55], v13 offset:12800
  s_add_u32 s94, s74, 4096
  buffer_load_dwordx4 v[152:155], v14, s[44:47], s94 offen offset:2048
  s_waitcnt lgkmcnt(10)
  v_mfma_f32_32x32x16_bf16 v[112:127], v[204:207], v[32:35], v[112:127]
  ds_read_b64_tr_b16 v[56:57], v13 offset:12544
  ds_read_b64_tr_b16 v[58:59], v13 offset:13056
  s_add_u32 s94, s74, 4096
  buffer_load_dwordx4 v[156:159], v14, s[44:47], s94 offen offset:3072
  s_waitcnt lgkmcnt(10)
  v_mfma_f32_32x32x16_bf16 v[96:111], v[208:211], v[36:39], v[96:111]
  ds_read_b64_tr_b16 v[32:33], v13 offset:14336
  ds_read_b64_tr_b16 v[34:35], v13 offset:14848
  s_sub_u32 m0, s97, 32768
  s_mov_b32 s94, 1048576
  buffer_load_dwordx4 v4, s[76:79], s94 offen lds
  s_waitcnt lgkmcnt(10)
  v_mfma_f32_32x32x16_bf16 v[112:127], v[208:211], v[40:43], v[112:127]
  ds_read_b64_tr_b16 v[36:37], v13 offset:14592
  ds_read_b64_tr_b16 v[38:39], v13 offset:15104
  s_sub_u32 m0, s97, 31744
  s_mov_b32 s94, 1081344
  buffer_load_dwordx4 v4, s[76:79], s94 offen lds
  s_waitcnt lgkmcnt(10)
  v_mfma_f32_32x32x16_bf16 v[96:111], v[212:215], v[44:47], v[96:111]
  ds_read_b64_tr_b16 v[40:41], v13 offset:16384
  ds_read_b64_tr_b16 v[42:43], v13 offset:16896
  s_add_u32 s94, s74, 8192
  buffer_load_dwordx4 v[160:163], v14, s[44:47], s94 offen offset:0
  s_waitcnt lgkmcnt(10)
  v_mfma_f32_32x32x16_bf16 v[112:127], v[212:215], v[48:51], v[112:127]
  ds_read_b64_tr_b16 v[44:45], v13 offset:16640
  ds_read_b64_tr_b16 v[46:47], v13 offset:17152
  s_add_u32 s94, s74, 8192
  buffer_load_dwordx4 v[164:167], v14, s[44:47], s94 offen offset:1024
  s_add_u32 s94, s89, 4096
  buffer_store_dwordx4 v[76:79], v14, s[20:23], s94 offen offset:1024 sc1
  s_waitcnt lgkmcnt(10)
  v_mfma_f32_32x32x16_bf16 v[96:111], v[216:219], v[52:55], v[96:111]
  ds_read_b64_tr_b16 v[48:49], v13 offset:18432
  ds_read_b64_tr_b16 v[50:51], v13 offset:18944
  s_add_u32 s94, s74, 8192
  buffer_load_dwordx4 v[168:171], v14, s[44:47], s94 offen offset:2048
  s_waitcnt lgkmcnt(10)
  v_mfma_f32_32x32x16_bf16 v[112:127], v[216:219], v[56:59], v[112:127]
  ds_read_b64_tr_b16 v[52:53], v13 offset:18688
  ds_read_b64_tr_b16 v[54:55], v13 offset:19200
  s_add_u32 s94, s74, 8192
  buffer_load_dwordx4 v[172:175], v14, s[44:47], s94 offen offset:3072
  s_waitcnt lgkmcnt(10)
  v_mfma_f32_32x32x16_bf16 v[96:111], v[220:223], v[32:35], v[96:111]
  ds_read_b64_tr_b16 v[56:57], v13 offset:20480
  ds_read_b64_tr_b16 v[58:59], v13 offset:20992
  s_waitcnt lgkmcnt(10)
  v_mfma_f32_32x32x16_bf16 v[112:127], v[220:223], v[36:39], v[112:127]
  ds_read_b64_tr_b16 v[32:33], v13 offset:20736
  ds_read_b64_tr_b16 v[34:35], v13 offset:21248
  s_waitcnt lgkmcnt(10)
  v_mfma_f32_32x32x16_bf16 v[96:111], v[224:227], v[40:43], v[96:111]
  ds_read_b64_tr_b16 v[36:37], v13 offset:22528
  ds_read_b64_tr_b16 v[38:39], v13 offset:23040
  s_waitcnt lgkmcnt(10)
  v_mfma_f32_32x32x16_bf16 v[112:127], v[224:227], v[44:47], v[112:127]
  ds_read_b64_tr_b16 v[40:41], v13 offset:22784
  ds_read_b64_tr_b16 v[42:43], v13 offset:23296
  s_waitcnt lgkmcnt(10)
  v_mfma_f32_32x32x16_bf16 v[96:111], v[228:231], v[48:51], v[96:111]
  ds_read_b64_tr_b16 v[44:45], v13 offset:24576
  ds_read_b64_tr_b16 v[46:47], v13 offset:25088
  s_waitcnt lgkmcnt(10)
  v_mfma_f32_32x32x16_bf16 v[112:127], v[228:231], v[52:55], v[112:127]
  ds_read_b64_tr_b16 v[48:49], v13 offset:24832
  ds_read_b64_tr_b16 v[50:51], v13 offset:25344
  s_waitcnt lgkmcnt(10)
  v_mfma_f32_32x32x16_bf16 v[96:111], v[232:235], v[56:59], v[96:111]
  ds_read_b64_tr_b16 v[52:53], v13 offset:26624
  ds_read_b64_tr_b16 v[54:55], v13 offset:27136
  s_waitcnt lgkmcnt(10)
  v_mfma_f32_32x32x16_bf16 v[112:127], v[232:235], v[32:35], v[112:127]
  ds_read_b64_tr_b16 v[56:57], v13 offset:26880
  ds_read_b64_tr_b16 v[58:59], v13 offset:27392
  s_waitcnt lgkmcnt(10)
  v_mfma_f32_32x32x16_bf16 v[96:111], v[236:239], v[36:39], v[96:111]
  ds_read_b64_tr_b16 v[32:33], v13 offset:28672
  ds_read_b64_tr_b16 v[34:35], v13 offset:29184
  s_waitcnt lgkmcnt(10)
  v_mfma_f32_32x32x16_bf16 v[112:127], v[236:239], v[40:43], v[112:127]
  ds_read_b64_tr_b16 v[36:37], v13 offset:28928
  ds_read_b64_tr_b16 v[38:39], v13 offset:29440
  s_waitcnt lgkmcnt(10)
  v_mfma_f32_32x32x16_bf16 v[96:111], v[240:243], v[44:47], v[96:111]
  ds_read_b64_tr_b16 v[40:41], v13 offset:30720
  ds_read_b64_tr_b16 v[42:43], v13 offset:31232
  s_waitcnt lgkmcnt(10)
  v_mfma_f32_32x32x16_bf16 v[112:127], v[240:243], v[48:51], v[112:127]
  ds_read_b64_tr_b16 v[44:45], v13 offset:30976
  ds_read_b64_tr_b16 v[46:47], v13 offset:31488
  s_waitcnt lgkmcnt(10)
  v_mfma_f32_32x32x16_bf16 v[96:111], v[244:247], v[52:55], v[96:111]
  s_waitcnt lgkmcnt(8)
  v_mfma_f32_32x32x16_bf16 v[112:127], v[244:247], v[56:59], v[112:127]
  s_waitcnt lgkmcnt(6)
  v_mfma_f32_32x32x16_bf16 v[96:111], v[248:251], v[32:35], v[96:111]
  s_waitcnt lgkmcnt(4)
  v_mfma_f32_32x32x16_bf16 v[112:127], v[248:251], v[36:39], v[112:127]
  s_waitcnt lgkmcnt(2)
  v_mfma_f32_32x32x16_bf16 v[96:111], v[252:255], v[40:43], v[96:111]
  s_waitcnt lgkmcnt(0)
  v_mfma_f32_32x32x16_bf16 v[112:127], v[252:255], v[44:47], v[112:127]
  s_nop 9
  v_cvt_pk_bf16_f32 v96, v96, v97
  v_cvt_pk_bf16_f32 v97, v98, v99
  v_cvt_pk_bf16_f32 v98, v100, v101
  v_cvt_pk_bf16_f32 v99, v102, v103
  v_cvt_pk_bf16_f32 v100, v104, v105
  v_cvt_pk_bf16_f32 v101, v106, v107
  v_cvt_pk_bf16_f32 v102, v108, v109
  v_cvt_pk_bf16_f32 v103, v110, v111
  s_add_u32 s94, s89, 0
  buffer_store_dwordx4 v[96:99], v14, s[20:23], s94 offen offset:2048 sc1
  s_add_u32 s94, s89, 4096
  buffer_store_dwordx4 v[100:103], v14, s[20:23], s94 offen offset:2048 sc1
  v_cvt_pk_bf16_f32 v112, v112, v113
  v_cvt_pk_bf16_f32 v113, v114, v115
  v_cvt_pk_bf16_f32 v114, v116, v117
  v_cvt_pk_bf16_f32 v115, v118, v119
  v_cvt_pk_bf16_f32 v116, v120, v121
  v_cvt_pk_bf16_f32 v117, v122, v123
  v_cvt_pk_bf16_f32 v118, v124, v125
  v_cvt_pk_bf16_f32 v119, v126, v127
  s_add_u32 s94, s89, 0
  buffer_store_dwordx4 v[112:115], v14, s[20:23], s94 offen offset:3072 sc1
  s_add_u32 s94, s89, 4096
  buffer_store_dwordx4 v[116:119], v14, s[20:23], s94 offen offset:3072 sc1
kva_kernel_att_1:
  s_load_dwordx4 s[80:83], s[0:1], 64
  s_load_dwordx2 s[84:85], s[0:1], 80
  s_load_dwordx2 s[92:93], s[0:1], 40
  s_mov_b64 s[4:5], s[76:77]
  s_mov_b64 s[6:7], s[78:79]
  s_mov_b64 s[8:9], s[44:45]
  s_mov_b64 s[10:11], s[46:47]
  s_mov_b64 s[12:13], s[16:17]
  s_mov_b64 s[14:15], s[18:19]
  s_mov_b64 s[16:17], s[20:21]
  s_mov_b64 s[18:19], s[22:23]
  s_add_u32 s88, s20, 50331648
  s_addc_u32 s89, s21, 0
  s_mov_b32 s90, 6668288
  s_mov_b32 s91, 0x00020000
  s_add_u32 s20, s20, 16777216
  s_addc_u32 s21, s21, 0
  s_mov_b32 s24, s3
  s_bfe_u32 s38, s2, 0x20003
  s_lshl_b32 s25, s38, 2
  s_lshr_b32 s25, 29984, s25
  s_xor_b32 s25, s25, s2
  s_and_b32 s25, s25, 7
  s_lshl_b32 s38, s38, 3
  s_add_u32 s25, s25, s38
  s_lshr_b32 s26, s2, 5
  s_lshr_b32 s27, s24, 2
  s_and_b32 s28, s24, 3
  v_lshlrev_b32 v2, 4, v0
  v_lshrrev_b32 v1, 2, v0
  v_and_b32 v1, 3, v1
  v_lshrrev_b32 v240, 4, v0
  v_and_b32 v241, 3, v0
  s_lshl_b32 s38, s24, 3
  v_add_u32 v3, s38, v1
  v_lshlrev_b32 v3, 13, v3
  v_lshl_add_u32 v3, v240, 6, v3
  v_lshl_add_u32 v3, v241, 4, v3
  s_lshl_b32 s38, s25, 8
  v_add_u32 v3, s38, v3
  s_sub_u32 s38, 15, s26
  s_cmp_eq_u32 s27, 0
  s_cselect_b32 s29, s26, s38
  s_lshl_b32 s47, s29, 2
  s_add_u32 s47, s47, s28
  s_mul_i32 s47, s47, 40960
  s_lshl_b32 s32, s24, 11
  s_lshl_b32 s39, s26, 1
  s_add_u32 s30, s39, 2
  s_add_u32 s31, s30, s27
  s_sub_u32 s31, s31, 1
  s_lshl_b32 s36, 1, s39
  s_lshl_b32 s33, 2, s39
  s_cmp_lt_u32 s28, 2
  s_cselect_b32 s36, s36, 0
  s_cselect_b32 s44, 0x10000, 0
  s_or_b32 s36, s36, s33
  s_or_b32 s36, s36, 0x10000
  s_lshl_b32 s33, 6, s39
  s_or_b32 s33, s33, s36
  s_add_u32 s42, s39, 1
  s_cmp_eq_u32 s27, 0
  s_cselect_b32 s36, s36, s44
  s_cselect_b32 s33, s33, s44
  s_cselect_b32 s42, s42, 100
  s_cselect_b32 s43, s30, 100
  s_cselect_b32 s44, 64, 0
  s_add_u32 s58, s30, 1
  s_cmp_eq_u32 s24, 0
  s_cselect_b32 s58, s58, 31
  s_bitset1_b32 s33, s58
  s_bfe_u32 s59, s2, 0x20003
  s_lshl_b32 s59, s59, 4
  s_add_u32 s59, s59, s26
  s_mul_i32 s59, s59, 4352
  s_and_b32 s38, s2, 7
  s_lshl_b32 s38, s38, 2
  s_add_u32 s59, s59, s38
  s_add_u32 s59, s59, 2621440
  s_sub_u32 s39, 7, s26
  s_bitcmp0_b32 s2, 2
  s_cselect_b32 s39, s26, s39
  s_and_b32 s38, s39, 3
  s_lshl_b32 s38, s38, 3
  s_lshl_b32 s38, 2, s38
  v_mov_b32 v244, s38
  s_lshr_b32 s39, s39, 2
  s_and_b32 s38, s2, 1
  s_lshl_b32 s38, s38, 2
  s_add_u32 s39, s39, s38
  s_and_b32 s38, s2, 2
  s_add_u32 s39, s39, s38
  v_and_b32 v245, 7, v0
  v_cmp_eq_u32 vcc, s39, v245
  s_nop 1
  v_cndmask_b32 v244, 0, v244, vcc
  v_or_b32 v20, v20, v244
  s_sub_u32 s38, 15, s26
  s_lshl_b32 s40, s26, 2
  s_add_u32 s40, s40, s28
  s_lshl_b32 s40, s40, 18
  s_lshl_b32 s41, s38, 2
  s_add_u32 s41, s41, s28
  s_lshl_b32 s41, s41, 18
  s_lshl_b32 s38, s25, 13
  s_add_u32 s40, s40, s38
  s_add_u32 s41, s41, s38
  s_lshl_b32 s34, s25, 19
  s_lshl_b32 s38, s28, 12
  s_add_u32 s34, s34, s38
  s_lshl_b32 s35, s27, 16
  s_add_u32 s35, s35, s38
  s_mov_b32 s37, 1040356334
  v_lshrrev_b32 v12, 5, v0
  v_lshlrev_b32 v4, 11, v12
  v_lshl_add_u32 v4, v1, 6, v4
  v_and_b32 v242, 1, v240
  v_lshl_add_u32 v4, v242, 5, v4
  v_lshl_add_u32 v4, v241, 3, v4
  v_add_u32 v5, 0x10000, v4
  v_add_u32 v6, 0x20000, v4
  s_lshl_b32 s38, s27, 16
  v_add_u32 v7, s38, v2
  v_and_b32 v8, 31, v0
  s_lshl_b32 s38, s28, 5
  v_add_u32 v8, s38, v8
  v_lshlrev_b32 v242, 2, v12
  v_sub_u32 v8, v8, v242
  v_mov_b32 v11, 0xf149f2ca
  s_mov_b32 s78, 2211840
  s_mov_b32 s79, 0x00020000
  s_lshl_b32 s100, s24, 8
  s_add_u32 s100, s100, s2
  s_cmp_lt_u32 s100, 1080
  s_cselect_b64 s[96:97], -1, 0
  s_cselect_b32 s100, s100, 0
  v_lshrrev_b32 v240, 3, v0
  v_and_b32 v241, 7, v0
  s_mul_i32 s101, s100, 2428
  s_lshr_b32 s101, s101, 16
  s_mul_i32 s38, s101, 27
  s_sub_u32 s38, s100, s38
  s_lshl_b32 s101, s101, 3
  v_add_u32 v242, s101, v240
  v_mul_u32_u24 v1, 3456, v242
  v_lshl_add_u32 v1, v241, 4, v1
  s_lshl_b32 s101, s38, 7
  v_add_u32 v1, s101, v1
  s_lshl_b32 s101, s38, 3
  v_add_u32 v243, s101, v241
  v_mul_u32_u24 v13, 20480, v243
  v_lshl_add_u32 v13, v242, 4, v13
  s_mul_i32 s101, s100, 6554
  s_lshr_b32 s101, s101, 16
  s_mul_i32 s38, s101, 10
  s_sub_u32 s38, s100, s38
  s_lshl_b32 s101, s101, 3
  v_add_u32 v242, s101, v240
  v_mul_u32_u24 v14, 1280, v242
  v_lshl_add_u32 v14, v241, 4, v14
  s_lshl_b32 s101, s38, 7
  v_add_u32 v14, s101, v14
  s_lshl_b32 s101, s38, 2
  v_lshrrev_b32 v243, 1, v241
  v_add_u32 v243, s101, v243
  v_mul_u32_u24 v15, 55296, v243
  v_lshl_add_u32 v15, v242, 5, v15
  v_and_b32 v243, 1, v0
  v_lshl_add_u32 v15, v243, 4, v15
  v_add_u32 v15, 4456448, v15
  s_waitcnt vmcnt(22)
  s_barrier
  ds_read_b64_tr_b16 v[176:177], v4 offset:32768
  ds_read_b64_tr_b16 v[178:179], v4 offset:33792
  ds_read_b64_tr_b16 v[180:181], v4 offset:33024
  ds_read_b64_tr_b16 v[182:183], v4 offset:34048
  ds_read_b64_tr_b16 v[184:185], v4 offset:33280
  ds_read_b64_tr_b16 v[186:187], v4 offset:34304
  ds_read_b64_tr_b16 v[188:189], v4 offset:33536
  ds_read_b64_tr_b16 v[190:191], v4 offset:34560
  s_waitcnt vmcnt(17) lgkmcnt(0)
  v_mfma_f32_32x32x16_bf16 v[48:63], v[176:179], v[128:131], 0
  ds_read_b64_tr_b16 v[192:193], v4 offset:36864
  ds_read_b64_tr_b16 v[194:195], v4 offset:37888
  v_mfma_f32_32x32x16_bf16 v[64:79], v[180:183], v[128:131], 0
  ds_read_b64_tr_b16 v[196:197], v4 offset:37120
  ds_read_b64_tr_b16 v[198:199], v4 offset:38144
  v_mfma_f32_32x32x16_bf16 v[80:95], v[184:187], v[128:131], 0
  ds_read_b64_tr_b16 v[200:201], v4 offset:37376
  ds_read_b64_tr_b16 v[202:203], v4 offset:38400
  s_add_u32 m0, s32, 81920
  s_mov_b32 s38, 1572864
  buffer_load_dwordx4 v3, s[4:7], s38 offen lds
  v_mfma_f32_32x32x16_bf16 v[96:111], v[188:191], v[128:131], 0
  ds_read_b64_tr_b16 v[204:205], v4 offset:37632
  ds_read_b64_tr_b16 v[206:207], v4 offset:38656
  s_add_u32 m0, s32, 82944
  s_mov_b32 s38, 1605632
  buffer_load_dwordx4 v3, s[4:7], s38 offen lds
  s_waitcnt lgkmcnt(6)
  v_mfma_f32_32x32x16_bf16 v[48:63], v[192:195], v[132:135], v[48:63]
  ds_read_b64_tr_b16 v[176:177], v4 offset:40960
  ds_read_b64_tr_b16 v[178:179], v4 offset:41984
  s_waitcnt lgkmcnt(6)
  v_mfma_f32_32x32x16_bf16 v[64:79], v[196:199], v[132:135], v[64:79]
  ds_read_b64_tr_b16 v[180:181], v4 offset:41216
  ds_read_b64_tr_b16 v[182:183], v4 offset:42240
  s_waitcnt lgkmcnt(6)
  v_mfma_f32_32x32x16_bf16 v[80:95], v[200:203], v[132:135], v[80:95]
  ds_read_b64_tr_b16 v[184:185], v4 offset:41472
  ds_read_b64_tr_b16 v[186:187], v4 offset:42496
  s_add_u32 s39, s47, 12288
  buffer_load_dwordx4 v[112:115], v2, s[8:11], s39 offen offset:0
  s_waitcnt lgkmcnt(6)
  v_mfma_f32_32x32x16_bf16 v[96:111], v[204:207], v[132:135], v[96:111]
  ds_read_b64_tr_b16 v[188:189], v4 offset:41728
  ds_read_b64_tr_b16 v[190:191], v4 offset:42752
  buffer_load_dwordx4 v[116:119], v2, s[8:11], s39 offen offset:1024
  s_waitcnt lgkmcnt(6)
  v_mfma_f32_32x32x16_bf16 v[48:63], v[176:179], v[136:139], v[48:63]
  ds_read_b64_tr_b16 v[192:193], v4 offset:45056
  ds_read_b64_tr_b16 v[194:195], v4 offset:46080
  s_waitcnt lgkmcnt(6)
  v_mfma_f32_32x32x16_bf16 v[64:79], v[180:183], v[136:139], v[64:79]
  ds_read_b64_tr_b16 v[196:197], v4 offset:45312
  ds_read_b64_tr_b16 v[198:199], v4 offset:46336
  s_waitcnt lgkmcnt(6)
  v_mfma_f32_32x32x16_bf16 v[80:95], v[184:187], v[136:139], v[80:95]
  ds_read_b64_tr_b16 v[200:201], v4 offset:45568
  ds_read_b64_tr_b16 v[202:203], v4 offset:46592
  buffer_load_dwordx4 v[120:123], v2, s[8:11], s39 offen offset:2048
  s_waitcnt lgkmcnt(6)
  v_mfma_f32_32x32x16_bf16 v[96:111], v[188:191], v[136:139], v[96:111]
  ds_read_b64_tr_b16 v[204:205], v4 offset:45824
  ds_read_b64_tr_b16 v[206:207], v4 offset:46848
  buffer_load_dwordx4 v[124:127], v2, s[8:11], s39 offen offset:3072
  s_waitcnt vmcnt(6)
  s_barrier
  v_mov_b32 v17, 7
  buffer_store_byte v17, v16, s[68:71], 0 offen sc1
  s_waitcnt lgkmcnt(6)
  v_mfma_f32_32x32x16_bf16 v[48:63], v[192:195], v[140:143], v[48:63]
  ds_read_b64_tr_b16 v[176:177], v4 offset:49152
  ds_read_b64_tr_b16 v[178:179], v4 offset:50176
  s_waitcnt lgkmcnt(6)
  v_mfma_f32_32x32x16_bf16 v[64:79], v[196:199], v[140:143], v[64:79]
  ds_read_b64_tr_b16 v[180:181], v4 offset:49408
  ds_read_b64_tr_b16 v[182:183], v4 offset:50432
  s_waitcnt lgkmcnt(6)
  v_mfma_f32_32x32x16_bf16 v[80:95], v[200:203], v[140:143], v[80:95]
  ds_read_b64_tr_b16 v[184:185], v4 offset:49664
  ds_read_b64_tr_b16 v[186:187], v4 offset:50688
  s_waitcnt lgkmcnt(6)
  v_mfma_f32_32x32x16_bf16 v[96:111], v[204:207], v[140:143], v[96:111]
  ds_read_b64_tr_b16 v[188:189], v4 offset:49920
  ds_read_b64_tr_b16 v[190:191], v4 offset:50944
  s_waitcnt vmcnt(18)
  s_waitcnt lgkmcnt(6)
  v_mfma_f32_32x32x16_bf16 v[48:63], v[176:179], v[144:147], v[48:63]
  ds_read_b64_tr_b16 v[192:193], v4 offset:53248
  ds_read_b64_tr_b16 v[194:195], v4 offset:54272
  s_waitcnt lgkmcnt(6)
  v_mfma_f32_32x32x16_bf16 v[64:79], v[180:183], v[144:147], v[64:79]
  ds_read_b64_tr_b16 v[196:197], v4 offset:53504
  ds_read_b64_tr_b16 v[198:199], v4 offset:54528
  s_waitcnt lgkmcnt(6)
  v_mfma_f32_32x32x16_bf16 v[80:95], v[184:187], v[144:147], v[80:95]
  ds_read_b64_tr_b16 v[200:201], v4 offset:53760
  ds_read_b64_tr_b16 v[202:203], v4 offset:54784
  s_add_u32 m0, s32, 98304
  s_mov_b32 s38, 2097152
  buffer_load_dwordx4 v3, s[4:7], s38 offen lds
  s_waitcnt lgkmcnt(6)
  v_mfma_f32_32x32x16_bf16 v[96:111], v[188:191], v[144:147], v[96:111]
  ds_read_b64_tr_b16 v[204:205], v4 offset:54016
  ds_read_b64_tr_b16 v[206:207], v4 offset:55040
  s_add_u32 m0, s32, 99328
  s_mov_b32 s38, 2129920
  buffer_load_dwordx4 v3, s[4:7], s38 offen lds
  s_waitcnt lgkmcnt(6)
  v_mfma_f32_32x32x16_bf16 v[48:63], v[192:195], v[148:151], v[48:63]
  ds_read_b64_tr_b16 v[176:177], v4 offset:57344
  ds_read_b64_tr_b16 v[178:179], v4 offset:58368
  s_waitcnt lgkmcnt(6)
  v_mfma_f32_32x32x16_bf16 v[64:79], v[196:199], v[148:151], v[64:79]
  ds_read_b64_tr_b16 v[180:181], v4 offset:57600
  ds_read_b64_tr_b16 v[182:183], v4 offset:58624
  s_waitcnt lgkmcnt(6)
  v_mfma_f32_32x32x16_bf16 v[80:95], v[200:203], v[148:151], v[80:95]
  ds_read_b64_tr_b16 v[184:185], v4 offset:57856
  ds_read_b64_tr_b16 v[186:187], v4 offset:58880
  s_add_u32 s39, s47, 16384
  buffer_load_dwordx4 v[128:131], v2, s[8:11], s39 offen offset:0
  s_waitcnt lgkmcnt(6)
  v_mfma_f32_32x32x16_bf16 v[96:111], v[204:207], v[148:151], v[96:111]
  ds_read_b64_tr_b16 v[188:189], v4 offset:58112
  ds_read_b64_tr_b16 v[190:191], v4 offset:59136
  buffer_load_dwordx4 v[132:135], v2, s[8:11], s39 offen offset:1024
  s_waitcnt lgkmcnt(6)
  v_mfma_f32_32x32x16_bf16 v[48:63], v[176:179], v[152:155], v[48:63]
  ds_read_b64_tr_b16 v[192:193], v4 offset:61440
  ds_read_b64_tr_b16 v[194:195], v4 offset:62464
  s_waitcnt lgkmcnt(6)
  v_mfma_f32_32x32x16_bf16 v[64:79], v[180:183], v[152:155], v[64:79]
  ds_read_b64_tr_b16 v[196:197], v4 offset:61696
  ds_read_b64_tr_b16 v[198:199], v4 offset:62720
  s_waitcnt lgkmcnt(6)
  v_mfma_f32_32x32x16_bf16 v[80:95], v[184:187], v[152:155], v[80:95]
  ds_read_b64_tr_b16 v[200:201], v4 offset:61952
  ds_read_b64_tr_b16 v[202:203], v4 offset:62976
  buffer_load_dwordx4 v[136:139], v2, s[8:11], s39 offen offset:2048
  s_waitcnt lgkmcnt(6)
  v_mfma_f32_32x32x16_bf16 v[96:111], v[188:191], v[152:155], v[96:111]
  ds_read_b64_tr_b16 v[204:205], v4 offset:62208
  ds_read_b64_tr_b16 v[206:207], v4 offset:63232
  buffer_load_dwordx4 v[140:143], v2, s[8:11], s39 offen offset:3072
  s_waitcnt vmcnt(22)
  s_barrier
  s_waitcnt lgkmcnt(6)
  v_mfma_f32_32x32x16_bf16 v[48:63], v[192:195], v[156:159], v[48:63]
  ds_read_b64_tr_b16 v[176:177], v5 offset:0
  ds_read_b64_tr_b16 v[178:179], v5 offset:1024
  s_waitcnt lgkmcnt(6)
  v_mfma_f32_32x32x16_bf16 v[64:79], v[196:199], v[156:159], v[64:79]
  ds_read_b64_tr_b16 v[180:181], v5 offset:256
  ds_read_b64_tr_b16 v[182:183], v5 offset:1280
  s_waitcnt lgkmcnt(6)
  v_mfma_f32_32x32x16_bf16 v[80:95], v[200:203], v[156:159], v[80:95]
  ds_read_b64_tr_b16 v[184:185], v5 offset:512
  ds_read_b64_tr_b16 v[186:187], v5 offset:1536
  s_waitcnt lgkmcnt(6)
  v_mfma_f32_32x32x16_bf16 v[96:111], v[204:207], v[156:159], v[96:111]
  ds_read_b64_tr_b16 v[188:189], v5 offset:768
  ds_read_b64_tr_b16 v[190:191], v5 offset:1792
  s_waitcnt vmcnt(17)
  s_waitcnt lgkmcnt(6)
  v_mfma_f32_32x32x16_bf16 v[48:63], v[176:179], v[160:163], v[48:63]
  ds_read_b64_tr_b16 v[192:193], v5 offset:4096
  ds_read_b64_tr_b16 v[194:195], v5 offset:5120
  s_waitcnt lgkmcnt(6)
  v_mfma_f32_32x32x16_bf16 v[64:79], v[180:183], v[160:163], v[64:79]
  ds_read_b64_tr_b16 v[196:197], v5 offset:4352
  ds_read_b64_tr_b16 v[198:199], v5 offset:5376
  s_waitcnt lgkmcnt(6)
  v_mfma_f32_32x32x16_bf16 v[80:95], v[184:187], v[160:163], v[80:95]
  ds_read_b64_tr_b16 v[200:201], v5 offset:4608
  ds_read_b64_tr_b16 v[202:203], v5 offset:5632
  s_add_u32 m0, s32, 114688
  s_mov_b32 s38, 2621440
  buffer_load_dwordx4 v3, s[4:7], s38 offen lds
  s_waitcnt lgkmcnt(6)
  v_mfma_f32_32x32x16_bf16 v[96:111], v[188:191], v[160:163], v[96:111]
  ds_read_b64_tr_b16 v[204:205], v5 offset:4864
  ds_read_b64_tr_b16 v[206:207], v5 offset:5888
  s_add_u32 m0, s32, 115712
  s_mov_b32 s38, 2654208
  buffer_load_dwordx4 v3, s[4:7], s38 offen lds
  s_waitcnt lgkmcnt(6)
  v_mfma_f32_32x32x16_bf16 v[48:63], v[192:195], v[164:167], v[48:63]
  ds_read_b64_tr_b16 v[176:177], v5 offset:8192
  ds_read_b64_tr_b16 v[178:179], v5 offset:9216
  s_waitcnt lgkmcnt(6)
  v_mfma_f32_32x32x16_bf16 v[64:79], v[196:199], v[164:167], v[64:79]
  ds_read_b64_tr_b16 v[180:181], v5 offset:8448
  ds_read_b64_tr_b16 v[182:183], v5 offset:9472
  s_waitcnt lgkmcnt(6)
  v_mfma_f32_32x32x16_bf16 v[80:95], v[200:203], v[164:167], v[80:95]
  ds_read_b64_tr_b16 v[184:185], v5 offset:8704
  ds_read_b64_tr_b16 v[186:187], v5 offset:9728
  s_add_u32 s39, s47, 20480
  buffer_load_dwordx4 v[144:147], v2, s[8:11], s39 offen offset:0
  s_waitcnt lgkmcnt(6)
  v_mfma_f32_32x32x16_bf16 v[96:111], v[204:207], v[164:167], v[96:111]
  ds_read_b64_tr_b16 v[188:189], v5 offset:8960
  ds_read_b64_tr_b16 v[190:191], v5 offset:9984
  buffer_load_dwordx4 v[148:151], v2, s[8:11], s39 offen offset:1024
  s_waitcnt lgkmcnt(6)
  v_mfma_f32_32x32x16_bf16 v[48:63], v[176:179], v[168:171], v[48:63]
  ds_read_b64_tr_b16 v[192:193], v5 offset:12288
  ds_read_b64_tr_b16 v[194:195], v5 offset:13312
  s_waitcnt lgkmcnt(6)
  v_mfma_f32_32x32x16_bf16 v[64:79], v[180:183], v[168:171], v[64:79]
  ds_read_b64_tr_b16 v[196:197], v5 offset:12544
  ds_read_b64_tr_b16 v[198:199], v5 offset:13568
  s_waitcnt lgkmcnt(6)
  v_mfma_f32_32x32x16_bf16 v[80:95], v[184:187], v[168:171], v[80:95]
  ds_read_b64_tr_b16 v[200:201], v5 offset:12800
  ds_read_b64_tr_b16 v[202:203], v5 offset:13824
  buffer_load_dwordx4 v[152:155], v2, s[8:11], s39 offen offset:2048
  s_waitcnt lgkmcnt(6)
  v_mfma_f32_32x32x16_bf16 v[96:111], v[188:191], v[168:171], v[96:111]
  ds_read_b64_tr_b16 v[204:205], v5 offset:13056
  ds_read_b64_tr_b16 v[206:207], v5 offset:14080
  buffer_load_dwordx4 v[156:159], v2, s[8:11], s39 offen offset:3072
  s_waitcnt vmcnt(17)
  s_barrier
  s_waitcnt lgkmcnt(6)
  v_mfma_f32_32x32x16_bf16 v[48:63], v[192:195], v[172:175], v[48:63]
  ds_read_b64_tr_b16 v[176:177], v5 offset:16384
  ds_read_b64_tr_b16 v[178:179], v5 offset:17408
  s_waitcnt lgkmcnt(6)
  v_mfma_f32_32x32x16_bf16 v[64:79], v[196:199], v[172:175], v[64:79]
  ds_read_b64_tr_b16 v[180:181], v5 offset:16640
  ds_read_b64_tr_b16 v[182:183], v5 offset:17664
  s_waitcnt lgkmcnt(6)
  v_mfma_f32_32x32x16_bf16 v[80:95], v[200:203], v[172:175], v[80:95]
  ds_read_b64_tr_b16 v[184:185], v5 offset:16896
  ds_read_b64_tr_b16 v[186:187], v5 offset:17920
  s_waitcnt lgkmcnt(6)
  v_mfma_f32_32x32x16_bf16 v[96:111], v[204:207], v[172:175], v[96:111]
  ds_read_b64_tr_b16 v[188:189], v5 offset:17152
  ds_read_b64_tr_b16 v[190:191], v5 offset:18176
  s_waitcnt vmcnt(13)
  s_waitcnt lgkmcnt(6)
  v_mfma_f32_32x32x16_bf16 v[48:63], v[176:179], v[112:115], v[48:63]
  ds_read_b64_tr_b16 v[192:193], v5 offset:20480
  ds_read_b64_tr_b16 v[194:195], v5 offset:21504
  s_waitcnt lgkmcnt(6)
  v_mfma_f32_32x32x16_bf16 v[64:79], v[180:183], v[112:115], v[64:79]
  ds_read_b64_tr_b16 v[196:197], v5 offset:20736
  ds_read_b64_tr_b16 v[198:199], v5 offset:21760
  s_waitcnt lgkmcnt(6)
  v_mfma_f32_32x32x16_bf16 v[80:95], v[184:187], v[112:115], v[80:95]
  ds_read_b64_tr_b16 v[200:201], v5 offset:20992
  ds_read_b64_tr_b16 v[202:203], v5 offset:22016
  s_add_u32 m0, s32, 131072
  s_mov_b32 s38, 3145728
  buffer_load_dwordx4 v3, s[4:7], s38 offen lds
  s_waitcnt lgkmcnt(6)
  v_mfma_f32_32x32x16_bf16 v[96:111], v[188:191], v[112:115], v[96:111]
  ds_read_b64_tr_b16 v[204:205], v5 offset:21248
  ds_read_b64_tr_b16 v[206:207], v5 offset:22272
  s_add_u32 m0, s32, 132096
  s_mov_b32 s38, 3178496
  buffer_load_dwordx4 v3, s[4:7], s38 offen lds
  s_waitcnt lgkmcnt(6)
  v_mfma_f32_32x32x16_bf16 v[48:63], v[192:195], v[116:119], v[48:63]
  ds_read_b64_tr_b16 v[176:177], v5 offset:24576
  ds_read_b64_tr_b16 v[178:179], v5 offset:25600
  s_waitcnt lgkmcnt(6)
  v_mfma_f32_32x32x16_bf16 v[64:79], v[196:199], v[116:119], v[64:79]
  ds_read_b64_tr_b16 v[180:181], v5 offset:24832
  ds_read_b64_tr_b16 v[182:183], v5 offset:25856
  s_waitcnt lgkmcnt(6)
  v_mfma_f32_32x32x16_bf16 v[80:95], v[200:203], v[116:119], v[80:95]
  ds_read_b64_tr_b16 v[184:185], v5 offset:25088
  ds_read_b64_tr_b16 v[186:187], v5 offset:26112
  s_add_u32 s39, s47, 24576
  buffer_load_dwordx4 v[160:163], v2, s[8:11], s39 offen offset:0
  s_waitcnt lgkmcnt(6)
  v_mfma_f32_32x32x16_bf16 v[96:111], v[204:207], v[116:119], v[96:111]
  ds_read_b64_tr_b16 v[188:189], v5 offset:25344
  ds_read_b64_tr_b16 v[190:191], v5 offset:26368
  buffer_load_dwordx4 v[164:167], v2, s[8:11], s39 offen offset:1024
  s_waitcnt lgkmcnt(6)
  v_mfma_f32_32x32x16_bf16 v[48:63], v[176:179], v[120:123], v[48:63]
  ds_read_b64_tr_b16 v[192:193], v5 offset:28672
  ds_read_b64_tr_b16 v[194:195], v5 offset:29696
  s_waitcnt lgkmcnt(6)
  v_mfma_f32_32x32x16_bf16 v[64:79], v[180:183], v[120:123], v[64:79]
  ds_read_b64_tr_b16 v[196:197], v5 offset:28928
  ds_read_b64_tr_b16 v[198:199], v5 offset:29952
  s_waitcnt lgkmcnt(6)
  v_mfma_f32_32x32x16_bf16 v[80:95], v[184:187], v[120:123], v[80:95]
  ds_read_b64_tr_b16 v[200:201], v5 offset:29184
  ds_read_b64_tr_b16 v[202:203], v5 offset:30208
  buffer_load_dwordx4 v[168:171], v2, s[8:11], s39 offen offset:2048
  s_waitcnt lgkmcnt(6)
  v_mfma_f32_32x32x16_bf16 v[96:111], v[188:191], v[120:123], v[96:111]
  ds_read_b64_tr_b16 v[204:205], v5 offset:29440
  ds_read_b64_tr_b16 v[206:207], v5 offset:30464
  buffer_load_dwordx4 v[172:175], v2, s[8:11], s39 offen offset:3072
  s_waitcnt vmcnt(16)
  s_barrier
  s_waitcnt lgkmcnt(6)
  v_mfma_f32_32x32x16_bf16 v[48:63], v[192:195], v[124:127], v[48:63]
  ds_read_b64_tr_b16 v[176:177], v5 offset:32768
  ds_read_b64_tr_b16 v[178:179], v5 offset:33792
  s_waitcnt lgkmcnt(6)
  v_mfma_f32_32x32x16_bf16 v[64:79], v[196:199], v[124:127], v[64:79]
  ds_read_b64_tr_b16 v[180:181], v5 offset:33024
  ds_read_b64_tr_b16 v[182:183], v5 offset:34048
  s_waitcnt lgkmcnt(6)
  v_mfma_f32_32x32x16_bf16 v[80:95], v[200:203], v[124:127], v[80:95]
  ds_read_b64_tr_b16 v[184:185], v5 offset:33280
  ds_read_b64_tr_b16 v[186:187], v5 offset:34304
  s_waitcnt lgkmcnt(6)
  v_mfma_f32_32x32x16_bf16 v[96:111], v[204:207], v[124:127], v[96:111]
  ds_read_b64_tr_b16 v[188:189], v5 offset:33536
  ds_read_b64_tr_b16 v[190:191], v5 offset:34560
  s_waitcnt vmcnt(12)
  s_waitcnt lgkmcnt(6)
  v_mfma_f32_32x32x16_bf16 v[48:63], v[176:179], v[128:131], v[48:63]
  ds_read_b64_tr_b16 v[192:193], v5 offset:36864
  ds_read_b64_tr_b16 v[194:195], v5 offset:37888
  s_waitcnt lgkmcnt(6)
  v_mfma_f32_32x32x16_bf16 v[64:79], v[180:183], v[128:131], v[64:79]
  ds_read_b64_tr_b16 v[196:197], v5 offset:37120
  ds_read_b64_tr_b16 v[198:199], v5 offset:38144
  s_waitcnt lgkmcnt(6)
  v_mfma_f32_32x32x16_bf16 v[80:95], v[184:187], v[128:131], v[80:95]
  ds_read_b64_tr_b16 v[200:201], v5 offset:37376
  ds_read_b64_tr_b16 v[202:203], v5 offset:38400
  s_add_u32 m0, s32, 147456
  s_mov_b32 s38, 3670016
  buffer_load_dwordx4 v3, s[4:7], s38 offen lds
  s_waitcnt lgkmcnt(6)
  v_mfma_f32_32x32x16_bf16 v[96:111], v[188:191], v[128:131], v[96:111]
  ds_read_b64_tr_b16 v[204:205], v5 offset:37632
  ds_read_b64_tr_b16 v[206:207], v5 offset:38656
  s_add_u32 m0, s32, 148480
  s_mov_b32 s38, 3702784
  buffer_load_dwordx4 v3, s[4:7], s38 offen lds
  s_waitcnt lgkmcnt(6)
  v_mfma_f32_32x32x16_bf16 v[48:63], v[192:195], v[132:135], v[48:63]
  ds_read_b64_tr_b16 v[176:177], v5 offset:40960
  ds_read_b64_tr_b16 v[178:179], v5 offset:41984
  s_waitcnt lgkmcnt(6)
  v_mfma_f32_32x32x16_bf16 v[64:79], v[196:199], v[132:135], v[64:79]
  ds_read_b64_tr_b16 v[180:181], v5 offset:41216
  ds_read_b64_tr_b16 v[182:183], v5 offset:42240
  s_waitcnt lgkmcnt(6)
  v_mfma_f32_32x32x16_bf16 v[80:95], v[200:203], v[132:135], v[80:95]
  ds_read_b64_tr_b16 v[184:185], v5 offset:41472
  ds_read_b64_tr_b16 v[186:187], v5 offset:42496
  s_add_u32 s39, s47, 28672
  buffer_load_dwordx4 v[112:115], v2, s[8:11], s39 offen offset:0
  s_waitcnt lgkmcnt(6)
  v_mfma_f32_32x32x16_bf16 v[96:111], v[204:207], v[132:135], v[96:111]
  ds_read_b64_tr_b16 v[188:189], v5 offset:41728
  ds_read_b64_tr_b16 v[190:191], v5 offset:42752
  buffer_load_dwordx4 v[116:119], v2, s[8:11], s39 offen offset:1024
  s_waitcnt lgkmcnt(6)
  v_mfma_f32_32x32x16_bf16 v[48:63], v[176:179], v[136:139], v[48:63]
  ds_read_b64_tr_b16 v[192:193], v5 offset:45056
  ds_read_b64_tr_b16 v[194:195], v5 offset:46080
  s_waitcnt lgkmcnt(6)
  v_mfma_f32_32x32x16_bf16 v[64:79], v[180:183], v[136:139], v[64:79]
  ds_read_b64_tr_b16 v[196:197], v5 offset:45312
  ds_read_b64_tr_b16 v[198:199], v5 offset:46336
  s_waitcnt lgkmcnt(6)
  v_mfma_f32_32x32x16_bf16 v[80:95], v[184:187], v[136:139], v[80:95]
  ds_read_b64_tr_b16 v[200:201], v5 offset:45568
  ds_read_b64_tr_b16 v[202:203], v5 offset:46592
  buffer_load_dwordx4 v[120:123], v2, s[8:11], s39 offen offset:2048
  s_waitcnt lgkmcnt(6)
  v_mfma_f32_32x32x16_bf16 v[96:111], v[188:191], v[136:139], v[96:111]
  ds_read_b64_tr_b16 v[204:205], v5 offset:45824
  ds_read_b64_tr_b16 v[206:207], v5 offset:46848
  buffer_load_dwordx4 v[124:127], v2, s[8:11], s39 offen offset:3072
  s_waitcnt vmcnt(16)
  s_barrier
  s_waitcnt lgkmcnt(6)
  v_mfma_f32_32x32x16_bf16 v[48:63], v[192:195], v[140:143], v[48:63]
  ds_read_b64_tr_b16 v[176:177], v5 offset:49152
  ds_read_b64_tr_b16 v[178:179], v5 offset:50176
  s_waitcnt lgkmcnt(6)
  v_mfma_f32_32x32x16_bf16 v[64:79], v[196:199], v[140:143], v[64:79]
  ds_read_b64_tr_b16 v[180:181], v5 offset:49408
  ds_read_b64_tr_b16 v[182:183], v5 offset:50432
  s_waitcnt lgkmcnt(6)
  v_mfma_f32_32x32x16_bf16 v[80:95], v[200:203], v[140:143], v[80:95]
  ds_read_b64_tr_b16 v[184:185], v5 offset:49664
  ds_read_b64_tr_b16 v[186:187], v5 offset:50688
  s_waitcnt lgkmcnt(6)
  v_mfma_f32_32x32x16_bf16 v[96:111], v[204:207], v[140:143], v[96:111]
  ds_read_b64_tr_b16 v[188:189], v5 offset:49920
  ds_read_b64_tr_b16 v[190:191], v5 offset:50944
  buffer_load_dword v17, v18, s[68:71], 0 offen sc1
  s_waitcnt vmcnt(13)
  s_waitcnt lgkmcnt(6)
  v_mfma_f32_32x32x16_bf16 v[48:63], v[176:179], v[144:147], v[48:63]
  ds_read_b64_tr_b16 v[192:193], v5 offset:53248
  ds_read_b64_tr_b16 v[194:195], v5 offset:54272
  s_waitcnt lgkmcnt(6)
  v_mfma_f32_32x32x16_bf16 v[64:79], v[180:183], v[144:147], v[64:79]
  ds_read_b64_tr_b16 v[196:197], v5 offset:53504
  ds_read_b64_tr_b16 v[198:199], v5 offset:54528
  s_waitcnt lgkmcnt(6)
  v_mfma_f32_32x32x16_bf16 v[80:95], v[184:187], v[144:147], v[80:95]
  ds_read_b64_tr_b16 v[200:201], v5 offset:53760
  ds_read_b64_tr_b16 v[202:203], v5 offset:54784
  s_add_u32 m0, s32, 32768
  s_mov_b32 s38, 4194304
  buffer_load_dwordx4 v3, s[4:7], s38 offen lds
  s_waitcnt lgkmcnt(6)
  v_mfma_f32_32x32x16_bf16 v[96:111], v[188:191], v[144:147], v[96:111]
  ds_read_b64_tr_b16 v[204:205], v5 offset:54016
  ds_read_b64_tr_b16 v[206:207], v5 offset:55040
  s_add_u32 m0, s32, 33792
  s_mov_b32 s38, 4227072
  buffer_load_dwordx4 v3, s[4:7], s38 offen lds
  s_waitcnt lgkmcnt(6)
  v_mfma_f32_32x32x16_bf16 v[48:63], v[192:195], v[148:151], v[48:63]
  ds_read_b64_tr_b16 v[176:177], v5 offset:57344
  ds_read_b64_tr_b16 v[178:179], v5 offset:58368
  s_waitcnt lgkmcnt(6)
  v_mfma_f32_32x32x16_bf16 v[64:79], v[196:199], v[148:151], v[64:79]
  ds_read_b64_tr_b16 v[180:181], v5 offset:57600
  ds_read_b64_tr_b16 v[182:183], v5 offset:58624
  s_waitcnt lgkmcnt(6)
  v_mfma_f32_32x32x16_bf16 v[80:95], v[200:203], v[148:151], v[80:95]
  ds_read_b64_tr_b16 v[184:185], v5 offset:57856
  ds_read_b64_tr_b16 v[186:187], v5 offset:58880
  s_add_u32 s39, s47, 32768
  buffer_load_dwordx4 v[128:131], v2, s[8:11], s39 offen offset:0
  s_waitcnt lgkmcnt(6)
  v_mfma_f32_32x32x16_bf16 v[96:111], v[204:207], v[148:151], v[96:111]
  ds_read_b64_tr_b16 v[188:189], v5 offset:58112
  ds_read_b64_tr_b16 v[190:191], v5 offset:59136
  buffer_load_dwordx4 v[132:135], v2, s[8:11], s39 offen offset:1024
  s_waitcnt lgkmcnt(6)
  v_mfma_f32_32x32x16_bf16 v[48:63], v[176:179], v[152:155], v[48:63]
  ds_read_b64_tr_b16 v[192:193], v5 offset:61440
  ds_read_b64_tr_b16 v[194:195], v5 offset:62464
  s_waitcnt lgkmcnt(6)
  v_mfma_f32_32x32x16_bf16 v[64:79], v[180:183], v[152:155], v[64:79]
  ds_read_b64_tr_b16 v[196:197], v5 offset:61696
  ds_read_b64_tr_b16 v[198:199], v5 offset:62720
  s_waitcnt lgkmcnt(6)
  v_mfma_f32_32x32x16_bf16 v[80:95], v[184:187], v[152:155], v[80:95]
  ds_read_b64_tr_b16 v[200:201], v5 offset:61952
  ds_read_b64_tr_b16 v[202:203], v5 offset:62976
  buffer_load_dwordx4 v[136:139], v2, s[8:11], s39 offen offset:2048
  s_waitcnt lgkmcnt(6)
  v_mfma_f32_32x32x16_bf16 v[96:111], v[188:191], v[152:155], v[96:111]
  ds_read_b64_tr_b16 v[204:205], v5 offset:62208
  ds_read_b64_tr_b16 v[206:207], v5 offset:63232
  buffer_load_dwordx4 v[140:143], v2, s[8:11], s39 offen offset:3072
  s_waitcnt vmcnt(17)
  s_barrier
  s_waitcnt lgkmcnt(6)
  v_mfma_f32_32x32x16_bf16 v[48:63], v[192:195], v[156:159], v[48:63]
  ds_read_b64_tr_b16 v[176:177], v6 offset:0
  ds_read_b64_tr_b16 v[178:179], v6 offset:1024
  s_waitcnt lgkmcnt(6)
  v_mfma_f32_32x32x16_bf16 v[64:79], v[196:199], v[156:159], v[64:79]
  ds_read_b64_tr_b16 v[180:181], v6 offset:256
  ds_read_b64_tr_b16 v[182:183], v6 offset:1280
  s_waitcnt lgkmcnt(6)
  v_mfma_f32_32x32x16_bf16 v[80:95], v[200:203], v[156:159], v[80:95]
  ds_read_b64_tr_b16 v[184:185], v6 offset:512
  ds_read_b64_tr_b16 v[186:187], v6 offset:1536
  s_waitcnt lgkmcnt(6)
  v_mfma_f32_32x32x16_bf16 v[96:111], v[204:207], v[156:159], v[96:111]
  ds_read_b64_tr_b16 v[188:189], v6 offset:768
  ds_read_b64_tr_b16 v[190:191], v6 offset:1792
  s_waitcnt vmcnt(6)
  s_cmp_lg_u32 s24, 0
  s_cbranch_scc1 kva_kernel_kok_17
  v_and_b32 v17, v17, v20
  v_cmp_ne_u32 vcc, v17, v20
  s_cbranch_vccnz kva_kernel_spin_18
kva_kernel_kok_17:
  s_waitcnt vmcnt(13)
  s_waitcnt lgkmcnt(6)
  v_mfma_f32_32x32x16_bf16 v[48:63], v[176:179], v[160:163], v[48:63]
  ds_read_b64_tr_b16 v[192:193], v6 offset:4096
  ds_read_b64_tr_b16 v[194:195], v6 offset:5120
  s_waitcnt lgkmcnt(6)
  v_mfma_f32_32x32x16_bf16 v[64:79], v[180:183], v[160:163], v[64:79]
  ds_read_b64_tr_b16 v[196:197], v6 offset:4352
  ds_read_b64_tr_b16 v[198:199], v6 offset:5376
  s_waitcnt lgkmcnt(6)
  v_mfma_f32_32x32x16_bf16 v[80:95], v[184:187], v[160:163], v[80:95]
  ds_read_b64_tr_b16 v[200:201], v6 offset:4608
  ds_read_b64_tr_b16 v[202:203], v6 offset:5632
  s_add_u32 m0, s32, 49152
  s_mov_b32 s38, 4718592
  buffer_load_dwordx4 v3, s[4:7], s38 offen lds
  s_waitcnt lgkmcnt(6)
  v_mfma_f32_32x32x16_bf16 v[96:111], v[188:191], v[160:163], v[96:111]
  ds_read_b64_tr_b16 v[204:205], v6 offset:4864
  ds_read_b64_tr_b16 v[206:207], v6 offset:5888
  s_add_u32 m0, s32, 50176
  s_mov_b32 s38, 4751360
  buffer_load_dwordx4 v3, s[4:7], s38 offen lds
  s_waitcnt lgkmcnt(6)
  v_mfma_f32_32x32x16_bf16 v[48:63], v[192:195], v[164:167], v[48:63]
  ds_read_b64_tr_b16 v[176:177], v6 offset:8192
  ds_read_b64_tr_b16 v[178:179], v6 offset:9216
  s_waitcnt lgkmcnt(6)
  v_mfma_f32_32x32x16_bf16 v[64:79], v[196:199], v[164:167], v[64:79]
  ds_read_b64_tr_b16 v[180:181], v6 offset:8448
  ds_read_b64_tr_b16 v[182:183], v6 offset:9472
  s_waitcnt lgkmcnt(6)
  v_mfma_f32_32x32x16_bf16 v[80:95], v[200:203], v[164:167], v[80:95]
  ds_read_b64_tr_b16 v[184:185], v6 offset:8704
  ds_read_b64_tr_b16 v[186:187], v6 offset:9728
  s_add_u32 s39, s47, 36864
  buffer_load_dwordx4 v[144:147], v2, s[8:11], s39 offen offset:0
  s_waitcnt lgkmcnt(6)
  v_mfma_f32_32x32x16_bf16 v[96:111], v[204:207], v[164:167], v[96:111]
  ds_read_b64_tr_b16 v[188:189], v6 offset:8960
  ds_read_b64_tr_b16 v[190:191], v6 offset:9984
  buffer_load_dwordx4 v[148:151], v2, s[8:11], s39 offen offset:1024
  s_waitcnt lgkmcnt(6)
  v_mfma_f32_32x32x16_bf16 v[48:63], v[176:179], v[168:171], v[48:63]
  ds_read_b64_tr_b16 v[192:193], v6 offset:12288
  ds_read_b64_tr_b16 v[194:195], v6 offset:13312
  s_waitcnt lgkmcnt(6)
  v_mfma_f32_32x32x16_bf16 v[64:79], v[180:183], v[168:171], v[64:79]
  ds_read_b64_tr_b16 v[196:197], v6 offset:12544
  ds_read_b64_tr_b16 v[198:199], v6 offset:13568
  s_waitcnt lgkmcnt(6)
  v_mfma_f32_32x32x16_bf16 v[80:95], v[184:187], v[168:171], v[80:95]
  ds_read_b64_tr_b16 v[200:201], v6 offset:12800
  ds_read_b64_tr_b16 v[202:203], v6 offset:13824
  buffer_load_dwordx4 v[152:155], v2, s[8:11], s39 offen offset:2048
  s_waitcnt lgkmcnt(6)
  v_mfma_f32_32x32x16_bf16 v[96:111], v[188:191], v[168:171], v[96:111]
  ds_read_b64_tr_b16 v[204:205], v6 offset:13056
  ds_read_b64_tr_b16 v[206:207], v6 offset:14080
  buffer_load_dwordx4 v[156:159], v2, s[8:11], s39 offen offset:3072
  s_waitcnt vmcnt(17)
  s_barrier
  s_waitcnt lgkmcnt(6)
  v_mfma_f32_32x32x16_bf16 v[48:63], v[192:195], v[172:175], v[48:63]
  ds_read_b64_tr_b16 v[176:177], v6 offset:16384
  ds_read_b64_tr_b16 v[178:179], v6 offset:17408
  s_waitcnt lgkmcnt(6)
  v_mfma_f32_32x32x16_bf16 v[64:79], v[196:199], v[172:175], v[64:79]
  ds_read_b64_tr_b16 v[180:181], v6 offset:16640
  ds_read_b64_tr_b16 v[182:183], v6 offset:17664
  s_waitcnt lgkmcnt(6)
  v_mfma_f32_32x32x16_bf16 v[80:95], v[200:203], v[172:175], v[80:95]
  ds_read_b64_tr_b16 v[184:185], v6 offset:16896
  ds_read_b64_tr_b16 v[186:187], v6 offset:17920
  s_waitcnt lgkmcnt(6)
  v_mfma_f32_32x32x16_bf16 v[96:111], v[204:207], v[172:175], v[96:111]
  ds_read_b64_tr_b16 v[188:189], v6 offset:17152
  ds_read_b64_tr_b16 v[190:191], v6 offset:18176
  s_waitcnt vmcnt(13)
  s_waitcnt lgkmcnt(6)
  v_mfma_f32_32x32x16_bf16 v[48:63], v[176:179], v[112:115], v[48:63]
  ds_read_b64_tr_b16 v[192:193], v6 offset:20480
  ds_read_b64_tr_b16 v[194:195], v6 offset:21504
  s_waitcnt lgkmcnt(6)
  v_mfma_f32_32x32x16_bf16 v[64:79], v[180:183], v[112:115], v[64:79]
  ds_read_b64_tr_b16 v[196:197], v6 offset:20736
  ds_read_b64_tr_b16 v[198:199], v6 offset:21760
  s_waitcnt lgkmcnt(6)
  v_mfma_f32_32x32x16_bf16 v[80:95], v[184:187], v[112:115], v[80:95]
  ds_read_b64_tr_b16 v[200:201], v6 offset:20992
  ds_read_b64_tr_b16 v[202:203], v6 offset:22016
  s_add_u32 s45, s34, 0
  s_add_u32 m0, s35, 0
  s_nop 0
  buffer_load_dwordx4 v2, s[12:15], s45 offen offset:0 lds
  s_waitcnt lgkmcnt(6)
  v_mfma_f32_32x32x16_bf16 v[96:111], v[188:191], v[112:115], v[96:111]
  ds_read_b64_tr_b16 v[204:205], v6 offset:21248
  ds_read_b64_tr_b16 v[206:207], v6 offset:22272
  buffer_load_dwordx4 v2, s[12:15], s45 offen offset:1024 lds
  s_waitcnt lgkmcnt(6)
  v_mfma_f32_32x32x16_bf16 v[48:63], v[192:195], v[116:119], v[48:63]
  ds_read_b64_tr_b16 v[176:177], v6 offset:24576
  ds_read_b64_tr_b16 v[178:179], v6 offset:25600
  s_waitcnt lgkmcnt(6)
  v_mfma_f32_32x32x16_bf16 v[64:79], v[196:199], v[116:119], v[64:79]
  ds_read_b64_tr_b16 v[180:181], v6 offset:24832
  ds_read_b64_tr_b16 v[182:183], v6 offset:25856
  s_waitcnt lgkmcnt(6)
  v_mfma_f32_32x32x16_bf16 v[80:95], v[200:203], v[116:119], v[80:95]
  ds_read_b64_tr_b16 v[184:185], v6 offset:25088
  ds_read_b64_tr_b16 v[186:187], v6 offset:26112
  buffer_load_dwordx4 v2, s[12:15], s45 offen offset:2048 lds
  s_waitcnt lgkmcnt(6)
  v_mfma_f32_32x32x16_bf16 v[96:111], v[204:207], v[116:119], v[96:111]
  ds_read_b64_tr_b16 v[188:189], v6 offset:25344
  ds_read_b64_tr_b16 v[190:191], v6 offset:26368
  buffer_load_dwordx4 v2, s[12:15], s45 offen offset:3072 lds
  s_waitcnt lgkmcnt(6)
  v_mfma_f32_32x32x16_bf16 v[48:63], v[176:179], v[120:123], v[48:63]
  ds_read_b64_tr_b16 v[192:193], v6 offset:28672
  ds_read_b64_tr_b16 v[194:195], v6 offset:29696
  s_waitcnt lgkmcnt(6)
  v_mfma_f32_32x32x16_bf16 v[64:79], v[180:183], v[120:123], v[64:79]
  ds_read_b64_tr_b16 v[196:197], v6 offset:28928
  ds_read_b64_tr_b16 v[198:199], v6 offset:29952
  s_waitcnt lgkmcnt(6)
  v_mfma_f32_32x32x16_bf16 v[80:95], v[184:187], v[120:123], v[80:95]
  ds_read_b64_tr_b16 v[200:201], v6 offset:29184
  ds_read_b64_tr_b16 v[202:203], v6 offset:30208
  s_waitcnt lgkmcnt(6)
  v_mfma_f32_32x32x16_bf16 v[96:111], v[188:191], v[120:123], v[96:111]
  ds_read_b64_tr_b16 v[204:205], v6 offset:29440
  ds_read_b64_tr_b16 v[206:207], v6 offset:30464
  s_waitcnt vmcnt(14)
  s_barrier
  s_waitcnt lgkmcnt(6)
  v_mfma_f32_32x32x16_bf16 v[48:63], v[192:195], v[124:127], v[48:63]
  ds_read_b64_tr_b16 v[176:177], v4 offset:32768
  ds_read_b64_tr_b16 v[178:179], v4 offset:33792
  s_waitcnt lgkmcnt(6)
  v_mfma_f32_32x32x16_bf16 v[64:79], v[196:199], v[124:127], v[64:79]
  ds_read_b64_tr_b16 v[180:181], v4 offset:33024
  ds_read_b64_tr_b16 v[182:183], v4 offset:34048
  s_waitcnt lgkmcnt(6)
  v_mfma_f32_32x32x16_bf16 v[80:95], v[200:203], v[124:127], v[80:95]
  ds_read_b64_tr_b16 v[184:185], v4 offset:33280
  ds_read_b64_tr_b16 v[186:187], v4 offset:34304
  s_waitcnt lgkmcnt(6)
  v_mfma_f32_32x32x16_bf16 v[96:111], v[204:207], v[124:127], v[96:111]
  ds_read_b64_tr_b16 v[188:189], v4 offset:33536
  ds_read_b64_tr_b16 v[190:191], v4 offset:34560
  s_waitcnt vmcnt(10)
  s_waitcnt lgkmcnt(6)
  v_mfma_f32_32x32x16_bf16 v[48:63], v[176:179], v[128:131], v[48:63]
  ds_read_b64_tr_b16 v[192:193], v4 offset:36864
  ds_read_b64_tr_b16 v[194:195], v4 offset:37888
  s_waitcnt lgkmcnt(6)
  v_mfma_f32_32x32x16_bf16 v[64:79], v[180:183], v[128:131], v[64:79]
  ds_read_b64_tr_b16 v[196:197], v4 offset:37120
  ds_read_b64_tr_b16 v[198:199], v4 offset:38144
  s_waitcnt lgkmcnt(6)
  v_mfma_f32_32x32x16_bf16 v[80:95], v[184:187], v[128:131], v[80:95]
  ds_read_b64_tr_b16 v[200:201], v4 offset:37376
  ds_read_b64_tr_b16 v[202:203], v4 offset:38400
  s_add_u32 s45, s34, 16384
  s_add_u32 m0, s35, 16384
  s_nop 0
  buffer_load_dwordx4 v2, s[12:15], s45 offen offset:0 lds
  s_waitcnt lgkmcnt(6)
  v_mfma_f32_32x32x16_bf16 v[96:111], v[188:191], v[128:131], v[96:111]
  ds_read_b64_tr_b16 v[204:205], v4 offset:37632
  ds_read_b64_tr_b16 v[206:207], v4 offset:38656
  buffer_load_dwordx4 v2, s[12:15], s45 offen offset:1024 lds
  s_waitcnt lgkmcnt(6)
  v_mfma_f32_32x32x16_bf16 v[48:63], v[192:195], v[132:135], v[48:63]
  ds_read_b64_tr_b16 v[176:177], v4 offset:40960
  ds_read_b64_tr_b16 v[178:179], v4 offset:41984
  s_waitcnt lgkmcnt(6)
  v_mfma_f32_32x32x16_bf16 v[64:79], v[196:199], v[132:135], v[64:79]
  ds_read_b64_tr_b16 v[180:181], v4 offset:41216
  ds_read_b64_tr_b16 v[182:183], v4 offset:42240
  s_waitcnt lgkmcnt(6)
  v_mfma_f32_32x32x16_bf16 v[80:95], v[200:203], v[132:135], v[80:95]
  ds_read_b64_tr_b16 v[184:185], v4 offset:41472
  ds_read_b64_tr_b16 v[186:187], v4 offset:42496
  buffer_load_dwordx4 v2, s[12:15], s45 offen offset:2048 lds
  s_waitcnt lgkmcnt(6)
  v_mfma_f32_32x32x16_bf16 v[96:111], v[204:207], v[132:135], v[96:111]
  ds_read_b64_tr_b16 v[188:189], v4 offset:41728
  ds_read_b64_tr_b16 v[190:191], v4 offset:42752
  buffer_load_dwordx4 v2, s[12:15], s45 offen offset:3072 lds
  s_waitcnt lgkmcnt(6)
  v_mfma_f32_32x32x16_bf16 v[48:63], v[176:179], v[136:139], v[48:63]
  ds_read_b64_tr_b16 v[192:193], v4 offset:45056
  ds_read_b64_tr_b16 v[194:195], v4 offset:46080
  s_waitcnt lgkmcnt(6)
  v_mfma_f32_32x32x16_bf16 v[64:79], v[180:183], v[136:139], v[64:79]
  ds_read_b64_tr_b16 v[196:197], v4 offset:45312
  ds_read_b64_tr_b16 v[198:199], v4 offset:46336
  s_waitcnt lgkmcnt(6)
  v_mfma_f32_32x32x16_bf16 v[80:95], v[184:187], v[136:139], v[80:95]
  ds_read_b64_tr_b16 v[200:201], v4 offset:45568
  ds_read_b64_tr_b16 v[202:203], v4 offset:46592
  s_waitcnt lgkmcnt(6)
  v_mfma_f32_32x32x16_bf16 v[96:111], v[188:191], v[136:139], v[96:111]
  ds_read_b64_tr_b16 v[204:205], v4 offset:45824
  ds_read_b64_tr_b16 v[206:207], v4 offset:46848
  s_waitcnt vmcnt(12)
  s_barrier
  s_waitcnt lgkmcnt(6)
  v_mfma_f32_32x32x16_bf16 v[48:63], v[192:195], v[140:143], v[48:63]
  ds_read_b64_tr_b16 v[176:177], v4 offset:49152
  ds_read_b64_tr_b16 v[178:179], v4 offset:50176
  s_waitcnt lgkmcnt(6)
  v_mfma_f32_32x32x16_bf16 v[64:79], v[196:199], v[140:143], v[64:79]
  ds_read_b64_tr_b16 v[180:181], v4 offset:49408
  ds_read_b64_tr_b16 v[182:183], v4 offset:50432
  s_waitcnt lgkmcnt(6)
  v_mfma_f32_32x32x16_bf16 v[80:95], v[200:203], v[140:143], v[80:95]
  ds_read_b64_tr_b16 v[184:185], v4 offset:49664
  ds_read_b64_tr_b16 v[186:187], v4 offset:50688
  s_waitcnt lgkmcnt(6)
  v_mfma_f32_32x32x16_bf16 v[96:111], v[204:207], v[140:143], v[96:111]
  ds_read_b64_tr_b16 v[188:189], v4 offset:49920
  ds_read_b64_tr_b16 v[190:191], v4 offset:50944
  s_waitcnt vmcnt(8)
  s_waitcnt lgkmcnt(6)
  v_mfma_f32_32x32x16_bf16 v[48:63], v[176:179], v[144:147], v[48:63]
  ds_read_b64_tr_b16 v[192:193], v4 offset:53248
  ds_read_b64_tr_b16 v[194:195], v4 offset:54272
  s_waitcnt lgkmcnt(6)
  v_mfma_f32_32x32x16_bf16 v[64:79], v[180:183], v[144:147], v[64:79]
  ds_read_b64_tr_b16 v[196:197], v4 offset:53504
  ds_read_b64_tr_b16 v[198:199], v4 offset:54528
  s_waitcnt lgkmcnt(6)
  v_mfma_f32_32x32x16_bf16 v[80:95], v[184:187], v[144:147], v[80:95]
  ds_read_b64_tr_b16 v[200:201], v4 offset:53760
  ds_read_b64_tr_b16 v[202:203], v4 offset:54784
  s_waitcnt lgkmcnt(6)
  v_mfma_f32_32x32x16_bf16 v[96:111], v[188:191], v[144:147], v[96:111]
  ds_read_b64_tr_b16 v[204:205], v4 offset:54016
  ds_read_b64_tr_b16 v[206:207], v4 offset:55040
  s_waitcnt lgkmcnt(6)
  v_mfma_f32_32x32x16_bf16 v[48:63], v[192:195], v[148:151], v[48:63]
  ds_read_b64_tr_b16 v[176:177], v4 offset:57344
  ds_read_b64_tr_b16 v[178:179], v4 offset:58368
  s_waitcnt lgkmcnt(6)
  v_mfma_f32_32x32x16_bf16 v[64:79], v[196:199], v[148:151], v[64:79]
  ds_read_b64_tr_b16 v[180:181], v4 offset:57600
  ds_read_b64_tr_b16 v[182:183], v4 offset:58624
  s_waitcnt lgkmcnt(6)
  v_mfma_f32_32x32x16_bf16 v[80:95], v[200:203], v[148:151], v[80:95]
  ds_read_b64_tr_b16 v[184:185], v4 offset:57856
  ds_read_b64_tr_b16 v[186:187], v4 offset:58880
  s_waitcnt lgkmcnt(6)
  v_mfma_f32_32x32x16_bf16 v[96:111], v[204:207], v[148:151], v[96:111]
  ds_read_b64_tr_b16 v[188:189], v4 offset:58112
  ds_read_b64_tr_b16 v[190:191], v4 offset:59136
  s_waitcnt lgkmcnt(6)
  v_mfma_f32_32x32x16_bf16 v[48:63], v[176:179], v[152:155], v[48:63]
  ds_read_b64_tr_b16 v[192:193], v4 offset:61440
  ds_read_b64_tr_b16 v[194:195], v4 offset:62464
  s_waitcnt lgkmcnt(6)
  v_mfma_f32_32x32x16_bf16 v[64:79], v[180:183], v[152:155], v[64:79]
  ds_read_b64_tr_b16 v[196:197], v4 offset:61696
  ds_read_b64_tr_b16 v[198:199], v4 offset:62720
  s_waitcnt lgkmcnt(6)
  v_mfma_f32_32x32x16_bf16 v[80:95], v[184:187], v[152:155], v[80:95]
  ds_read_b64_tr_b16 v[200:201], v4 offset:61952
  ds_read_b64_tr_b16 v[202:203], v4 offset:62976
  s_waitcnt lgkmcnt(6)
  v_mfma_f32_32x32x16_bf16 v[96:111], v[188:191], v[152:155], v[96:111]
  ds_read_b64_tr_b16 v[204:205], v4 offset:62208
  ds_read_b64_tr_b16 v[206:207], v4 offset:63232
  s_waitcnt lgkmcnt(6)
  v_mfma_f32_32x32x16_bf16 v[48:63], v[192:195], v[156:159], v[48:63]
  s_waitcnt lgkmcnt(4)
  v_mfma_f32_32x32x16_bf16 v[64:79], v[196:199], v[156:159], v[64:79]
  s_waitcnt lgkmcnt(2)
  v_mfma_f32_32x32x16_bf16 v[80:95], v[200:203], v[156:159], v[80:95]
  s_waitcnt lgkmcnt(0)
  v_mfma_f32_32x32x16_bf16 v[96:111], v[204:207], v[156:159], v[96:111]
  s_nop 5
  v_mul_f32 v48, s37, v48
  v_mul_f32 v49, s37, v49
  v_mul_f32 v50, s37, v50
  v_mul_f32 v51, s37, v51
  v_cvt_pk_bf16_f32 v16, v48, v49
  v_mul_f32 v52, s37, v52
  v_mul_f32 v53, s37, v53
  v_cvt_pk_bf16_f32 v17, v50, v51
  v_mul_f32 v54, s37, v54
  v_mul_f32 v55, s37, v55
  v_cvt_pk_bf16_f32 v18, v52, v53
  v_mul_f32 v56, s37, v56
  v_mul_f32 v57, s37, v57
  v_cvt_pk_bf16_f32 v19, v54, v55
  v_mul_f32 v58, s37, v58
  v_mul_f32 v59, s37, v59
  v_cvt_pk_bf16_f32 v20, v56, v57
  v_mul_f32 v60, s37, v60
  v_mul_f32 v61, s37, v61
  v_cvt_pk_bf16_f32 v21, v58, v59
  v_mul_f32 v62, s37, v62
  v_mul_f32 v63, s37, v63
  v_cvt_pk_bf16_f32 v22, v60, v61
  v_mul_f32 v64, s37, v64
  v_mul_f32 v65, s37, v65
  v_cvt_pk_bf16_f32 v23, v62, v63
  v_mul_f32 v66, s37, v66
  v_mul_f32 v67, s37, v67
  v_cvt_pk_bf16_f32 v24, v64, v65
  v_mul_f32 v68, s37, v68
  v_mul_f32 v69, s37, v69
  v_cvt_pk_bf16_f32 v25, v66, v67
  v_mul_f32 v70, s37, v70
  v_mul_f32 v71, s37, v71
  v_cvt_pk_bf16_f32 v26, v68, v69
  v_mul_f32 v72, s37, v72
  v_mul_f32 v73, s37, v73
  v_cvt_pk_bf16_f32 v27, v70, v71
  v_mul_f32 v74, s37, v74
  v_mul_f32 v75, s37, v75
  v_cvt_pk_bf16_f32 v28, v72, v73
  v_mul_f32 v76, s37, v76
  v_mul_f32 v77, s37, v77
  v_cvt_pk_bf16_f32 v29, v74, v75
  v_mul_f32 v78, s37, v78
  v_mul_f32 v79, s37, v79
  v_cvt_pk_bf16_f32 v30, v76, v77
  v_mul_f32 v80, s37, v80
  v_mul_f32 v81, s37, v81
  v_cvt_pk_bf16_f32 v31, v78, v79
  v_mul_f32 v82, s37, v82
  v_mul_f32 v83, s37, v83
  v_cvt_pk_bf16_f32 v32, v80, v81
  v_mul_f32 v84, s37, v84
  v_mul_f32 v85, s37, v85
  v_cvt_pk_bf16_f32 v33, v82, v83
  v_mul_f32 v86, s37, v86
  v_mul_f32 v87, s37, v87
  v_cvt_pk_bf16_f32 v34, v84, v85
  v_mul_f32 v88, s37, v88
  v_mul_f32 v89, s37, v89
  v_cvt_pk_bf16_f32 v35, v86, v87
  v_mul_f32 v90, s37, v90
  v_mul_f32 v91, s37, v91
  v_cvt_pk_bf16_f32 v36, v88, v89
  v_mul_f32 v92, s37, v92
  v_mul_f32 v93, s37, v93
  v_cvt_pk_bf16_f32 v37, v90, v91
  v_mul_f32 v94, s37, v94
  v_mul_f32 v95, s37, v95
  v_cvt_pk_bf16_f32 v38, v92, v93
  v_mul_f32 v96, s37, v96
  v_mul_f32 v97, s37, v97
  v_cvt_pk_bf16_f32 v39, v94, v95
  v_mul_f32 v98, s37, v98
  v_mul_f32 v99, s37, v99
  v_cvt_pk_bf16_f32 v40, v96, v97
  v_mul_f32 v100, s37, v100
  v_mul_f32 v101, s37, v101
  v_cvt_pk_bf16_f32 v41, v98, v99
  v_mul_f32 v102, s37, v102
  v_mul_f32 v103, s37, v103
  v_cvt_pk_bf16_f32 v42, v100, v101
  v_mul_f32 v104, s37, v104
  v_mul_f32 v105, s37, v105
  v_cvt_pk_bf16_f32 v43, v102, v103
  v_mul_f32 v106, s37, v106
  v_mul_f32 v107, s37, v107
  v_cvt_pk_bf16_f32 v44, v104, v105
  v_mul_f32 v108, s37, v108
  v_mul_f32 v109, s37, v109
  v_cvt_pk_bf16_f32 v45, v106, v107
  v_mul_f32 v110, s37, v110
  v_mul_f32 v111, s37, v111
  v_cvt_pk_bf16_f32 v46, v108, v109
  v_cvt_pk_bf16_f32 v47, v110, v111
  s_cmp_eq_u32 s27, 0
  s_cbranch_scc1 kva_kernel_qx_19
  s_lshl_b32 s38, s28, 13
  s_add_u32 s38, s38, 0x20000
  v_add_u32 v240, s38, v2
  ds_write_b128 v240, v[16:19] offset:0
  ds_write_b128 v240, v[20:23] offset:1024
  ds_write_b128 v240, v[24:27] offset:2048
  ds_write_b128 v240, v[28:31] offset:3072
  ds_write_b128 v240, v[32:35] offset:4096
  ds_write_b128 v240, v[36:39] offset:5120
  ds_write_b128 v240, v[40:43] offset:6144
  ds_write_b128 v240, v[44:47] offset:7168
kva_kernel_qx_19:
  s_waitcnt vmcnt(4)
  s_barrier
  ds_read_b128 v[176:179], v7 offset:0
  ds_read_b128 v[180:183], v7 offset:1024
  ds_read_b128 v[184:187], v7 offset:2048
  ds_read_b128 v[188:191], v7 offset:3072
  s_movk_i32 s38, 1280
  v_add_u32 v240, 0, v0
  v_mul_u32_u24 v241, 0xccd, v240
  v_lshrrev_b32 v241, 18, v241
  v_mul_u32_u24 v242, 80, v241
  v_sub_u32 v240, v240, v242
  v_bfe_u32 v242, v240, 2, 2
  v_lshl_add_u32 v241, v241, 2, v242
  v_mul_lo_u32 v241, v241, s38
  v_lshrrev_b32 v242, 4, v240
  v_lshl_add_u32 v241, v242, 6, v241
  v_and_b32 v242, 3, v240
  v_lshl_add_u32 v3, v242, 4, v241
  v_add_u32 v240, 64, v0
  v_mul_u32_u24 v241, 0xccd, v240
  v_lshrrev_b32 v241, 18, v241
  v_mul_u32_u24 v242, 80, v241
  v_sub_u32 v240, v240, v242
  v_bfe_u32 v242, v240, 2, 2
  v_lshl_add_u32 v241, v241, 2, v242
  v_mul_lo_u32 v241, v241, s38
  v_lshrrev_b32 v242, 4, v240
  v_lshl_add_u32 v241, v242, 6, v241
  v_and_b32 v242, 3, v240
  v_lshl_add_u32 v4, v242, 4, v241
  v_add_u32 v240, 128, v0
  v_mul_u32_u24 v241, 0xccd, v240
  v_lshrrev_b32 v241, 18, v241
  v_mul_u32_u24 v242, 80, v241
  v_sub_u32 v240, v240, v242
  v_bfe_u32 v242, v240, 2, 2
  v_lshl_add_u32 v241, v241, 2, v242
  v_mul_lo_u32 v241, v241, s38
  v_lshrrev_b32 v242, 4, v240
  v_lshl_add_u32 v241, v242, 6, v241
  v_and_b32 v242, 3, v240
  v_lshl_add_u32 v5, v242, 4, v241
  v_add_u32 v240, 192, v0
  v_mul_u32_u24 v241, 0xccd, v240
  v_lshrrev_b32 v241, 18, v241
  v_mul_u32_u24 v242, 80, v241
  v_sub_u32 v240, v240, v242
  v_bfe_u32 v242, v240, 2, 2
  v_lshl_add_u32 v241, v241, 2, v242
  v_mul_lo_u32 v241, v241, s38
  v_lshrrev_b32 v242, 4, v240
  v_lshl_add_u32 v241, v242, 6, v241
  v_and_b32 v242, 3, v240
  v_lshl_add_u32 v6, v242, 4, v241
  v_add_u32 v240, 256, v0
  v_mul_u32_u24 v241, 0xccd, v240
  v_lshrrev_b32 v241, 18, v241
  v_mul_u32_u24 v242, 80, v241
  v_sub_u32 v240, v240, v242
  v_bfe_u32 v242, v240, 2, 2
  v_lshl_add_u32 v241, v241, 2, v242
  v_mul_lo_u32 v241, v241, s38
  v_lshrrev_b32 v242, 4, v240
  v_lshl_add_u32 v241, v242, 6, v241
  v_and_b32 v242, 3, v240
  v_lshl_add_u32 v12, v242, 4, v241
  s_mov_b64 s[4:5], s[92:93]
  s_mov_b32 s6, 5242880
  s_mov_b32 s7, 0x00020000
  s_and_b32 s73, s2, 3
  s_lshl_b32 s73, s73, 10
  s_lshr_b32 s38, s3, 2
  s_lshl_b32 s38, s38, 9
  s_add_u32 s73, s73, s38
  s_and_b32 s38, s3, 3
  s_lshl_b32 s38, s38, 4
  s_add_u32 s73, s73, s38
  s_mul_i32 s73, s73, 1280
  s_bfe_u32 s38, s2, 0x20003
  s_mul_i32 s38, s38, 320
  s_add_u32 s73, s73, s38
  s_mul_i32 s74, s3, 5120
  v_mov_b32 v48, 0
  v_mov_b32 v49, 0
  v_mov_b32 v50, 0
  v_mov_b32 v51, 0
  v_mov_b32 v52, 0
  v_mov_b32 v53, 0
  v_mov_b32 v54, 0
  v_mov_b32 v55, 0
  v_mov_b32 v56, 0
  v_mov_b32 v57, 0
  v_mov_b32 v58, 0
  v_mov_b32 v59, 0
  v_mov_b32 v60, 0
  v_mov_b32 v61, 0
  v_mov_b32 v62, 0
  v_mov_b32 v63, 0
  v_mov_b32 v64, 0
  v_mov_b32 v65, 0
  v_mov_b32 v66, 0
  v_mov_b32 v67, 0
  v_mov_b32 v68, 0
  v_mov_b32 v69, 0
  v_mov_b32 v70, 0
  v_mov_b32 v71, 0
  v_mov_b32 v72, 0
  v_mov_b32 v73, 0
  v_mov_b32 v74, 0
  v_mov_b32 v75, 0
  v_mov_b32 v76, 0
  v_mov_b32 v77, 0
  v_mov_b32 v78, 0
  v_mov_b32 v79, 0
  v_mov_b32 v80, 0
  v_mov_b32 v81, 0
  v_mov_b32 v82, 0
  v_mov_b32 v83, 0
  v_mov_b32 v84, 0
  v_mov_b32 v85, 0
  v_mov_b32 v86, 0
  v_mov_b32 v87, 0
  v_mov_b32 v88, 0
  v_mov_b32 v89, 0
  v_mov_b32 v90, 0
  v_mov_b32 v91, 0
  v_mov_b32 v92, 0
  v_mov_b32 v93, 0
  v_mov_b32 v94, 0
  v_mov_b32 v95, 0
  v_mov_b32 v96, 0
  v_mov_b32 v97, 0
  v_mov_b32 v98, 0
  v_mov_b32 v99, 0
  v_mov_b32 v100, 0
  v_mov_b32 v101, 0
  v_mov_b32 v102, 0
  v_mov_b32 v103, 0
  v_mov_b32 v104, 0
  v_mov_b32 v105, 0
  v_mov_b32 v106, 0
  v_mov_b32 v107, 0
  v_mov_b32 v108, 0
  v_mov_b32 v109, 0
  v_mov_b32 v110, 0
  v_mov_b32 v111, 0
  v_mov_b32 v9, 0
  s_mov_b32 s32, 0
  s_mov_b64 s[56:57], -1
  s_waitcnt lgkmcnt(3)
  v_mfma_f32_32x32x16_bf16 v[112:127], v[176:179], v[16:19], 0
  ds_read_b128 v[176:179], v7 offset:4096
  s_waitcnt lgkmcnt(3)
  v_mfma_f32_32x32x16_bf16 v[112:127], v[180:183], v[20:23], v[112:127]
  ds_read_b128 v[180:183], v7 offset:5120
  s_waitcnt lgkmcnt(3)
  v_mfma_f32_32x32x16_bf16 v[112:127], v[184:187], v[24:27], v[112:127]
  ds_read_b128 v[184:187], v7 offset:6144
  s_waitcnt lgkmcnt(3)
  v_mfma_f32_32x32x16_bf16 v[112:127], v[188:191], v[28:31], v[112:127]
  ds_read_b128 v[188:191], v7 offset:7168
  s_waitcnt lgkmcnt(3)
  v_mfma_f32_32x32x16_bf16 v[112:127], v[176:179], v[32:35], v[112:127]
  ds_read_b128 v[176:179], v7 offset:8192
  s_waitcnt lgkmcnt(3)
  v_mfma_f32_32x32x16_bf16 v[112:127], v[180:183], v[36:39], v[112:127]
  ds_read_b128 v[180:183], v7 offset:9216
  s_waitcnt lgkmcnt(3)
  v_mfma_f32_32x32x16_bf16 v[112:127], v[184:187], v[40:43], v[112:127]
  ds_read_b128 v[184:187], v7 offset:10240
  s_waitcnt lgkmcnt(3)
  v_mfma_f32_32x32x16_bf16 v[112:127], v[188:191], v[44:47], v[112:127]
  ds_read_b128 v[188:191], v7 offset:11264
  s_waitcnt lgkmcnt(3)
  v_mfma_f32_32x32x16_bf16 v[128:143], v[176:179], v[16:19], 0
  ds_read_b128 v[176:179], v7 offset:12288
  s_waitcnt lgkmcnt(3)
  v_mfma_f32_32x32x16_bf16 v[128:143], v[180:183], v[20:23], v[128:143]
  ds_read_b128 v[180:183], v7 offset:13312
  s_waitcnt lgkmcnt(3)
  v_mfma_f32_32x32x16_bf16 v[128:143], v[184:187], v[24:27], v[128:143]
  ds_read_b128 v[184:187], v7 offset:14336
  s_waitcnt lgkmcnt(3)
  v_mfma_f32_32x32x16_bf16 v[128:143], v[188:191], v[28:31], v[128:143]
  ds_read_b128 v[188:191], v7 offset:15360
  s_waitcnt lgkmcnt(3)
  v_mfma_f32_32x32x16_bf16 v[128:143], v[176:179], v[32:35], v[128:143]
  s_waitcnt lgkmcnt(2)
  v_mfma_f32_32x32x16_bf16 v[128:143], v[180:183], v[36:39], v[128:143]
  s_waitcnt vmcnt(0) lgkmcnt(0)
  s_barrier
  s_lshl_b32 s46, s32, 1
  s_sub_u32 s46, s46, s31
  s_cmp_lt_u32 s32, s30
  s_cselect_b32 s46, s32, s46
  s_lshl_b32 s46, s46, 14
  s_add_u32 s46, s46, s34
  s_add_u32 m0, s35, 32768
  s_nop 0
  buffer_load_dwordx4 v2, s[16:19], s46 offen lds
  v_mfma_f32_32x32x16_bf16 v[128:143], v[184:187], v[40:43], v[128:143]
  buffer_load_dwordx4 v2, s[16:19], s46 offen offset:1024 lds
  v_mfma_f32_32x32x16_bf16 v[128:143], v[188:191], v[44:47], v[128:143]
  s_bitcmp1_b32 s33, s32
  s_cbranch_scc1 kva_kernel_sp_20
kva_kernel_spb_21:
  v_mov_b32 v192, 0
  v_mov_b32 v193, 0
  v_mov_b32 v194, 0
  v_mov_b32 v195, 0
  v_mov_b32 v196, 0
  v_mov_b32 v197, 0
  v_mov_b32 v198, 0
  v_mov_b32 v199, 0
  v_mov_b32 v200, 0
  v_mov_b32 v201, 0
  v_mov_b32 v202, 0
  v_mov_b32 v203, 0
  v_mov_b32 v204, 0
  v_mov_b32 v205, 0
  v_mov_b32 v206, 0
  v_mov_b32 v207, 0
  v_max3_f32 v240, v112, v113, v114
  v_max3_f32 v241, v115, v116, v117
  v_max3_f32 v240, v240, v118, v119
  v_max3_f32 v241, v241, v120, v121
  v_max3_f32 v240, v240, v122, v123
  v_max3_f32 v241, v241, v124, v125
  v_max3_f32 v240, v240, v126, v127
  v_max3_f32 v241, v241, v128, v129
  v_max3_f32 v240, v240, v130, v131
  v_max3_f32 v241, v241, v132, v133
  v_max3_f32 v240, v240, v134, v135
  v_max3_f32 v241, v241, v136, v137
  v_max3_f32 v240, v240, v138, v139
  v_max3_f32 v241, v241, v140, v141
  v_max3_f32 v240, v240, v142, v143
  v_max_f32 v240, v240, v241
  v_mov_b32 v241, v240
  s_nop 1
  v_permlane32_swap_b32 v240, v241
  v_max_f32 v240, v240, v241
  v_sub_f32 v112, v112, v240
  v_sub_f32 v113, v113, v240
  v_sub_f32 v114, v114, v240
  v_sub_f32 v115, v115, v240
  v_sub_f32 v116, v116, v240
  v_sub_f32 v117, v117, v240
  v_sub_f32 v118, v118, v240
  v_sub_f32 v119, v119, v240
  v_sub_f32 v120, v120, v240
  v_sub_f32 v121, v121, v240
  v_sub_f32 v122, v122, v240
  v_sub_f32 v123, v123, v240
  v_sub_f32 v124, v124, v240
  v_sub_f32 v125, v125, v240
  v_sub_f32 v126, v126, v240
  v_sub_f32 v127, v127, v240
  v_sub_f32 v128, v128, v240
  v_sub_f32 v129, v129, v240
  v_sub_f32 v130, v130, v240
  v_sub_f32 v131, v131, v240
  v_sub_f32 v132, v132, v240
  v_sub_f32 v133, v133, v240
  v_sub_f32 v134, v134, v240
  v_sub_f32 v135, v135, v240
  v_sub_f32 v136, v136, v240
  v_sub_f32 v137, v137, v240
  v_sub_f32 v138, v138, v240
  v_sub_f32 v139, v139, v240
  v_sub_f32 v140, v140, v240
  v_sub_f32 v141, v141, v240
  v_sub_f32 v142, v142, v240
  v_sub_f32 v143, v143, v240
  v_sub_f32 v192, v192, v240
  v_sub_f32 v193, v193, v240
  v_sub_f32 v194, v194, v240
  v_sub_f32 v195, v195, v240
  v_sub_f32 v196, v196, v240
  v_sub_f32 v197, v197, v240
  v_sub_f32 v198, v198, v240
  v_sub_f32 v199, v199, v240
  v_sub_f32 v200, v200, v240
  v_sub_f32 v201, v201, v240
  v_sub_f32 v202, v202, v240
  v_sub_f32 v203, v203, v240
  v_sub_f32 v204, v204, v240
  v_sub_f32 v205, v205, v240
  v_sub_f32 v206, v206, v240
  v_sub_f32 v207, v207, v240
  buffer_load_dwordx4 v2, s[16:19], s46 offen offset:2048 lds
  buffer_load_dwordx4 v2, s[16:19], s46 offen offset:3072 lds
  s_add_u32 s39, s32, 2
  s_lshl_b32 s45, s39, 1
  s_sub_u32 s45, s45, s31
  s_cmp_lt_u32 s39, s30
  s_cselect_b32 s45, s39, s45
  s_lshl_b32 s45, s45, 14
  s_add_u32 s45, s45, s34
  s_cmp_lt_u32 s32, 15
  s_cselect_b64 s[56:57], -1, 0
  s_add_u32 m0, s35, 0
  s_mov_b64 exec, s[56:57]
  buffer_load_dwordx4 v2, s[12:15], s45 offen offset:0 lds
  s_mov_b64 exec, -1
  s_mov_b64 exec, s[56:57]
  buffer_load_dwordx4 v2, s[12:15], s45 offen offset:1024 lds
  s_mov_b64 exec, -1
  s_mov_b64 exec, s[56:57]
  buffer_load_dwordx4 v2, s[12:15], s45 offen offset:2048 lds
  s_mov_b64 exec, -1
  s_mov_b64 exec, s[56:57]
  buffer_load_dwordx4 v2, s[12:15], s45 offen offset:3072 lds
  s_mov_b64 exec, -1
  v_exp_f32 v232, v112
  v_exp_f32 v233, v113
  v_exp_f32 v234, v114
  v_add_f32 v10, v232, v233
  v_cvt_pk_bf16_f32 v208, v232, v233
  v_exp_f32 v235, v115
  v_add_f32 v10, v10, v234
  v_exp_f32 v236, v116
  v_add_f32 v10, v10, v235
  v_cvt_pk_bf16_f32 v209, v234, v235
  v_exp_f32 v237, v117
  v_add_f32 v10, v10, v236
  v_exp_f32 v238, v118
  v_add_f32 v10, v10, v237
  v_cvt_pk_bf16_f32 v210, v236, v237
  v_exp_f32 v239, v119
  v_add_f32 v10, v10, v238
  v_exp_f32 v232, v120
  v_add_f32 v10, v10, v239
  v_cvt_pk_bf16_f32 v211, v238, v239
  v_exp_f32 v233, v121
  v_add_f32 v10, v10, v232
  v_exp_f32 v234, v122
  v_add_f32 v10, v10, v233
  v_cvt_pk_bf16_f32 v212, v232, v233
  v_exp_f32 v235, v123
  v_add_f32 v10, v10, v234
  v_exp_f32 v236, v124
  v_add_f32 v10, v10, v235
  v_cvt_pk_bf16_f32 v213, v234, v235
  v_exp_f32 v237, v125
  v_add_f32 v10, v10, v236
  v_exp_f32 v238, v126
  v_add_f32 v10, v10, v237
  v_cvt_pk_bf16_f32 v214, v236, v237
  v_exp_f32 v239, v127
  v_add_f32 v10, v10, v238
  v_add_f32 v10, v10, v239
  v_cvt_pk_bf16_f32 v215, v238, v239
  ds_read_b128 v[176:179], v7 offset:16384
  ds_read_b128 v[180:183], v7 offset:17408
  ds_read_b128 v[184:187], v7 offset:18432
  ds_read_b128 v[188:191], v7 offset:19456
  s_add_u32 s32, s32, 1
kva_kernel_loop_22:
  s_waitcnt lgkmcnt(3)
  v_mfma_f32_32x32x16_bf16 v[144:159], v[176:179], v[16:19], v[192:207]
  ds_read_b128 v[176:179], v7 offset:20480
  v_exp_f32 v232, v128
  v_exp_f32 v233, v129
  s_waitcnt lgkmcnt(3)
  v_mfma_f32_32x32x16_bf16 v[144:159], v[180:183], v[20:23], v[144:159]
  ds_read_b128 v[180:183], v7 offset:21504
  v_add_f32 v10, v10, v232
  v_exp_f32 v234, v130
  v_add_f32 v10, v10, v233
  s_waitcnt lgkmcnt(3)
  v_mfma_f32_32x32x16_bf16 v[144:159], v[184:187], v[24:27], v[144:159]
  ds_read_b128 v[184:187], v7 offset:22528
  v_cvt_pk_bf16_f32 v224, v232, v233
  v_exp_f32 v235, v131
  v_add_f32 v10, v10, v234
  s_waitcnt lgkmcnt(3)
  v_mfma_f32_32x32x16_bf16 v[144:159], v[188:191], v[28:31], v[144:159]
  ds_read_b128 v[188:191], v7 offset:23552
  v_exp_f32 v236, v132
  v_add_f32 v10, v10, v235
  s_waitcnt lgkmcnt(3)
  v_mfma_f32_32x32x16_bf16 v[144:159], v[176:179], v[32:35], v[144:159]
  ds_read_b128 v[176:179], v7 offset:24576
  v_cvt_pk_bf16_f32 v225, v234, v235
  v_exp_f32 v237, v133
  v_add_f32 v10, v10, v236
  s_waitcnt lgkmcnt(3)
  v_mfma_f32_32x32x16_bf16 v[144:159], v[180:183], v[36:39], v[144:159]
  ds_read_b128 v[180:183], v7 offset:25600
  v_exp_f32 v238, v134
  v_add_f32 v10, v10, v237
  v_cvt_pk_bf16_f32 v226, v236, v237
  s_waitcnt lgkmcnt(3)
  v_mfma_f32_32x32x16_bf16 v[144:159], v[184:187], v[40:43], v[144:159]
  ds_read_b128 v[184:187], v7 offset:26624
  v_exp_f32 v239, v135
  v_add_f32 v10, v10, v238
  s_waitcnt lgkmcnt(3)
  v_mfma_f32_32x32x16_bf16 v[144:159], v[188:191], v[44:47], v[144:159]
  ds_read_b128 v[188:191], v7 offset:27648
  v_exp_f32 v232, v136
  v_add_f32 v10, v10, v239
  v_cvt_pk_bf16_f32 v227, v238, v239
  s_waitcnt lgkmcnt(3)
  v_mfma_f32_32x32x16_bf16 v[160:175], v[176:179], v[16:19], v[192:207]
  ds_read_b128 v[176:179], v7 offset:28672
  v_exp_f32 v233, v137
  v_add_f32 v10, v10, v232
  v_exp_f32 v234, v138
  s_waitcnt lgkmcnt(3)
  v_mfma_f32_32x32x16_bf16 v[160:175], v[180:183], v[20:23], v[160:175]
  ds_read_b128 v[180:183], v7 offset:29696
  v_add_f32 v10, v10, v233
  v_cvt_pk_bf16_f32 v228, v232, v233
  s_waitcnt lgkmcnt(3)
  v_mfma_f32_32x32x16_bf16 v[160:175], v[184:187], v[24:27], v[160:175]
  ds_read_b128 v[184:187], v7 offset:30720
  v_exp_f32 v235, v139
  v_add_f32 v10, v10, v234
  v_exp_f32 v236, v140
  s_waitcnt lgkmcnt(3)
  v_mfma_f32_32x32x16_bf16 v[160:175], v[188:191], v[28:31], v[160:175]
  ds_read_b128 v[188:191], v7 offset:31744
  v_add_f32 v10, v10, v235
  v_cvt_pk_bf16_f32 v229, v234, v235
  v_exp_f32 v237, v141
  s_waitcnt lgkmcnt(3)
  v_mfma_f32_32x32x16_bf16 v[160:175], v[176:179], v[32:35], v[160:175]
  v_add_f32 v10, v10, v236
  v_exp_f32 v238, v142
  s_waitcnt lgkmcnt(2)
  v_mfma_f32_32x32x16_bf16 v[160:175], v[180:183], v[36:39], v[160:175]
  s_waitcnt vmcnt(0) lgkmcnt(0)
  s_barrier
  ds_read_b128 v[176:179], v7 offset:32768
  ds_read_b128 v[180:183], v7 offset:33792
  v_add_f32 v10, v10, v237
  v_cvt_pk_bf16_f32 v230, v236, v237
  v_exp_f32 v239, v143
  s_lshl_b32 s46, s32, 1
  s_sub_u32 s46, s46, s31
  s_cmp_lt_u32 s32, s30
  s_cselect_b32 s46, s32, s46
  s_lshl_b32 s46, s46, 14
  s_add_u32 s46, s46, s34
  s_add_u32 m0, s35, 49152
  s_nop 0
  buffer_load_dwordx4 v2, s[16:19], s46 offen lds
  v_mfma_f32_32x32x16_bf16 v[160:175], v[184:187], v[40:43], v[160:175]
  ds_read_b128 v[184:187], v7 offset:34816
  v_add_f32 v10, v10, v238
  v_add_f32 v10, v10, v239
  v_cvt_pk_bf16_f32 v231, v238, v239
  buffer_load_dwordx4 v2, s[16:19], s46 offen offset:1024 lds
  v_mfma_f32_32x32x16_bf16 v[160:175], v[188:191], v[44:47], v[160:175]
  ds_read_b128 v[188:191], v7 offset:35840
  v_cmp_lt_f32 vcc, 1182793728, v10
  s_cbranch_vccnz kva_kernel_r2_23
kva_kernel_r2b_24:
  v_add_f32 v9, v9, v10
  s_bitcmp1_b32 s33, s32
  s_cbranch_scc1 kva_kernel_sp_25
kva_kernel_spb_26:
  s_waitcnt lgkmcnt(3)
  v_mfma_f32_32x32x16_bf16 v[48:63], v[176:179], v[208:211], v[48:63]
  ds_read_b128 v[176:179], v7 offset:36864
  v_exp_f32 v232, v144
  v_exp_f32 v233, v145
  buffer_load_dwordx4 v2, s[16:19], s46 offen offset:2048 lds
  s_waitcnt lgkmcnt(3)
  v_mfma_f32_32x32x16_bf16 v[64:79], v[180:183], v[208:211], v[64:79]
  ds_read_b128 v[180:183], v7 offset:37888
  v_exp_f32 v234, v146
  v_add_f32 v10, v232, v233
  buffer_load_dwordx4 v2, s[16:19], s46 offen offset:3072 lds
  s_waitcnt lgkmcnt(3)
  v_mfma_f32_32x32x16_bf16 v[80:95], v[184:187], v[208:211], v[80:95]
  ds_read_b128 v[184:187], v7 offset:38912
  v_cvt_pk_bf16_f32 v216, v232, v233
  v_exp_f32 v235, v147
  v_add_f32 v10, v10, v234
  s_add_u32 s39, s32, 2
  s_lshl_b32 s45, s39, 1
  s_sub_u32 s45, s45, s31
  s_cmp_lt_u32 s39, s30
  s_cselect_b32 s45, s39, s45
  s_lshl_b32 s45, s45, 14
  s_add_u32 s45, s45, s34
  s_cmp_lt_u32 s32, 15
  s_cselect_b64 s[56:57], -1, 0
  s_add_u32 m0, s35, 16384
  s_waitcnt lgkmcnt(3)
  v_mfma_f32_32x32x16_bf16 v[96:111], v[188:191], v[208:211], v[96:111]
  ds_read_b128 v[188:191], v7 offset:39936
  v_exp_f32 v236, v148
  v_add_f32 v10, v10, v235
  s_mov_b64 exec, s[56:57]
  buffer_load_dwordx4 v2, s[12:15], s45 offen offset:0 lds
  s_mov_b64 exec, -1
  s_waitcnt lgkmcnt(3)
  v_mfma_f32_32x32x16_bf16 v[48:63], v[176:179], v[212:215], v[48:63]
  ds_read_b128 v[176:179], v7 offset:40960
  v_cvt_pk_bf16_f32 v217, v234, v235
  v_exp_f32 v237, v149
  v_add_f32 v10, v10, v236
  s_mov_b64 exec, s[56:57]
  buffer_load_dwordx4 v2, s[12:15], s45 offen offset:1024 lds
  s_mov_b64 exec, -1
  s_waitcnt lgkmcnt(3)
  v_mfma_f32_32x32x16_bf16 v[64:79], v[180:183], v[212:215], v[64:79]
  ds_read_b128 v[180:183], v7 offset:41984
  v_exp_f32 v238, v150
  v_add_f32 v10, v10, v237
  s_mov_b64 exec, s[56:57]
  buffer_load_dwordx4 v2, s[12:15], s45 offen offset:2048 lds
  s_mov_b64 exec, -1
  s_waitcnt lgkmcnt(3)
  v_mfma_f32_32x32x16_bf16 v[80:95], v[184:187], v[212:215], v[80:95]
  ds_read_b128 v[184:187], v7 offset:43008
  v_cvt_pk_bf16_f32 v218, v236, v237
  v_exp_f32 v239, v151
  v_add_f32 v10, v10, v238
  s_mov_b64 exec, s[56:57]
  buffer_load_dwordx4 v2, s[12:15], s45 offen offset:3072 lds
  s_mov_b64 exec, -1
  s_waitcnt lgkmcnt(3)
  v_mfma_f32_32x32x16_bf16 v[96:111], v[188:191], v[212:215], v[96:111]
  ds_read_b128 v[188:191], v7 offset:44032
  v_exp_f32 v232, v152
  v_add_f32 v10, v10, v239
  s_cmp_lt_u32 s32, 5
  s_cselect_b64 s[76:77], s[80:81], s[82:83]
  s_cmp_lt_u32 s32, 9
  s_cselect_b64 s[76:77], s[76:77], s[84:85]
  s_cselect_b64 s[86:87], -1, 0
  s_lshr_b32 s101, s32, 1
  s_and_b32 s100, s101, 1
  s_waitcnt lgkmcnt(3)
  v_mfma_f32_32x32x16_bf16 v[48:63], v[176:179], v[224:227], v[48:63]
  ds_read_b128 v[176:179], v7 offset:45056
  v_cvt_pk_bf16_f32 v219, v238, v239
  v_exp_f32 v233, v153
  s_mul_i32 s101, s101, 5120
  s_mul_i32 s39, s100, 27648
  s_cmp_lt_u32 s32, 9
  s_cselect_b32 s101, s101, s39
  s_mul_i32 s100, s100, 1105920
  s_cmp_lt_u32 s32, 13
  s_cselect_b64 s[98:99], s[96:97], 0
  v_cndmask_b32_e64 v251, v14, v1, s[86:87]
  s_waitcnt lgkmcnt(3)
  v_mfma_f32_32x32x16_bf16 v[64:79], v[180:183], v[224:227], v[64:79]
  ds_read_b128 v[180:183], v7 offset:46080
  v_add_f32 v10, v10, v232
  v_exp_f32 v234, v154
  v_add_f32 v10, v10, v233
  s_mov_b64 exec, s[98:99]
  buffer_load_dwordx4 v[252:255], v251, s[76:79], s100 offen nt
  s_mov_b64 exec, -1
  s_waitcnt lgkmcnt(3)
  v_mfma_f32_32x32x16_bf16 v[80:95], v[184:187], v[224:227], v[80:95]
  ds_read_b128 v[184:187], v7 offset:47104
  v_cvt_pk_bf16_f32 v220, v232, v233
  v_exp_f32 v235, v155
  s_waitcnt lgkmcnt(3)
  v_mfma_f32_32x32x16_bf16 v[96:111], v[188:191], v[224:227], v[96:111]
  ds_read_b128 v[188:191], v7 offset:48128
  v_add_f32 v10, v10, v234
  v_exp_f32 v236, v156
  v_add_f32 v10, v10, v235
  s_waitcnt lgkmcnt(3)
  v_mfma_f32_32x32x16_bf16 v[48:63], v[176:179], v[228:231], v[48:63]
  ds_read_b128 v[176:179], v7 offset:0
  v_cvt_pk_bf16_f32 v221, v234, v235
  v_exp_f32 v237, v157
  s_waitcnt lgkmcnt(3)
  v_mfma_f32_32x32x16_bf16 v[64:79], v[180:183], v[228:231], v[64:79]
  ds_read_b128 v[180:183], v7 offset:1024
  v_add_f32 v10, v10, v236
  v_exp_f32 v238, v158
  v_add_f32 v10, v10, v237
  s_waitcnt lgkmcnt(3)
  v_mfma_f32_32x32x16_bf16 v[80:95], v[184:187], v[228:231], v[80:95]
  ds_read_b128 v[184:187], v7 offset:2048
  v_cvt_pk_bf16_f32 v222, v236, v237
  v_exp_f32 v239, v159
  s_waitcnt lgkmcnt(3)
  v_mfma_f32_32x32x16_bf16 v[96:111], v[188:191], v[228:231], v[96:111]
  ds_read_b128 v[188:191], v7 offset:3072
  v_add_f32 v10, v10, v238
  v_add_f32 v10, v10, v239
  v_cvt_pk_bf16_f32 v223, v238, v239
  s_add_u32 s32, s32, 1
  s_waitcnt lgkmcnt(3)
  v_mfma_f32_32x32x16_bf16 v[112:127], v[176:179], v[16:19], v[192:207]
  ds_read_b128 v[176:179], v7 offset:4096
  v_exp_f32 v232, v160
  v_exp_f32 v233, v161
  s_waitcnt lgkmcnt(3)
  v_mfma_f32_32x32x16_bf16 v[112:127], v[180:183], v[20:23], v[112:127]
  ds_read_b128 v[180:183], v7 offset:5120
  v_add_f32 v10, v10, v232
  v_exp_f32 v234, v162
  v_add_f32 v10, v10, v233
  s_waitcnt lgkmcnt(3)
  v_mfma_f32_32x32x16_bf16 v[112:127], v[184:187], v[24:27], v[112:127]
  ds_read_b128 v[184:187], v7 offset:6144
  v_cvt_pk_bf16_f32 v224, v232, v233
  v_exp_f32 v235, v163
  v_add_f32 v10, v10, v234
  s_waitcnt lgkmcnt(3)
  v_mfma_f32_32x32x16_bf16 v[112:127], v[188:191], v[28:31], v[112:127]
  ds_read_b128 v[188:191], v7 offset:7168
  v_exp_f32 v236, v164
  v_add_f32 v10, v10, v235
  s_waitcnt lgkmcnt(3)
  v_mfma_f32_32x32x16_bf16 v[112:127], v[176:179], v[32:35], v[112:127]
  ds_read_b128 v[176:179], v7 offset:8192
  v_cvt_pk_bf16_f32 v225, v234, v235
  v_exp_f32 v237, v165
  v_add_f32 v10, v10, v236
  s_waitcnt lgkmcnt(3)
  v_mfma_f32_32x32x16_bf16 v[112:127], v[180:183], v[36:39], v[112:127]
  ds_read_b128 v[180:183], v7 offset:9216
  v_exp_f32 v238, v166
  v_add_f32 v10, v10, v237
  v_cvt_pk_bf16_f32 v226, v236, v237
  s_waitcnt lgkmcnt(3)
  v_mfma_f32_32x32x16_bf16 v[112:127], v[184:187], v[40:43], v[112:127]
  ds_read_b128 v[184:187], v7 offset:10240
  v_exp_f32 v239, v167
  v_add_f32 v10, v10, v238
  s_waitcnt lgkmcnt(3)
  v_mfma_f32_32x32x16_bf16 v[112:127], v[188:191], v[44:47], v[112:127]
  ds_read_b128 v[188:191], v7 offset:11264
  v_exp_f32 v232, v168
  v_add_f32 v10, v10, v239
  v_cvt_pk_bf16_f32 v227, v238, v239
  s_waitcnt lgkmcnt(3)
  v_mfma_f32_32x32x16_bf16 v[128:143], v[176:179], v[16:19], v[192:207]
  ds_read_b128 v[176:179], v7 offset:12288
  v_exp_f32 v233, v169
  v_add_f32 v10, v10, v232
  v_exp_f32 v234, v170
  s_waitcnt lgkmcnt(3)
  v_mfma_f32_32x32x16_bf16 v[128:143], v[180:183], v[20:23], v[128:143]
  ds_read_b128 v[180:183], v7 offset:13312
  v_add_f32 v10, v10, v233
  v_cvt_pk_bf16_f32 v228, v232, v233
  s_waitcnt lgkmcnt(3)
  v_mfma_f32_32x32x16_bf16 v[128:143], v[184:187], v[24:27], v[128:143]
  ds_read_b128 v[184:187], v7 offset:14336
  v_exp_f32 v235, v171
  v_add_f32 v10, v10, v234
  v_exp_f32 v236, v172
  s_waitcnt lgkmcnt(3)
  v_mfma_f32_32x32x16_bf16 v[128:143], v[188:191], v[28:31], v[128:143]
  ds_read_b128 v[188:191], v7 offset:15360
  v_add_f32 v10, v10, v235
  v_cvt_pk_bf16_f32 v229, v234, v235
  v_exp_f32 v237, v173
  s_waitcnt lgkmcnt(3)
  v_mfma_f32_32x32x16_bf16 v[128:143], v[176:179], v[32:35], v[128:143]
  v_add_f32 v10, v10, v236
  v_exp_f32 v238, v174
  s_waitcnt lgkmcnt(2)
  v_mfma_f32_32x32x16_bf16 v[128:143], v[180:183], v[36:39], v[128:143]
  s_waitcnt vmcnt(0) lgkmcnt(0)
  s_barrier
  ds_read_b128 v[176:179], v7 offset:49152
  ds_read_b128 v[180:183], v7 offset:50176
  v_add_f32 v10, v10, v237
  v_cvt_pk_bf16_f32 v230, v236, v237
  v_exp_f32 v239, v175
  s_lshl_b32 s46, s32, 1
  s_sub_u32 s46, s46, s31
  s_cmp_lt_u32 s32, s30
  s_cselect_b32 s46, s32, s46
  s_lshl_b32 s46, s46, 14
  s_add_u32 s46, s46, s34
  s_add_u32 m0, s35, 32768
  s_nop 0
  buffer_load_dwordx4 v2, s[16:19], s46 offen lds
  v_mfma_f32_32x32x16_bf16 v[128:143], v[184:187], v[40:43], v[128:143]
  ds_read_b128 v[184:187], v7 offset:51200
  v_add_f32 v10, v10, v238
  v_add_f32 v10, v10, v239
  v_cvt_pk_bf16_f32 v231, v238, v239
  buffer_load_dwordx4 v2, s[16:19], s46 offen offset:1024 lds
  v_mfma_f32_32x32x16_bf16 v[128:143], v[188:191], v[44:47], v[128:143]
  ds_read_b128 v[188:191], v7 offset:52224
  v_cmp_lt_f32 vcc, 1182793728, v10
  s_cbranch_vccnz kva_kernel_r2_27
kva_kernel_r2b_28:
  v_add_f32 v9, v9, v10
  s_bitcmp1_b32 s33, s32
  s_cbranch_scc1 kva_kernel_sp_29
kva_kernel_spb_30:
  s_waitcnt lgkmcnt(3)
  v_mfma_f32_32x32x16_bf16 v[48:63], v[176:179], v[216:219], v[48:63]
  ds_read_b128 v[176:179], v7 offset:53248
  v_exp_f32 v232, v112
  v_exp_f32 v233, v113
  buffer_load_dwordx4 v2, s[16:19], s46 offen offset:2048 lds
  s_waitcnt lgkmcnt(3)
  v_mfma_f32_32x32x16_bf16 v[64:79], v[180:183], v[216:219], v[64:79]
  ds_read_b128 v[180:183], v7 offset:54272
  v_exp_f32 v234, v114
  v_add_f32 v10, v232, v233
  buffer_load_dwordx4 v2, s[16:19], s46 offen offset:3072 lds
  s_waitcnt lgkmcnt(3)
  v_mfma_f32_32x32x16_bf16 v[80:95], v[184:187], v[216:219], v[80:95]
  ds_read_b128 v[184:187], v7 offset:55296
  v_cvt_pk_bf16_f32 v208, v232, v233
  v_exp_f32 v235, v115
  v_add_f32 v10, v10, v234
  s_add_u32 s39, s32, 2
  s_lshl_b32 s45, s39, 1
  s_sub_u32 s45, s45, s31
  s_cmp_lt_u32 s39, s30
  s_cselect_b32 s45, s39, s45
  s_lshl_b32 s45, s45, 14
  s_add_u32 s45, s45, s34
  s_cmp_lt_u32 s32, 15
  s_cselect_b64 s[56:57], -1, 0
  s_add_u32 m0, s35, 0
  s_waitcnt lgkmcnt(3)
  v_mfma_f32_32x32x16_bf16 v[96:111], v[188:191], v[216:219], v[96:111]
  ds_read_b128 v[188:191], v7 offset:56320
  v_exp_f32 v236, v116
  v_add_f32 v10, v10, v235
  s_mov_b64 exec, s[56:57]
  buffer_load_dwordx4 v2, s[12:15], s45 offen offset:0 lds
  s_mov_b64 exec, -1
  s_waitcnt lgkmcnt(3)
  v_mfma_f32_32x32x16_bf16 v[48:63], v[176:179], v[220:223], v[48:63]
  ds_read_b128 v[176:179], v7 offset:57344
  v_cvt_pk_bf16_f32 v209, v234, v235
  v_exp_f32 v237, v117
  v_add_f32 v10, v10, v236
  s_mov_b64 exec, s[56:57]
  buffer_load_dwordx4 v2, s[12:15], s45 offen offset:1024 lds
  s_mov_b64 exec, -1
  s_waitcnt lgkmcnt(3)
  v_mfma_f32_32x32x16_bf16 v[64:79], v[180:183], v[220:223], v[64:79]
  ds_read_b128 v[180:183], v7 offset:58368
  v_exp_f32 v238, v118
  v_add_f32 v10, v10, v237
  s_mov_b64 exec, s[56:57]
  buffer_load_dwordx4 v2, s[12:15], s45 offen offset:2048 lds
  s_mov_b64 exec, -1
  s_waitcnt lgkmcnt(3)
  v_mfma_f32_32x32x16_bf16 v[80:95], v[184:187], v[220:223], v[80:95]
  ds_read_b128 v[184:187], v7 offset:59392
  v_cvt_pk_bf16_f32 v210, v236, v237
  v_exp_f32 v239, v119
  v_add_f32 v10, v10, v238
  s_mov_b64 exec, s[56:57]
  buffer_load_dwordx4 v2, s[12:15], s45 offen offset:3072 lds
  s_mov_b64 exec, -1
  s_waitcnt lgkmcnt(3)
  v_mfma_f32_32x32x16_bf16 v[96:111], v[188:191], v[220:223], v[96:111]
  ds_read_b128 v[188:191], v7 offset:60416
  v_exp_f32 v232, v120
  v_add_f32 v10, v10, v239
  v_cndmask_b32_e64 v251, v15, v13, s[86:87]
  s_waitcnt lgkmcnt(3)
  v_mfma_f32_32x32x16_bf16 v[48:63], v[176:179], v[224:227], v[48:63]
  ds_read_b128 v[176:179], v7 offset:61440
  v_cvt_pk_bf16_f32 v211, v238, v239
  v_exp_f32 v233, v121
  s_mov_b64 exec, s[98:99]
  buffer_store_dwordx4 v[252:255], v251, s[88:91], s101 offen sc1
  s_mov_b64 exec, -1
  s_waitcnt lgkmcnt(3)
  v_mfma_f32_32x32x16_bf16 v[64:79], v[180:183], v[224:227], v[64:79]
  ds_read_b128 v[180:183], v7 offset:62464
  v_add_f32 v10, v10, v232
  v_exp_f32 v234, v122
  v_add_f32 v10, v10, v233
  s_waitcnt lgkmcnt(3)
  v_mfma_f32_32x32x16_bf16 v[80:95], v[184:187], v[224:227], v[80:95]
  ds_read_b128 v[184:187], v7 offset:63488
  v_cvt_pk_bf16_f32 v212, v232, v233
  v_exp_f32 v235, v123
  s_waitcnt lgkmcnt(3)
  v_mfma_f32_32x32x16_bf16 v[96:111], v[188:191], v[224:227], v[96:111]
  ds_read_b128 v[188:191], v7 offset:64512
  v_add_f32 v10, v10, v234
  v_exp_f32 v236, v124
  v_add_f32 v10, v10, v235
  s_waitcnt lgkmcnt(3)
  v_mfma_f32_32x32x16_bf16 v[48:63], v[176:179], v[228:231], v[48:63]
  ds_read_b128 v[176:179], v7 offset:16384
  v_cvt_pk_bf16_f32 v213, v234, v235
  v_exp_f32 v237, v125
  s_waitcnt lgkmcnt(3)
  v_mfma_f32_32x32x16_bf16 v[64:79], v[180:183], v[228:231], v[64:79]
  ds_read_b128 v[180:183], v7 offset:17408
  v_add_f32 v10, v10, v236
  v_exp_f32 v238, v126
  v_add_f32 v10, v10, v237
  s_waitcnt lgkmcnt(3)
  v_mfma_f32_32x32x16_bf16 v[80:95], v[184:187], v[228:231], v[80:95]
  ds_read_b128 v[184:187], v7 offset:18432
  v_cvt_pk_bf16_f32 v214, v236, v237
  v_exp_f32 v239, v127
  s_waitcnt lgkmcnt(3)
  v_mfma_f32_32x32x16_bf16 v[96:111], v[188:191], v[228:231], v[96:111]
  ds_read_b128 v[188:191], v7 offset:19456
  v_add_f32 v10, v10, v238
  v_add_f32 v10, v10, v239
  v_cvt_pk_bf16_f32 v215, v238, v239
  s_cmp_eq_u32 s32, s43
  s_cbranch_scc1 kva_kernel_fin_31
kva_kernel_finb_32:
  s_add_u32 s32, s32, 1
  s_cmp_lt_u32 s32, 17
  s_cbranch_scc1 kva_kernel_loop_22
  s_waitcnt vmcnt(0) lgkmcnt(0)
  s_barrier
  ds_read_b128 v[176:179], v7 offset:32768
  ds_read_b128 v[180:183], v7 offset:33792
  ds_read_b128 v[184:187], v7 offset:34816
  ds_read_b128 v[188:191], v7 offset:35840
  s_cmp_eq_u32 s58, 17
  s_cselect_b64 exec, 1, 0
  buffer_store_dword v11, off, s[8:11], s59 sc1
  s_mov_b64 exec, -1
  v_exp_f32 v232, v128
  v_exp_f32 v233, v129
  v_add_f32 v10, v10, v232
  v_exp_f32 v234, v130
  v_add_f32 v10, v10, v233
  v_cvt_pk_bf16_f32 v224, v232, v233
  v_exp_f32 v235, v131
  v_add_f32 v10, v10, v234
  v_exp_f32 v236, v132
  v_add_f32 v10, v10, v235
  v_cvt_pk_bf16_f32 v225, v234, v235
  v_exp_f32 v237, v133
  v_add_f32 v10, v10, v236
  v_exp_f32 v238, v134
  v_add_f32 v10, v10, v237
  v_cvt_pk_bf16_f32 v226, v236, v237
  v_exp_f32 v239, v135
  v_add_f32 v10, v10, v238
  v_exp_f32 v232, v136
  v_add_f32 v10, v10, v239
  v_cvt_pk_bf16_f32 v227, v238, v239
  v_exp_f32 v233, v137
  v_add_f32 v10, v10, v232
  v_exp_f32 v234, v138
  v_add_f32 v10, v10, v233
  v_cvt_pk_bf16_f32 v228, v232, v233
  v_exp_f32 v235, v139
  v_add_f32 v10, v10, v234
  v_exp_f32 v236, v140
  v_add_f32 v10, v10, v235
  v_cvt_pk_bf16_f32 v229, v234, v235
  v_exp_f32 v237, v141
  v_add_f32 v10, v10, v236
  v_exp_f32 v238, v142
  v_add_f32 v10, v10, v237
  v_cvt_pk_bf16_f32 v230, v236, v237
  v_exp_f32 v239, v143
  v_add_f32 v10, v10, v238
  v_add_f32 v10, v10, v239
  v_cvt_pk_bf16_f32 v231, v238, v239
  v_cmp_lt_f32 vcc, 1182793728, v10
  s_cbranch_vccnz kva_kernel_r2_33
kva_kernel_r2b_34:
  v_add_f32 v9, v9, v10
  s_waitcnt lgkmcnt(3)
  v_mfma_f32_32x32x16_bf16 v[48:63], v[176:179], v[208:211], v[48:63]
  ds_read_b128 v[176:179], v7 offset:36864
  s_add_u32 m0, s74, 122880
  s_nop 0
  buffer_load_dwordx4 v3, s[4:7], s73 offen lds
  s_waitcnt lgkmcnt(3)
  v_mfma_f32_32x32x16_bf16 v[64:79], v[180:183], v[208:211], v[64:79]
  ds_read_b128 v[180:183], v7 offset:37888
  s_add_u32 m0, s74, 123904
  s_nop 0
  buffer_load_dwordx4 v4, s[4:7], s73 offen lds
  s_waitcnt lgkmcnt(3)
  v_mfma_f32_32x32x16_bf16 v[80:95], v[184:187], v[208:211], v[80:95]
  ds_read_b128 v[184:187], v7 offset:38912
  s_add_u32 m0, s74, 124928
  s_nop 0
  buffer_load_dwordx4 v5, s[4:7], s73 offen lds
  s_waitcnt lgkmcnt(3)
  v_mfma_f32_32x32x16_bf16 v[96:111], v[188:191], v[208:211], v[96:111]
  ds_read_b128 v[188:191], v7 offset:39936
  s_add_u32 m0, s74, 125952
  s_nop 0
  buffer_load_dwordx4 v6, s[4:7], s73 offen lds
  s_waitcnt lgkmcnt(3)
  v_mfma_f32_32x32x16_bf16 v[48:63], v[176:179], v[212:215], v[48:63]
  ds_read_b128 v[176:179], v7 offset:40960
  s_add_u32 m0, s74, 126976
  s_nop 0
  buffer_load_dwordx4 v12, s[4:7], s73 offen lds
  s_waitcnt lgkmcnt(3)
  v_mfma_f32_32x32x16_bf16 v[64:79], v[180:183], v[212:215], v[64:79]
  ds_read_b128 v[180:183], v7 offset:41984
  s_waitcnt lgkmcnt(3)
  v_mfma_f32_32x32x16_bf16 v[80:95], v[184:187], v[212:215], v[80:95]
  ds_read_b128 v[184:187], v7 offset:43008
  s_waitcnt lgkmcnt(3)
  v_mfma_f32_32x32x16_bf16 v[96:111], v[188:191], v[212:215], v[96:111]
  ds_read_b128 v[188:191], v7 offset:44032
  s_waitcnt lgkmcnt(3)
  v_mfma_f32_32x32x16_bf16 v[48:63], v[176:179], v[224:227], v[48:63]
  ds_read_b128 v[176:179], v7 offset:45056
  s_waitcnt lgkmcnt(3)
  v_mfma_f32_32x32x16_bf16 v[64:79], v[180:183], v[224:227], v[64:79]
  ds_read_b128 v[180:183], v7 offset:46080
  s_waitcnt lgkmcnt(3)
  v_mfma_f32_32x32x16_bf16 v[80:95], v[184:187], v[224:227], v[80:95]
  ds_read_b128 v[184:187], v7 offset:47104
  s_waitcnt lgkmcnt(3)
  v_mfma_f32_32x32x16_bf16 v[96:111], v[188:191], v[224:227], v[96:111]
  ds_read_b128 v[188:191], v7 offset:48128
  s_waitcnt lgkmcnt(3)
  v_mfma_f32_32x32x16_bf16 v[48:63], v[176:179], v[228:231], v[48:63]
  s_waitcnt lgkmcnt(2)
  v_mfma_f32_32x32x16_bf16 v[64:79], v[180:183], v[228:231], v[64:79]
  s_waitcnt lgkmcnt(1)
  v_mfma_f32_32x32x16_bf16 v[80:95], v[184:187], v[228:231], v[80:95]
  s_waitcnt lgkmcnt(0)
  v_mfma_f32_32x32x16_bf16 v[96:111], v[188:191], v[228:231], v[96:111]
  v_mov_b32 v10, v9
  s_nop 1
  v_permlane32_swap_b32 v9, v10
  v_add_f32 v9, v9, v10
  v_sub_f32 v10, 0, v192
  v_mov_b32 v240, v10
  v_mov_b32 v241, v9
  s_lshl_b32 s38, s24, 9
  s_add_u32 s38, s38, 49152
  v_lshlrev_b32 v242, 3, v0
  v_add_u32 v242, s38, v242
  ds_write_b64 v242, v[240:241]
  v_xor_b32 v242, 0x800, v242
  s_lshl_b32 s38, s28, 13
  v_add_u32 v243, s38, v7
  v_xor_b32 v244, 0x10000, v243
  s_cmp_eq_u32 s27, 1
  s_cbranch_scc1 kva_kernel_mB_35
  ds_write_b128 v243, v[80:83] offset:0
  ds_write_b128 v243, v[84:87] offset:1024
  ds_write_b128 v243, v[88:91] offset:2048
  ds_write_b128 v243, v[92:95] offset:3072
  ds_write_b128 v243, v[96:99] offset:4096
  ds_write_b128 v243, v[100:103] offset:5120
  ds_write_b128 v243, v[104:107] offset:6144
  ds_write_b128 v243, v[108:111] offset:7168
  s_waitcnt lgkmcnt(0)
  s_barrier
  ds_read_b64 v[246:247], v242
  ds_read_b128 v[112:115], v244 offset:0
  ds_read_b128 v[116:119], v244 offset:1024
  ds_read_b128 v[120:123], v244 offset:2048
  ds_read_b128 v[124:127], v244 offset:3072
  ds_read_b128 v[128:131], v244 offset:4096
  ds_read_b128 v[132:135], v244 offset:5120
  ds_read_b128 v[136:139], v244 offset:6144
  ds_read_b128 v[140:143], v244 offset:7168
  s_waitcnt lgkmcnt(8)
  v_max_f32 v240, v10, v246
  v_sub_f32 v241, v10, v240
  v_sub_f32 v242, v246, v240
  v_exp_f32 v241, v241
  v_exp_f32 v242, v242
  v_mul_f32 v240, v9, v241
  v_fmac_f32 v240, v247, v242
  v_rcp_f32 v240, v240
  s_nop 0
  v_mul_f32 v241, v241, v240
  v_mul_f32 v242, v242, v240
  s_waitcnt lgkmcnt(0)
  v_mul_f32 v48, v48, v241
  v_fmac_f32 v48, v112, v242
  v_mul_f32 v49, v49, v241
  v_fmac_f32 v49, v113, v242
  v_mul_f32 v50, v50, v241
  v_fmac_f32 v50, v114, v242
  v_mul_f32 v51, v51, v241
  v_fmac_f32 v51, v115, v242
  v_mul_f32 v52, v52, v241
  v_fmac_f32 v52, v116, v242
  v_mul_f32 v53, v53, v241
  v_fmac_f32 v53, v117, v242
  v_mul_f32 v54, v54, v241
  v_fmac_f32 v54, v118, v242
  v_mul_f32 v55, v55, v241
  v_fmac_f32 v55, v119, v242
  v_mul_f32 v56, v56, v241
  v_fmac_f32 v56, v120, v242
  v_mul_f32 v57, v57, v241
  v_fmac_f32 v57, v121, v242
  v_mul_f32 v58, v58, v241
  v_fmac_f32 v58, v122, v242
  v_mul_f32 v59, v59, v241
  v_fmac_f32 v59, v123, v242
  v_mul_f32 v60, v60, v241
  v_fmac_f32 v60, v124, v242
  v_mul_f32 v61, v61, v241
  v_fmac_f32 v61, v125, v242
  v_mul_f32 v62, v62, v241
  v_fmac_f32 v62, v126, v242
  v_mul_f32 v63, v63, v241
  v_fmac_f32 v63, v127, v242
  v_mul_f32 v64, v64, v241
  v_fmac_f32 v64, v128, v242
  v_mul_f32 v65, v65, v241
  v_fmac_f32 v65, v129, v242
  v_mul_f32 v66, v66, v241
  v_fmac_f32 v66, v130, v242
  v_mul_f32 v67, v67, v241
  v_fmac_f32 v67, v131, v242
  v_mul_f32 v68, v68, v241
  v_fmac_f32 v68, v132, v242
  v_mul_f32 v69, v69, v241
  v_fmac_f32 v69, v133, v242
  v_mul_f32 v70, v70, v241
  v_fmac_f32 v70, v134, v242
  v_mul_f32 v71, v71, v241
  v_fmac_f32 v71, v135, v242
  v_mul_f32 v72, v72, v241
  v_fmac_f32 v72, v136, v242
  v_mul_f32 v73, v73, v241
  v_fmac_f32 v73, v137, v242
  v_mul_f32 v74, v74, v241
  v_fmac_f32 v74, v138, v242
  v_mul_f32 v75, v75, v241
  v_fmac_f32 v75, v139, v242
  v_mul_f32 v76, v76, v241
  v_fmac_f32 v76, v140, v242
  v_mul_f32 v77, v77, v241
  v_fmac_f32 v77, v141, v242
  v_mul_f32 v78, v78, v241
  v_fmac_f32 v78, v142, v242
  v_mul_f32 v79, v79, v241
  v_fmac_f32 v79, v143, v242
  v_cvt_pk_bf16_f32 v244, v48, v49
  v_cvt_pk_bf16_f32 v245, v50, v51
  v_cvt_pk_bf16_f32 v246, v52, v53
  v_cvt_pk_bf16_f32 v247, v54, v55
  s_add_u32 s38, s41, 0
  buffer_store_dwordx4 v[244:247], v2, s[20:23], s38 offen offset:0 sc1
  v_cvt_pk_bf16_f32 v248, v56, v57
  v_cvt_pk_bf16_f32 v249, v58, v59
  v_cvt_pk_bf16_f32 v250, v60, v61
  v_cvt_pk_bf16_f32 v251, v62, v63
  s_add_u32 s38, s41, 0
  buffer_store_dwordx4 v[248:251], v2, s[20:23], s38 offen offset:1024 sc1
  v_cvt_pk_bf16_f32 v244, v64, v65
  v_cvt_pk_bf16_f32 v245, v66, v67
  v_cvt_pk_bf16_f32 v246, v68, v69
  v_cvt_pk_bf16_f32 v247, v70, v71
  s_add_u32 s38, s41, 0
  buffer_store_dwordx4 v[244:247], v2, s[20:23], s38 offen offset:2048 sc1
  v_cvt_pk_bf16_f32 v248, v72, v73
  v_cvt_pk_bf16_f32 v249, v74, v75
  v_cvt_pk_bf16_f32 v250, v76, v77
  v_cvt_pk_bf16_f32 v251, v78, v79
  s_add_u32 s38, s41, 0
  buffer_store_dwordx4 v[248:251], v2, s[20:23], s38 offen offset:3072 sc1
  s_branch kva_kernel_mE_36
kva_kernel_mB_35:
  ds_write_b128 v243, v[48:51] offset:0
  ds_write_b128 v243, v[52:55] offset:1024
  ds_write_b128 v243, v[56:59] offset:2048
  ds_write_b128 v243, v[60:63] offset:3072
  ds_write_b128 v243, v[64:67] offset:4096
  ds_write_b128 v243, v[68:71] offset:5120
  ds_write_b128 v243, v[72:75] offset:6144
  ds_write_b128 v243, v[76:79] offset:7168
  s_waitcnt lgkmcnt(0)
  s_barrier
  ds_read_b64 v[246:247], v242
  ds_read_b128 v[112:115], v244 offset:0
  ds_read_b128 v[116:119], v244 offset:1024
  ds_read_b128 v[120:123], v244 offset:2048
  ds_read_b128 v[124:127], v244 offset:3072
  ds_read_b128 v[128:131], v244 offset:4096
  ds_read_b128 v[132:135], v244 offset:5120
  ds_read_b128 v[136:139], v244 offset:6144
  ds_read_b128 v[140:143], v244 offset:7168
  s_waitcnt lgkmcnt(8)
  v_max_f32 v240, v10, v246
  v_sub_f32 v241, v10, v240
  v_sub_f32 v242, v246, v240
  v_exp_f32 v241, v241
  v_exp_f32 v242, v242
  v_mul_f32 v240, v9, v241
  v_fmac_f32 v240, v247, v242
  v_rcp_f32 v240, v240
  s_nop 0
  v_mul_f32 v241, v241, v240
  v_mul_f32 v242, v242, v240
  s_waitcnt lgkmcnt(0)
  v_mul_f32 v80, v80, v241
  v_fmac_f32 v80, v112, v242
  v_mul_f32 v81, v81, v241
  v_fmac_f32 v81, v113, v242
  v_mul_f32 v82, v82, v241
  v_fmac_f32 v82, v114, v242
  v_mul_f32 v83, v83, v241
  v_fmac_f32 v83, v115, v242
  v_mul_f32 v84, v84, v241
  v_fmac_f32 v84, v116, v242
  v_mul_f32 v85, v85, v241
  v_fmac_f32 v85, v117, v242
  v_mul_f32 v86, v86, v241
  v_fmac_f32 v86, v118, v242
  v_mul_f32 v87, v87, v241
  v_fmac_f32 v87, v119, v242
  v_mul_f32 v88, v88, v241
  v_fmac_f32 v88, v120, v242
  v_mul_f32 v89, v89, v241
  v_fmac_f32 v89, v121, v242
  v_mul_f32 v90, v90, v241
  v_fmac_f32 v90, v122, v242
  v_mul_f32 v91, v91, v241
  v_fmac_f32 v91, v123, v242
  v_mul_f32 v92, v92, v241
  v_fmac_f32 v92, v124, v242
  v_mul_f32 v93, v93, v241
  v_fmac_f32 v93, v125, v242
  v_mul_f32 v94, v94, v241
  v_fmac_f32 v94, v126, v242
  v_mul_f32 v95, v95, v241
  v_fmac_f32 v95, v127, v242
  v_mul_f32 v96, v96, v241
  v_fmac_f32 v96, v128, v242
  v_mul_f32 v97, v97, v241
  v_fmac_f32 v97, v129, v242
  v_mul_f32 v98, v98, v241
  v_fmac_f32 v98, v130, v242
  v_mul_f32 v99, v99, v241
  v_fmac_f32 v99, v131, v242
  v_mul_f32 v100, v100, v241
  v_fmac_f32 v100, v132, v242
  v_mul_f32 v101, v101, v241
  v_fmac_f32 v101, v133, v242
  v_mul_f32 v102, v102, v241
  v_fmac_f32 v102, v134, v242
  v_mul_f32 v103, v103, v241
  v_fmac_f32 v103, v135, v242
  v_mul_f32 v104, v104, v241
  v_fmac_f32 v104, v136, v242
  v_mul_f32 v105, v105, v241
  v_fmac_f32 v105, v137, v242
  v_mul_f32 v106, v106, v241
  v_fmac_f32 v106, v138, v242
  v_mul_f32 v107, v107, v241
  v_fmac_f32 v107, v139, v242
  v_mul_f32 v108, v108, v241
  v_fmac_f32 v108, v140, v242
  v_mul_f32 v109, v109, v241
  v_fmac_f32 v109, v141, v242
  v_mul_f32 v110, v110, v241
  v_fmac_f32 v110, v142, v242
  v_mul_f32 v111, v111, v241
  v_fmac_f32 v111, v143, v242
  v_cvt_pk_bf16_f32 v244, v80, v81
  v_cvt_pk_bf16_f32 v245, v82, v83
  v_cvt_pk_bf16_f32 v246, v84, v85
  v_cvt_pk_bf16_f32 v247, v86, v87
  s_add_u32 s38, s41, 4096
  buffer_store_dwordx4 v[244:247], v2, s[20:23], s38 offen offset:0 sc1
  v_cvt_pk_bf16_f32 v248, v88, v89
  v_cvt_pk_bf16_f32 v249, v90, v91
  v_cvt_pk_bf16_f32 v250, v92, v93
  v_cvt_pk_bf16_f32 v251, v94, v95
  s_add_u32 s38, s41, 4096
  buffer_store_dwordx4 v[248:251], v2, s[20:23], s38 offen offset:1024 sc1
  v_cvt_pk_bf16_f32 v244, v96, v97
  v_cvt_pk_bf16_f32 v245, v98, v99
  v_cvt_pk_bf16_f32 v246, v100, v101
  v_cvt_pk_bf16_f32 v247, v102, v103
  s_add_u32 s38, s41, 4096
  buffer_store_dwordx4 v[244:247], v2, s[20:23], s38 offen offset:2048 sc1
  v_cvt_pk_bf16_f32 v248, v104, v105
  v_cvt_pk_bf16_f32 v249, v106, v107
  v_cvt_pk_bf16_f32 v250, v108, v109
  v_cvt_pk_bf16_f32 v251, v110, v111
  s_add_u32 s38, s41, 4096
  buffer_store_dwordx4 v[248:251], v2, s[20:23], s38 offen offset:3072 sc1
kva_kernel_mE_36:
  s_mov_b64 s[44:45], s[8:9]
  s_mov_b64 s[46:47], s[10:11]
  s_mov_b64 s[4:5], s[92:93]
  s_mov_b32 s6, 5242880
  s_mov_b32 s7, 0x00020000
  s_mov_b64 s[8:9], s[20:21]
  s_mov_b64 s[10:11], s[22:23]
  s_add_u32 s12, s20, 16777216
  s_addc_u32 s13, s21, 0
  s_mov_b32 s14, 20971520
  s_mov_b32 s15, 0x00020000
  s_sub_u32 s16, s20, 50266112
  s_subb_u32 s17, s21, 0
  s_mov_b32 s18, 131072
  s_mov_b32 s19, 0x00020000
  s_mov_b32 s24, s3
  s_and_b32 s25, s2, 7
  s_lshr_b32 s26, s2, 3
  s_and_b32 s27, s25, 3
  s_lshr_b32 s28, s25, 2
  s_lshl_b32 s28, s28, 3
  s_lshr_b32 s32, s26, 2
  s_add_u32 s28, s28, s32
  s_and_b32 s29, s26, 3
  s_and_b32 s30, s24, 3
  s_lshr_b32 s31, s24, 2
  s_lshl_b32 s34, s27, 10
  s_lshl_b32 s32, s31, 9
  s_add_u32 s34, s34, s32
  s_lshl_b32 s32, s30, 4
  s_add_u32 s34, s34, s32
  s_mul_i32 s34, s34, 1280
  s_mul_i32 s32, s29, 320
  s_add_u32 s34, s34, s32
  s_mul_i32 s36, s24, 5120
  s_lshl_b32 s35, s28, 2
  s_add_u32 s35, s35, s30
  s_mul_i32 s37, s35, 40960
  s_lshl_b32 s35, s35, 18
  s_lshl_b32 s32, s27, 16
  s_add_u32 s35, s35, s32
  s_lshl_b32 s32, s31, 15
  s_add_u32 s35, s35, s32
  s_mul_i32 s32, s27, 2621440
  s_add_u32 s37, s37, s32
  s_mul_i32 s32, s29, 1280
  s_add_u32 s37, s37, s32
  v_lshlrev_b32 v2, 4, v0
  v_lshrrev_b32 v13, 5, v0
  v_mul_u32_u24 v7, 1280, v13
  v_bfe_u32 v14, v0, 2, 2
  v_lshl_add_u32 v7, v14, 6, v7
  v_bfe_u32 v14, v0, 4, 1
  v_lshl_add_u32 v7, v14, 5, v7
  v_and_b32 v14, 3, v0
  v_lshl_add_u32 v7, v14, 3, v7
  s_mul_i32 s32, s31, 20480
  v_add_u32 v7, s32, v7
  v_add_u32 v9, 81920, v7
  v_bfe_u32 v14, v0, 2, 3
  v_mul_u32_u24 v10, 5120, v14
  v_and_b32 v14, 3, v0
  v_lshl_add_u32 v10, v14, 4, v10
  v_lshl_add_u32 v10, v13, 6, v10
  v_lshlrev_b32 v18, 2, v0
  v_mov_b32 v19, 1
  s_lshr_b32 s32, s2, 4
  s_and_b32 s32, s32, 14
  s_sub_u32 s32, 15, s32
  s_mul_i32 s32, s32, 4352
  s_add_u32 s59, s59, s32
  s_lshl_b32 s58, s27, 4
  s_add_u32 s58, s58, s28
  s_mul_i32 s58, s58, 4352
  s_add_u32 s58, s58, 2621440
  s_cmp_eq_u32 s24, 0
  s_cbranch_scc1 kva_kernel_w0_37
  s_waitcnt vmcnt(0)
  s_barrier
  s_add_u32 s33, s34, 81920
  s_add_u32 m0, s36, 0
  s_nop 0
  buffer_load_dwordx4 v3, s[4:7], s33 offen lds
  s_add_u32 m0, s36, 1024
  s_nop 0
  buffer_load_dwordx4 v4, s[4:7], s33 offen lds
  s_add_u32 m0, s36, 2048
  s_nop 0
  buffer_load_dwordx4 v5, s[4:7], s33 offen lds
  s_add_u32 m0, s36, 3072
  s_nop 0
  buffer_load_dwordx4 v6, s[4:7], s33 offen lds
  s_add_u32 m0, s36, 4096
  s_nop 0
  buffer_load_dwordx4 v12, s[4:7], s33 offen lds
  s_add_u32 s33, s34, 163840
  s_add_u32 m0, s36, 40960
  s_nop 0
  buffer_load_dwordx4 v3, s[4:7], s33 offen lds
  s_add_u32 m0, s36, 41984
  s_nop 0
  buffer_load_dwordx4 v4, s[4:7], s33 offen lds
  s_add_u32 m0, s36, 43008
  s_nop 0
  buffer_load_dwordx4 v5, s[4:7], s33 offen lds
  s_add_u32 m0, s36, 44032
  s_nop 0
  buffer_load_dwordx4 v6, s[4:7], s33 offen lds
  s_add_u32 m0, s36, 45056
  s_nop 0
  buffer_load_dwordx4 v12, s[4:7], s33 offen lds
  s_add_u32 s33, s34, 245760
  s_add_u32 m0, s36, 81920
  s_nop 0
  buffer_load_dwordx4 v3, s[4:7], s33 offen lds
  s_add_u32 m0, s36, 82944
  s_nop 0
  buffer_load_dwordx4 v4, s[4:7], s33 offen lds
  s_add_u32 m0, s36, 83968
  s_nop 0
  buffer_load_dwordx4 v5, s[4:7], s33 offen lds
  s_add_u32 m0, s36, 84992
  s_nop 0
  buffer_load_dwordx4 v6, s[4:7], s33 offen lds
  s_add_u32 m0, s36, 86016
  s_nop 0
  buffer_load_dwordx4 v12, s[4:7], s33 offen lds
  s_branch kva_kernel_wj_38
kva_kernel_w0_37:
  s_waitcnt vmcnt(0)
  s_barrier
  s_mov_b64 exec, 1
  buffer_store_dword v19, off, s[44:47], s59 sc1
  s_mov_b64 exec, 0xff
  buffer_load_dword v17, v18, s[44:47], s58 offen sc1
  s_mov_b64 exec, -1
  s_add_u32 s33, s34, 81920
  s_add_u32 m0, s36, 0
  s_nop 0
  buffer_load_dwordx4 v3, s[4:7], s33 offen lds
  s_add_u32 m0, s36, 1024
  s_nop 0
  buffer_load_dwordx4 v4, s[4:7], s33 offen lds
  s_add_u32 m0, s36, 2048
  s_nop 0
  buffer_load_dwordx4 v5, s[4:7], s33 offen lds
  s_add_u32 m0, s36, 3072
  s_nop 0
  buffer_load_dwordx4 v6, s[4:7], s33 offen lds
  s_add_u32 m0, s36, 4096
  s_nop 0
  buffer_load_dwordx4 v12, s[4:7], s33 offen lds
  s_add_u32 s33, s34, 163840
  s_add_u32 m0, s36, 40960
  s_nop 0
  buffer_load_dwordx4 v3, s[4:7], s33 offen lds
  s_add_u32 m0, s36, 41984
  s_nop 0
  buffer_load_dwordx4 v4, s[4:7], s33 offen lds
  s_add_u32 m0, s36, 43008
  s_nop 0
  buffer_load_dwordx4 v5, s[4:7], s33 offen lds
  s_add_u32 m0, s36, 44032
  s_nop 0
  buffer_load_dwordx4 v6, s[4:7], s33 offen lds
  s_add_u32 m0, s36, 45056
  s_nop 0
  buffer_load_dwordx4 v12, s[4:7], s33 offen lds
  s_add_u32 s33, s34, 245760
  s_add_u32 m0, s36, 81920
  s_nop 0
  buffer_load_dwordx4 v3, s[4:7], s33 offen lds
  s_add_u32 m0, s36, 82944
  s_nop 0
  buffer_load_dwordx4 v4, s[4:7], s33 offen lds
  s_add_u32 m0, s36, 83968
  s_nop 0
  buffer_load_dwordx4 v5, s[4:7], s33 offen lds
  s_add_u32 m0, s36, 84992
  s_nop 0
  buffer_load_dwordx4 v6, s[4:7], s33 offen lds
  s_add_u32 m0, s36, 86016
  s_nop 0
  buffer_load_dwordx4 v12, s[4:7], s33 offen lds
  s_waitcnt vmcnt(15)
  s_mov_b64 exec, 0xff
  v_cmp_eq_u32 vcc, 0, v17
  s_mov_b64 exec, -1
  s_cbranch_vccnz kva_kernel_ospin_39
kva_kernel_wj_38:
  s_waitcnt vmcnt(15)
  s_barrier
  s_add_u32 s32, s35, 0
  buffer_load_dwordx4 v[96:99], v2, s[8:11], s32 offen offset:0
  buffer_load_dwordx4 v[100:103], v2, s[8:11], s32 offen offset:1024
  buffer_load_dwordx4 v[104:107], v2, s[8:11], s32 offen offset:2048
  buffer_load_dwordx4 v[108:111], v2, s[8:11], s32 offen offset:3072
  s_add_u32 s32, s35, 4096
  buffer_load_dwordx4 v[112:115], v2, s[8:11], s32 offen offset:0
  buffer_load_dwordx4 v[116:119], v2, s[8:11], s32 offen offset:1024
  buffer_load_dwordx4 v[120:123], v2, s[8:11], s32 offen offset:2048
  buffer_load_dwordx4 v[124:127], v2, s[8:11], s32 offen offset:3072
  ds_read_b64_tr_b16 v[224:225], v9 offset:40960
  ds_read_b64_tr_b16 v[226:227], v9 offset:43520
  ds_read_b64_tr_b16 v[228:229], v9 offset:41216
  ds_read_b64_tr_b16 v[230:231], v9 offset:43776
  ds_read_b64_tr_b16 v[232:233], v9 offset:41472
  ds_read_b64_tr_b16 v[234:235], v9 offset:44032
  ds_read_b64_tr_b16 v[236:237], v9 offset:41728
  ds_read_b64_tr_b16 v[238:239], v9 offset:44288
  ds_read_b64_tr_b16 v[240:241], v9 offset:41984
  ds_read_b64_tr_b16 v[242:243], v9 offset:44544
  ds_read_b64_tr_b16 v[244:245], v9 offset:46080
  ds_read_b64_tr_b16 v[246:247], v9 offset:48640
  s_waitcnt vmcnt(4)
  s_waitcnt lgkmcnt(10)
  v_mfma_f32_32x32x16_bf16 v[16:31], v[224:227], v[96:99], 0
  ds_read_b64_tr_b16 v[248:249], v9 offset:46336
  ds_read_b64_tr_b16 v[250:251], v9 offset:48896
  s_add_u32 s32, s35, 8192
  buffer_load_dwordx4 v[128:131], v2, s[8:11], s32 offen offset:0
  s_waitcnt lgkmcnt(10)
  v_mfma_f32_32x32x16_bf16 v[32:47], v[228:231], v[96:99], 0
  ds_read_b64_tr_b16 v[252:253], v9 offset:46592
  ds_read_b64_tr_b16 v[254:255], v9 offset:49152
  buffer_load_dwordx4 v[132:135], v2, s[8:11], s32 offen offset:1024
  s_waitcnt lgkmcnt(10)
  v_mfma_f32_32x32x16_bf16 v[48:63], v[232:235], v[96:99], 0
  ds_read_b64_tr_b16 v[224:225], v9 offset:46848
  ds_read_b64_tr_b16 v[226:227], v9 offset:49408
  buffer_load_dwordx4 v[136:139], v2, s[8:11], s32 offen offset:2048
  s_waitcnt lgkmcnt(10)
  v_mfma_f32_32x32x16_bf16 v[64:79], v[236:239], v[96:99], 0
  ds_read_b64_tr_b16 v[228:229], v9 offset:47104
  ds_read_b64_tr_b16 v[230:231], v9 offset:49664
  buffer_load_dwordx4 v[140:143], v2, s[8:11], s32 offen offset:3072
  s_waitcnt lgkmcnt(10)
  v_mfma_f32_32x32x16_bf16 v[80:95], v[240:243], v[96:99], 0
  ds_read_b64_tr_b16 v[232:233], v9 offset:51200
  ds_read_b64_tr_b16 v[234:235], v9 offset:53760
  s_add_u32 s32, s35, 12288
  buffer_load_dwordx4 v[144:147], v2, s[8:11], s32 offen offset:0
  s_waitcnt lgkmcnt(10)
  v_mfma_f32_32x32x16_bf16 v[16:31], v[244:247], v[100:103], v[16:31]
  ds_read_b64_tr_b16 v[236:237], v9 offset:51456
  ds_read_b64_tr_b16 v[238:239], v9 offset:54016
  buffer_load_dwordx4 v[148:151], v2, s[8:11], s32 offen offset:1024
  s_waitcnt lgkmcnt(10)
  v_mfma_f32_32x32x16_bf16 v[32:47], v[248:251], v[100:103], v[32:47]
  ds_read_b64_tr_b16 v[240:241], v9 offset:51712
  ds_read_b64_tr_b16 v[242:243], v9 offset:54272
  buffer_load_dwordx4 v[152:155], v2, s[8:11], s32 offen offset:2048
  s_waitcnt lgkmcnt(10)
  v_mfma_f32_32x32x16_bf16 v[48:63], v[252:255], v[100:103], v[48:63]
  ds_read_b64_tr_b16 v[244:245], v9 offset:51968
  ds_read_b64_tr_b16 v[246:247], v9 offset:54528
  buffer_load_dwordx4 v[156:159], v2, s[8:11], s32 offen offset:3072
  s_waitcnt lgkmcnt(10)
  v_mfma_f32_32x32x16_bf16 v[64:79], v[224:227], v[100:103], v[64:79]
  ds_read_b64_tr_b16 v[248:249], v9 offset:52224
  ds_read_b64_tr_b16 v[250:251], v9 offset:54784
  s_add_u32 s32, s35, 16384
  buffer_load_dwordx4 v[160:163], v2, s[8:11], s32 offen offset:0
  s_waitcnt lgkmcnt(10)
  v_mfma_f32_32x32x16_bf16 v[80:95], v[228:231], v[100:103], v[80:95]
  ds_read_b64_tr_b16 v[252:253], v9 offset:56320
  ds_read_b64_tr_b16 v[254:255], v9 offset:58880
  buffer_load_dwordx4 v[164:167], v2, s[8:11], s32 offen offset:1024
  s_waitcnt lgkmcnt(10)
  v_mfma_f32_32x32x16_bf16 v[16:31], v[232:235], v[104:107], v[16:31]
  ds_read_b64_tr_b16 v[224:225], v9 offset:56576
  ds_read_b64_tr_b16 v[226:227], v9 offset:59136
  buffer_load_dwordx4 v[168:171], v2, s[8:11], s32 offen offset:2048
  s_waitcnt lgkmcnt(10)
  v_mfma_f32_32x32x16_bf16 v[32:47], v[236:239], v[104:107], v[32:47]
  ds_read_b64_tr_b16 v[228:229], v9 offset:56832
  ds_read_b64_tr_b16 v[230:231], v9 offset:59392
  buffer_load_dwordx4 v[172:175], v2, s[8:11], s32 offen offset:3072
  s_waitcnt lgkmcnt(10)
  v_mfma_f32_32x32x16_bf16 v[48:63], v[240:243], v[104:107], v[48:63]
  ds_read_b64_tr_b16 v[232:233], v9 offset:57088
  ds_read_b64_tr_b16 v[234:235], v9 offset:59648
  s_add_u32 s32, s35, 20480
  buffer_load_dwordx4 v[176:179], v2, s[8:11], s32 offen offset:0
  s_waitcnt lgkmcnt(10)
  v_mfma_f32_32x32x16_bf16 v[64:79], v[244:247], v[104:107], v[64:79]
  ds_read_b64_tr_b16 v[236:237], v9 offset:57344
  ds_read_b64_tr_b16 v[238:239], v9 offset:59904
  buffer_load_dwordx4 v[180:183], v2, s[8:11], s32 offen offset:1024
  s_waitcnt lgkmcnt(10)
  v_mfma_f32_32x32x16_bf16 v[80:95], v[248:251], v[104:107], v[80:95]
  s_waitcnt vmcnt(14)
  s_barrier
  ds_read_b64_tr_b16 v[240:241], v7 offset:0
  ds_read_b64_tr_b16 v[242:243], v7 offset:2560
  buffer_load_dwordx4 v[184:187], v2, s[8:11], s32 offen offset:2048
  s_waitcnt lgkmcnt(10)
  v_mfma_f32_32x32x16_bf16 v[16:31], v[252:255], v[108:111], v[16:31]
  ds_read_b64_tr_b16 v[244:245], v7 offset:256
  ds_read_b64_tr_b16 v[246:247], v7 offset:2816
  buffer_load_dwordx4 v[188:191], v2, s[8:11], s32 offen offset:3072
  s_waitcnt lgkmcnt(10)
  v_mfma_f32_32x32x16_bf16 v[32:47], v[224:227], v[108:111], v[32:47]
  ds_read_b64_tr_b16 v[248:249], v7 offset:512
  ds_read_b64_tr_b16 v[250:251], v7 offset:3072
  s_add_u32 s32, s35, 24576
  buffer_load_dwordx4 v[192:195], v2, s[8:11], s32 offen offset:0
  s_waitcnt lgkmcnt(10)
  v_mfma_f32_32x32x16_bf16 v[48:63], v[228:231], v[108:111], v[48:63]
  ds_read_b64_tr_b16 v[252:253], v7 offset:768
  ds_read_b64_tr_b16 v[254:255], v7 offset:3328
  buffer_load_dwordx4 v[196:199], v2, s[8:11], s32 offen offset:1024
  s_waitcnt lgkmcnt(10)
  v_mfma_f32_32x32x16_bf16 v[64:79], v[232:235], v[108:111], v[64:79]
  ds_read_b64_tr_b16 v[224:225], v7 offset:1024
  ds_read_b64_tr_b16 v[226:227], v7 offset:3584
  buffer_load_dwordx4 v[200:203], v2, s[8:11], s32 offen offset:2048
  s_waitcnt lgkmcnt(10)
  v_mfma_f32_32x32x16_bf16 v[80:95], v[236:239], v[108:111], v[80:95]
  ds_read_b64_tr_b16 v[228:229], v7 offset:5120
  ds_read_b64_tr_b16 v[230:231], v7 offset:7680
  buffer_load_dwordx4 v[204:207], v2, s[8:11], s32 offen offset:3072
  s_waitcnt lgkmcnt(10)
  v_mfma_f32_32x32x16_bf16 v[16:31], v[240:243], v[112:115], v[16:31]
  ds_read_b64_tr_b16 v[232:233], v7 offset:5376
  ds_read_b64_tr_b16 v[234:235], v7 offset:7936
  s_add_u32 s32, s35, 28672
  buffer_load_dwordx4 v[208:211], v2, s[8:11], s32 offen offset:0
  s_waitcnt lgkmcnt(10)
  v_mfma_f32_32x32x16_bf16 v[32:47], v[244:247], v[112:115], v[32:47]
  ds_read_b64_tr_b16 v[236:237], v7 offset:5632
  ds_read_b64_tr_b16 v[238:239], v7 offset:8192
  buffer_load_dwordx4 v[212:215], v2, s[8:11], s32 offen offset:1024
  s_waitcnt lgkmcnt(10)
  v_mfma_f32_32x32x16_bf16 v[48:63], v[248:251], v[112:115], v[48:63]
  ds_read_b64_tr_b16 v[240:241], v7 offset:5888
  ds_read_b64_tr_b16 v[242:243], v7 offset:8448
  buffer_load_dwordx4 v[216:219], v2, s[8:11], s32 offen offset:2048
  s_waitcnt lgkmcnt(10)
  v_mfma_f32_32x32x16_bf16 v[64:79], v[252:255], v[112:115], v[64:79]
  ds_read_b64_tr_b16 v[244:245], v7 offset:6144
  ds_read_b64_tr_b16 v[246:247], v7 offset:8704
  buffer_load_dwordx4 v[220:223], v2, s[8:11], s32 offen offset:3072
  s_waitcnt lgkmcnt(10)
  v_mfma_f32_32x32x16_bf16 v[80:95], v[224:227], v[112:115], v[80:95]
  ds_read_b64_tr_b16 v[248:249], v7 offset:10240
  ds_read_b64_tr_b16 v[250:251], v7 offset:12800
  s_waitcnt lgkmcnt(10)
  v_mfma_f32_32x32x16_bf16 v[16:31], v[228:231], v[116:119], v[16:31]
  ds_read_b64_tr_b16 v[252:253], v7 offset:10496
  ds_read_b64_tr_b16 v[254:255], v7 offset:13056
  s_waitcnt lgkmcnt(10)
  v_mfma_f32_32x32x16_bf16 v[32:47], v[232:235], v[116:119], v[32:47]
  ds_read_b64_tr_b16 v[224:225], v7 offset:10752
  ds_read_b64_tr_b16 v[226:227], v7 offset:13312
  s_waitcnt lgkmcnt(10)
  v_mfma_f32_32x32x16_bf16 v[48:63], v[236:239], v[116:119], v[48:63]
  ds_read_b64_tr_b16 v[228:229], v7 offset:11008
  ds_read_b64_tr_b16 v[230:231], v7 offset:13568
  s_waitcnt lgkmcnt(10)
  v_mfma_f32_32x32x16_bf16 v[64:79], v[240:243], v[116:119], v[64:79]
  ds_read_b64_tr_b16 v[232:233], v7 offset:11264
  ds_read_b64_tr_b16 v[234:235], v7 offset:13824
  s_waitcnt lgkmcnt(10)
  v_mfma_f32_32x32x16_bf16 v[80:95], v[244:247], v[116:119], v[80:95]
  ds_read_b64_tr_b16 v[236:237], v7 offset:15360
  ds_read_b64_tr_b16 v[238:239], v7 offset:17920
  s_waitcnt lgkmcnt(10)
  v_mfma_f32_32x32x16_bf16 v[16:31], v[248:251], v[120:123], v[16:31]
  ds_read_b64_tr_b16 v[240:241], v7 offset:15616
  ds_read_b64_tr_b16 v[242:243], v7 offset:18176
  s_waitcnt lgkmcnt(10)
  v_mfma_f32_32x32x16_bf16 v[32:47], v[252:255], v[120:123], v[32:47]
  ds_read_b64_tr_b16 v[244:245], v7 offset:15872
  ds_read_b64_tr_b16 v[246:247], v7 offset:18432
  s_waitcnt lgkmcnt(10)
  v_mfma_f32_32x32x16_bf16 v[48:63], v[224:227], v[120:123], v[48:63]
  ds_read_b64_tr_b16 v[248:249], v7 offset:16128
  ds_read_b64_tr_b16 v[250:251], v7 offset:18688
  s_waitcnt lgkmcnt(10)
  v_mfma_f32_32x32x16_bf16 v[64:79], v[228:231], v[120:123], v[64:79]
  ds_read_b64_tr_b16 v[252:253], v7 offset:16384
  ds_read_b64_tr_b16 v[254:255], v7 offset:18944
  s_waitcnt lgkmcnt(10)
  v_mfma_f32_32x32x16_bf16 v[80:95], v[232:235], v[120:123], v[80:95]
  s_waitcnt vmcnt(20)
  s_barrier
  ds_read_b64_tr_b16 v[224:225], v7 offset:40960
  ds_read_b64_tr_b16 v[226:227], v7 offset:43520
  s_waitcnt lgkmcnt(10)
  v_mfma_f32_32x32x16_bf16 v[16:31], v[236:239], v[124:127], v[16:31]
  ds_read_b64_tr_b16 v[228:229], v7 offset:41216
  ds_read_b64_tr_b16 v[230:231], v7 offset:43776
  s_add_u32 s33, s34, 327680
  s_add_u32 m0, s36, 122880
  s_nop 0
  buffer_load_dwordx4 v3, s[4:7], s33 offen lds
  s_waitcnt lgkmcnt(10)
  v_mfma_f32_32x32x16_bf16 v[32:47], v[240:243], v[124:127], v[32:47]
  ds_read_b64_tr_b16 v[232:233], v7 offset:41472
  ds_read_b64_tr_b16 v[234:235], v7 offset:44032
  s_add_u32 m0, s36, 123904
  s_nop 0
  buffer_load_dwordx4 v4, s[4:7], s33 offen lds
  s_waitcnt lgkmcnt(10)
  v_mfma_f32_32x32x16_bf16 v[48:63], v[244:247], v[124:127], v[48:63]
  ds_read_b64_tr_b16 v[236:237], v7 offset:41728
  ds_read_b64_tr_b16 v[238:239], v7 offset:44288
  s_add_u32 m0, s36, 124928
  s_nop 0
  buffer_load_dwordx4 v5, s[4:7], s33 offen lds
  s_waitcnt lgkmcnt(10)
  v_mfma_f32_32x32x16_bf16 v[64:79], v[248:251], v[124:127], v[64:79]
  ds_read_b64_tr_b16 v[240:241], v7 offset:41984
  ds_read_b64_tr_b16 v[242:243], v7 offset:44544
  s_add_u32 m0, s36, 125952
  s_nop 0
  buffer_load_dwordx4 v6, s[4:7], s33 offen lds
  s_waitcnt lgkmcnt(10)
  v_mfma_f32_32x32x16_bf16 v[80:95], v[252:255], v[124:127], v[80:95]
  ds_read_b64_tr_b16 v[244:245], v7 offset:46080
  ds_read_b64_tr_b16 v[246:247], v7 offset:48640
  s_add_u32 m0, s36, 126976
  s_nop 0
  buffer_load_dwordx4 v12, s[4:7], s33 offen lds
  s_waitcnt lgkmcnt(10)
  v_mfma_f32_32x32x16_bf16 v[16:31], v[224:227], v[128:131], v[16:31]
  ds_read_b64_tr_b16 v[248:249], v7 offset:46336
  ds_read_b64_tr_b16 v[250:251], v7 offset:48896
  s_waitcnt lgkmcnt(10)
  v_mfma_f32_32x32x16_bf16 v[32:47], v[228:231], v[128:131], v[32:47]
  ds_read_b64_tr_b16 v[252:253], v7 offset:46592
  ds_read_b64_tr_b16 v[254:255], v7 offset:49152
  s_waitcnt lgkmcnt(10)
  v_mfma_f32_32x32x16_bf16 v[48:63], v[232:235], v[128:131], v[48:63]
  ds_read_b64_tr_b16 v[224:225], v7 offset:46848
  ds_read_b64_tr_b16 v[226:227], v7 offset:49408
  s_waitcnt lgkmcnt(10)
  v_mfma_f32_32x32x16_bf16 v[64:79], v[236:239], v[128:131], v[64:79]
  ds_read_b64_tr_b16 v[228:229], v7 offset:47104
  ds_read_b64_tr_b16 v[230:231], v7 offset:49664
  s_waitcnt lgkmcnt(10)
  v_mfma_f32_32x32x16_bf16 v[80:95], v[240:243], v[128:131], v[80:95]
  ds_read_b64_tr_b16 v[232:233], v7 offset:51200
  ds_read_b64_tr_b16 v[234:235], v7 offset:53760
  s_waitcnt lgkmcnt(10)
  v_mfma_f32_32x32x16_bf16 v[16:31], v[244:247], v[132:135], v[16:31]
  ds_read_b64_tr_b16 v[236:237], v7 offset:51456
  ds_read_b64_tr_b16 v[238:239], v7 offset:54016
  s_waitcnt lgkmcnt(10)
  v_mfma_f32_32x32x16_bf16 v[32:47], v[248:251], v[132:135], v[32:47]
  ds_read_b64_tr_b16 v[240:241], v7 offset:51712
  ds_read_b64_tr_b16 v[242:243], v7 offset:54272
  s_waitcnt lgkmcnt(10)
  v_mfma_f32_32x32x16_bf16 v[48:63], v[252:255], v[132:135], v[48:63]
  ds_read_b64_tr_b16 v[244:245], v7 offset:51968
  ds_read_b64_tr_b16 v[246:247], v7 offset:54528
  s_waitcnt lgkmcnt(10)
  v_mfma_f32_32x32x16_bf16 v[64:79], v[224:227], v[132:135], v[64:79]
  ds_read_b64_tr_b16 v[248:249], v7 offset:52224
  ds_read_b64_tr_b16 v[250:251], v7 offset:54784
  s_waitcnt lgkmcnt(10)
  v_mfma_f32_32x32x16_bf16 v[80:95], v[228:231], v[132:135], v[80:95]
  ds_read_b64_tr_b16 v[252:253], v7 offset:56320
  ds_read_b64_tr_b16 v[254:255], v7 offset:58880
  s_waitcnt lgkmcnt(10)
  v_mfma_f32_32x32x16_bf16 v[16:31], v[232:235], v[136:139], v[16:31]
  ds_read_b64_tr_b16 v[224:225], v7 offset:56576
  ds_read_b64_tr_b16 v[226:227], v7 offset:59136
  s_waitcnt lgkmcnt(10)
  v_mfma_f32_32x32x16_bf16 v[32:47], v[236:239], v[136:139], v[32:47]
  ds_read_b64_tr_b16 v[228:229], v7 offset:56832
  ds_read_b64_tr_b16 v[230:231], v7 offset:59392
  s_waitcnt lgkmcnt(10)
  v_mfma_f32_32x32x16_bf16 v[48:63], v[240:243], v[136:139], v[48:63]
  ds_read_b64_tr_b16 v[232:233], v7 offset:57088
  ds_read_b64_tr_b16 v[234:235], v7 offset:59648
  s_waitcnt lgkmcnt(10)
  v_mfma_f32_32x32x16_bf16 v[64:79], v[244:247], v[136:139], v[64:79]
  ds_read_b64_tr_b16 v[236:237], v7 offset:57344
  ds_read_b64_tr_b16 v[238:239], v7 offset:59904
  s_waitcnt lgkmcnt(10)
  v_mfma_f32_32x32x16_bf16 v[80:95], v[248:251], v[136:139], v[80:95]
  s_waitcnt vmcnt(21)
  s_barrier
  ds_read_b64_tr_b16 v[240:241], v9 offset:0
  ds_read_b64_tr_b16 v[242:243], v9 offset:2560
  s_waitcnt lgkmcnt(10)
  v_mfma_f32_32x32x16_bf16 v[16:31], v[252:255], v[140:143], v[16:31]
  ds_read_b64_tr_b16 v[244:245], v9 offset:256
  ds_read_b64_tr_b16 v[246:247], v9 offset:2816
  s_add_u32 s33, s34, 409600
  s_add_u32 m0, s36, 0
  s_nop 0
  buffer_load_dwordx4 v3, s[4:7], s33 offen lds
  s_waitcnt lgkmcnt(10)
  v_mfma_f32_32x32x16_bf16 v[32:47], v[224:227], v[140:143], v[32:47]
  ds_read_b64_tr_b16 v[248:249], v9 offset:512
  ds_read_b64_tr_b16 v[250:251], v9 offset:3072
  s_add_u32 m0, s36, 1024
  s_nop 0
  buffer_load_dwordx4 v4, s[4:7], s33 offen lds
  s_waitcnt lgkmcnt(10)
  v_mfma_f32_32x32x16_bf16 v[48:63], v[228:231], v[140:143], v[48:63]
  ds_read_b64_tr_b16 v[252:253], v9 offset:768
  ds_read_b64_tr_b16 v[254:255], v9 offset:3328
  s_add_u32 m0, s36, 2048
  s_nop 0
  buffer_load_dwordx4 v5, s[4:7], s33 offen lds
  s_waitcnt lgkmcnt(10)
  v_mfma_f32_32x32x16_bf16 v[64:79], v[232:235], v[140:143], v[64:79]
  ds_read_b64_tr_b16 v[224:225], v9 offset:1024
  ds_read_b64_tr_b16 v[226:227], v9 offset:3584
  s_add_u32 m0, s36, 3072
  s_nop 0
  buffer_load_dwordx4 v6, s[4:7], s33 offen lds
  s_waitcnt lgkmcnt(10)
  v_mfma_f32_32x32x16_bf16 v[80:95], v[236:239], v[140:143], v[80:95]
  ds_read_b64_tr_b16 v[228:229], v9 offset:5120
  ds_read_b64_tr_b16 v[230:231], v9 offset:7680
  s_add_u32 m0, s36, 4096
  s_nop 0
  buffer_load_dwordx4 v12, s[4:7], s33 offen lds
  s_waitcnt lgkmcnt(10)
  v_mfma_f32_32x32x16_bf16 v[16:31], v[240:243], v[144:147], v[16:31]
  ds_read_b64_tr_b16 v[232:233], v9 offset:5376
  ds_read_b64_tr_b16 v[234:235], v9 offset:7936
  s_waitcnt lgkmcnt(10)
  v_mfma_f32_32x32x16_bf16 v[32:47], v[244:247], v[144:147], v[32:47]
  ds_read_b64_tr_b16 v[236:237], v9 offset:5632
  ds_read_b64_tr_b16 v[238:239], v9 offset:8192
  s_waitcnt lgkmcnt(10)
  v_mfma_f32_32x32x16_bf16 v[48:63], v[248:251], v[144:147], v[48:63]
  ds_read_b64_tr_b16 v[240:241], v9 offset:5888
  ds_read_b64_tr_b16 v[242:243], v9 offset:8448
  s_waitcnt lgkmcnt(10)
  v_mfma_f32_32x32x16_bf16 v[64:79], v[252:255], v[144:147], v[64:79]
  ds_read_b64_tr_b16 v[244:245], v9 offset:6144
  ds_read_b64_tr_b16 v[246:247], v9 offset:8704
  s_waitcnt lgkmcnt(10)
  v_mfma_f32_32x32x16_bf16 v[80:95], v[224:227], v[144:147], v[80:95]
  ds_read_b64_tr_b16 v[248:249], v9 offset:10240
  ds_read_b64_tr_b16 v[250:251], v9 offset:12800
  s_waitcnt lgkmcnt(10)
  v_mfma_f32_32x32x16_bf16 v[16:31], v[228:231], v[148:151], v[16:31]
  ds_read_b64_tr_b16 v[252:253], v9 offset:10496
  ds_read_b64_tr_b16 v[254:255], v9 offset:13056
  s_waitcnt lgkmcnt(10)
  v_mfma_f32_32x32x16_bf16 v[32:47], v[232:235], v[148:151], v[32:47]
  ds_read_b64_tr_b16 v[224:225], v9 offset:10752
  ds_read_b64_tr_b16 v[226:227], v9 offset:13312
  s_waitcnt lgkmcnt(10)
  v_mfma_f32_32x32x16_bf16 v[48:63], v[236:239], v[148:151], v[48:63]
  ds_read_b64_tr_b16 v[228:229], v9 offset:11008
  ds_read_b64_tr_b16 v[230:231], v9 offset:13568
  s_waitcnt lgkmcnt(10)
  v_mfma_f32_32x32x16_bf16 v[64:79], v[240:243], v[148:151], v[64:79]
  ds_read_b64_tr_b16 v[232:233], v9 offset:11264
  ds_read_b64_tr_b16 v[234:235], v9 offset:13824
  s_waitcnt lgkmcnt(10)
  v_mfma_f32_32x32x16_bf16 v[80:95], v[244:247], v[148:151], v[80:95]
  ds_read_b64_tr_b16 v[236:237], v9 offset:15360
  ds_read_b64_tr_b16 v[238:239], v9 offset:17920
  s_waitcnt lgkmcnt(10)
  v_mfma_f32_32x32x16_bf16 v[16:31], v[248:251], v[152:155], v[16:31]
  ds_read_b64_tr_b16 v[240:241], v9 offset:15616
  ds_read_b64_tr_b16 v[242:243], v9 offset:18176
  s_waitcnt lgkmcnt(10)
  v_mfma_f32_32x32x16_bf16 v[32:47], v[252:255], v[152:155], v[32:47]
  ds_read_b64_tr_b16 v[244:245], v9 offset:15872
  ds_read_b64_tr_b16 v[246:247], v9 offset:18432
  s_waitcnt lgkmcnt(10)
  v_mfma_f32_32x32x16_bf16 v[48:63], v[224:227], v[152:155], v[48:63]
  ds_read_b64_tr_b16 v[248:249], v9 offset:16128
  ds_read_b64_tr_b16 v[250:251], v9 offset:18688
  s_waitcnt lgkmcnt(10)
  v_mfma_f32_32x32x16_bf16 v[64:79], v[228:231], v[152:155], v[64:79]
  ds_read_b64_tr_b16 v[252:253], v9 offset:16384
  ds_read_b64_tr_b16 v[254:255], v9 offset:18944
  s_waitcnt lgkmcnt(10)
  v_mfma_f32_32x32x16_bf16 v[80:95], v[232:235], v[152:155], v[80:95]
  s_waitcnt vmcnt(5)
  s_barrier
  ds_read_b64_tr_b16 v[224:225], v9 offset:40960
  ds_read_b64_tr_b16 v[226:227], v9 offset:43520
  s_waitcnt lgkmcnt(10)
  v_mfma_f32_32x32x16_bf16 v[16:31], v[236:239], v[156:159], v[16:31]
  ds_read_b64_tr_b16 v[228:229], v9 offset:41216
  ds_read_b64_tr_b16 v[230:231], v9 offset:43776
  s_add_u32 s33, s34, 491520
  s_add_u32 m0, s36, 40960
  s_nop 0
  buffer_load_dwordx4 v3, s[4:7], s33 offen lds
  s_waitcnt lgkmcnt(10)
  v_mfma_f32_32x32x16_bf16 v[32:47], v[240:243], v[156:159], v[32:47]
  ds_read_b64_tr_b16 v[232:233], v9 offset:41472
  ds_read_b64_tr_b16 v[234:235], v9 offset:44032
  s_add_u32 m0, s36, 41984
  s_nop 0
  buffer_load_dwordx4 v4, s[4:7], s33 offen lds
  s_waitcnt lgkmcnt(10)
  v_mfma_f32_32x32x16_bf16 v[48:63], v[244:247], v[156:159], v[48:63]
  ds_read_b64_tr_b16 v[236:237], v9 offset:41728
  ds_read_b64_tr_b16 v[238:239], v9 offset:44288
  s_add_u32 m0, s36, 43008
  s_nop 0
  buffer_load_dwordx4 v5, s[4:7], s33 offen lds
  s_waitcnt lgkmcnt(10)
  v_mfma_f32_32x32x16_bf16 v[64:79], v[248:251], v[156:159], v[64:79]
  ds_read_b64_tr_b16 v[240:241], v9 offset:41984
  ds_read_b64_tr_b16 v[242:243], v9 offset:44544
  s_add_u32 m0, s36, 44032
  s_nop 0
  buffer_load_dwordx4 v6, s[4:7], s33 offen lds
  s_waitcnt lgkmcnt(10)
  v_mfma_f32_32x32x16_bf16 v[80:95], v[252:255], v[156:159], v[80:95]
  ds_read_b64_tr_b16 v[244:245], v9 offset:46080
  ds_read_b64_tr_b16 v[246:247], v9 offset:48640
  s_add_u32 m0, s36, 45056
  s_nop 0
  buffer_load_dwordx4 v12, s[4:7], s33 offen lds
  s_waitcnt lgkmcnt(10)
  v_mfma_f32_32x32x16_bf16 v[16:31], v[224:227], v[160:163], v[16:31]
  ds_read_b64_tr_b16 v[248:249], v9 offset:46336
  ds_read_b64_tr_b16 v[250:251], v9 offset:48896
  s_waitcnt lgkmcnt(10)
  v_mfma_f32_32x32x16_bf16 v[32:47], v[228:231], v[160:163], v[32:47]
  ds_read_b64_tr_b16 v[252:253], v9 offset:46592
  ds_read_b64_tr_b16 v[254:255], v9 offset:49152
  s_waitcnt lgkmcnt(10)
  v_mfma_f32_32x32x16_bf16 v[48:63], v[232:235], v[160:163], v[48:63]
  ds_read_b64_tr_b16 v[224:225], v9 offset:46848
  ds_read_b64_tr_b16 v[226:227], v9 offset:49408
  s_waitcnt lgkmcnt(10)
  v_mfma_f32_32x32x16_bf16 v[64:79], v[236:239], v[160:163], v[64:79]
  ds_read_b64_tr_b16 v[228:229], v9 offset:47104
  ds_read_b64_tr_b16 v[230:231], v9 offset:49664
  s_waitcnt lgkmcnt(10)
  v_mfma_f32_32x32x16_bf16 v[80:95], v[240:243], v[160:163], v[80:95]
  ds_read_b64_tr_b16 v[232:233], v9 offset:51200
  ds_read_b64_tr_b16 v[234:235], v9 offset:53760
  s_waitcnt lgkmcnt(10)
  v_mfma_f32_32x32x16_bf16 v[16:31], v[244:247], v[164:167], v[16:31]
  ds_read_b64_tr_b16 v[236:237], v9 offset:51456
  ds_read_b64_tr_b16 v[238:239], v9 offset:54016
  s_waitcnt lgkmcnt(10)
  v_mfma_f32_32x32x16_bf16 v[32:47], v[248:251], v[164:167], v[32:47]
  ds_read_b64_tr_b16 v[240:241], v9 offset:51712
  ds_read_b64_tr_b16 v[242:243], v9 offset:54272
  s_waitcnt lgkmcnt(10)
  v_mfma_f32_32x32x16_bf16 v[48:63], v[252:255], v[164:167], v[48:63]
  ds_read_b64_tr_b16 v[244:245], v9 offset:51968
  ds_read_b64_tr_b16 v[246:247], v9 offset:54528
  s_waitcnt lgkmcnt(10)
  v_mfma_f32_32x32x16_bf16 v[64:79], v[224:227], v[164:167], v[64:79]
  ds_read_b64_tr_b16 v[248:249], v9 offset:52224
  ds_read_b64_tr_b16 v[250:251], v9 offset:54784
  s_waitcnt lgkmcnt(10)
  v_mfma_f32_32x32x16_bf16 v[80:95], v[228:231], v[164:167], v[80:95]
  ds_read_b64_tr_b16 v[252:253], v9 offset:56320
  ds_read_b64_tr_b16 v[254:255], v9 offset:58880
  s_waitcnt lgkmcnt(10)
  v_mfma_f32_32x32x16_bf16 v[16:31], v[232:235], v[168:171], v[16:31]
  ds_read_b64_tr_b16 v[224:225], v9 offset:56576
  ds_read_b64_tr_b16 v[226:227], v9 offset:59136
  s_waitcnt lgkmcnt(10)
  v_mfma_f32_32x32x16_bf16 v[32:47], v[236:239], v[168:171], v[32:47]
  ds_read_b64_tr_b16 v[228:229], v9 offset:56832
  ds_read_b64_tr_b16 v[230:231], v9 offset:59392
  s_waitcnt lgkmcnt(10)
  v_mfma_f32_32x32x16_bf16 v[48:63], v[240:243], v[168:171], v[48:63]
  ds_read_b64_tr_b16 v[232:233], v9 offset:57088
  ds_read_b64_tr_b16 v[234:235], v9 offset:59648
  s_waitcnt lgkmcnt(10)
  v_mfma_f32_32x32x16_bf16 v[64:79], v[244:247], v[168:171], v[64:79]
  ds_read_b64_tr_b16 v[236:237], v9 offset:57344
  ds_read_b64_tr_b16 v[238:239], v9 offset:59904
  s_waitcnt lgkmcnt(10)
  v_mfma_f32_32x32x16_bf16 v[80:95], v[248:251], v[168:171], v[80:95]
  s_waitcnt vmcnt(5)
  s_barrier
  ds_read_b64_tr_b16 v[240:241], v7 offset:0
  ds_read_b64_tr_b16 v[242:243], v7 offset:2560
  s_waitcnt lgkmcnt(10)
  v_mfma_f32_32x32x16_bf16 v[16:31], v[252:255], v[172:175], v[16:31]
  ds_read_b64_tr_b16 v[244:245], v7 offset:256
  ds_read_b64_tr_b16 v[246:247], v7 offset:2816
  s_add_u32 s33, s34, 573440
  s_add_u32 m0, s36, 81920
  s_nop 0
  buffer_load_dwordx4 v3, s[4:7], s33 offen lds
  s_waitcnt lgkmcnt(10)
  v_mfma_f32_32x32x16_bf16 v[32:47], v[224:227], v[172:175], v[32:47]
  ds_read_b64_tr_b16 v[248:249], v7 offset:512
  ds_read_b64_tr_b16 v[250:251], v7 offset:3072
  s_add_u32 m0, s36, 82944
  s_nop 0
  buffer_load_dwordx4 v4, s[4:7], s33 offen lds
  s_waitcnt lgkmcnt(10)
  v_mfma_f32_32x32x16_bf16 v[48:63], v[228:231], v[172:175], v[48:63]
  ds_read_b64_tr_b16 v[252:253], v7 offset:768
  ds_read_b64_tr_b16 v[254:255], v7 offset:3328
  s_add_u32 m0, s36, 83968
  s_nop 0
  buffer_load_dwordx4 v5, s[4:7], s33 offen lds
  s_waitcnt lgkmcnt(10)
  v_mfma_f32_32x32x16_bf16 v[64:79], v[232:235], v[172:175], v[64:79]
  ds_read_b64_tr_b16 v[224:225], v7 offset:1024
  ds_read_b64_tr_b16 v[226:227], v7 offset:3584
  s_add_u32 m0, s36, 84992
  s_nop 0
  buffer_load_dwordx4 v6, s[4:7], s33 offen lds
  s_waitcnt lgkmcnt(10)
  v_mfma_f32_32x32x16_bf16 v[80:95], v[236:239], v[172:175], v[80:95]
  ds_read_b64_tr_b16 v[228:229], v7 offset:5120
  ds_read_b64_tr_b16 v[230:231], v7 offset:7680
  s_add_u32 m0, s36, 86016
  s_nop 0
  buffer_load_dwordx4 v12, s[4:7], s33 offen lds
  s_waitcnt lgkmcnt(10)
  v_mfma_f32_32x32x16_bf16 v[16:31], v[240:243], v[176:179], v[16:31]
  ds_read_b64_tr_b16 v[232:233], v7 offset:5376
  ds_read_b64_tr_b16 v[234:235], v7 offset:7936
  s_waitcnt lgkmcnt(10)
  v_mfma_f32_32x32x16_bf16 v[32:47], v[244:247], v[176:179], v[32:47]
  ds_read_b64_tr_b16 v[236:237], v7 offset:5632
  ds_read_b64_tr_b16 v[238:239], v7 offset:8192
  s_waitcnt lgkmcnt(10)
  v_mfma_f32_32x32x16_bf16 v[48:63], v[248:251], v[176:179], v[48:63]
  ds_read_b64_tr_b16 v[240:241], v7 offset:5888
  ds_read_b64_tr_b16 v[242:243], v7 offset:8448
  s_waitcnt lgkmcnt(10)
  v_mfma_f32_32x32x16_bf16 v[64:79], v[252:255], v[176:179], v[64:79]
  ds_read_b64_tr_b16 v[244:245], v7 offset:6144
  ds_read_b64_tr_b16 v[246:247], v7 offset:8704
  s_waitcnt lgkmcnt(10)
  v_mfma_f32_32x32x16_bf16 v[80:95], v[224:227], v[176:179], v[80:95]
  ds_read_b64_tr_b16 v[248:249], v7 offset:10240
  ds_read_b64_tr_b16 v[250:251], v7 offset:12800
  s_waitcnt lgkmcnt(10)
  v_mfma_f32_32x32x16_bf16 v[16:31], v[228:231], v[180:183], v[16:31]
  ds_read_b64_tr_b16 v[252:253], v7 offset:10496
  ds_read_b64_tr_b16 v[254:255], v7 offset:13056
  s_waitcnt lgkmcnt(10)
  v_mfma_f32_32x32x16_bf16 v[32:47], v[232:235], v[180:183], v[32:47]
  ds_read_b64_tr_b16 v[224:225], v7 offset:10752
  ds_read_b64_tr_b16 v[226:227], v7 offset:13312
  s_waitcnt lgkmcnt(10)
  v_mfma_f32_32x32x16_bf16 v[48:63], v[236:239], v[180:183], v[48:63]
  ds_read_b64_tr_b16 v[228:229], v7 offset:11008
  ds_read_b64_tr_b16 v[230:231], v7 offset:13568
  s_waitcnt lgkmcnt(10)
  v_mfma_f32_32x32x16_bf16 v[64:79], v[240:243], v[180:183], v[64:79]
  ds_read_b64_tr_b16 v[232:233], v7 offset:11264
  ds_read_b64_tr_b16 v[234:235], v7 offset:13824
  s_waitcnt lgkmcnt(10)
  v_mfma_f32_32x32x16_bf16 v[80:95], v[244:247], v[180:183], v[80:95]
  ds_read_b64_tr_b16 v[236:237], v7 offset:15360
  ds_read_b64_tr_b16 v[238:239], v7 offset:17920
  s_waitcnt lgkmcnt(10)
  v_mfma_f32_32x32x16_bf16 v[16:31], v[248:251], v[184:187], v[16:31]
  ds_read_b64_tr_b16 v[240:241], v7 offset:15616
  ds_read_b64_tr_b16 v[242:243], v7 offset:18176
  s_waitcnt lgkmcnt(10)
  v_mfma_f32_32x32x16_bf16 v[32:47], v[252:255], v[184:187], v[32:47]
  ds_read_b64_tr_b16 v[244:245], v7 offset:15872
  ds_read_b64_tr_b16 v[246:247], v7 offset:18432
  s_waitcnt lgkmcnt(10)
  v_mfma_f32_32x32x16_bf16 v[48:63], v[224:227], v[184:187], v[48:63]
  ds_read_b64_tr_b16 v[248:249], v7 offset:16128
  ds_read_b64_tr_b16 v[250:251], v7 offset:18688
  s_waitcnt lgkmcnt(10)
  v_mfma_f32_32x32x16_bf16 v[64:79], v[228:231], v[184:187], v[64:79]
  ds_read_b64_tr_b16 v[252:253], v7 offset:16384
  ds_read_b64_tr_b16 v[254:255], v7 offset:18944
  s_waitcnt lgkmcnt(10)
  v_mfma_f32_32x32x16_bf16 v[80:95], v[232:235], v[184:187], v[80:95]
  s_waitcnt vmcnt(5)
  s_barrier
  ds_read_b64_tr_b16 v[224:225], v7 offset:40960
  ds_read_b64_tr_b16 v[226:227], v7 offset:43520
  s_waitcnt lgkmcnt(10)
  v_mfma_f32_32x32x16_bf16 v[16:31], v[236:239], v[188:191], v[16:31]
  ds_read_b64_tr_b16 v[228:229], v7 offset:41216
  ds_read_b64_tr_b16 v[230:231], v7 offset:43776
  s_waitcnt lgkmcnt(10)
  v_mfma_f32_32x32x16_bf16 v[32:47], v[240:243], v[188:191], v[32:47]
  ds_read_b64_tr_b16 v[232:233], v7 offset:41472
  ds_read_b64_tr_b16 v[234:235], v7 offset:44032
  s_waitcnt lgkmcnt(10)
  v_mfma_f32_32x32x16_bf16 v[48:63], v[244:247], v[188:191], v[48:63]
  ds_read_b64_tr_b16 v[236:237], v7 offset:41728
  ds_read_b64_tr_b16 v[238:239], v7 offset:44288
  s_waitcnt lgkmcnt(10)
  v_mfma_f32_32x32x16_bf16 v[64:79], v[248:251], v[188:191], v[64:79]
  ds_read_b64_tr_b16 v[240:241], v7 offset:41984
  ds_read_b64_tr_b16 v[242:243], v7 offset:44544
  s_waitcnt lgkmcnt(10)
  v_mfma_f32_32x32x16_bf16 v[80:95], v[252:255], v[188:191], v[80:95]
  ds_read_b64_tr_b16 v[244:245], v7 offset:46080
  ds_read_b64_tr_b16 v[246:247], v7 offset:48640
  s_waitcnt lgkmcnt(10)
  v_mfma_f32_32x32x16_bf16 v[16:31], v[224:227], v[192:195], v[16:31]
  ds_read_b64_tr_b16 v[248:249], v7 offset:46336
  ds_read_b64_tr_b16 v[250:251], v7 offset:48896
  s_waitcnt lgkmcnt(10)
  v_mfma_f32_32x32x16_bf16 v[32:47], v[228:231], v[192:195], v[32:47]
  ds_read_b64_tr_b16 v[252:253], v7 offset:46592
  ds_read_b64_tr_b16 v[254:255], v7 offset:49152
  s_waitcnt lgkmcnt(10)
  v_mfma_f32_32x32x16_bf16 v[48:63], v[232:235], v[192:195], v[48:63]
  ds_read_b64_tr_b16 v[224:225], v7 offset:46848
  ds_read_b64_tr_b16 v[226:227], v7 offset:49408
  s_waitcnt lgkmcnt(10)
  v_mfma_f32_32x32x16_bf16 v[64:79], v[236:239], v[192:195], v[64:79]
  ds_read_b64_tr_b16 v[228:229], v7 offset:47104
  ds_read_b64_tr_b16 v[230:231], v7 offset:49664
  s_waitcnt lgkmcnt(10)
  v_mfma_f32_32x32x16_bf16 v[80:95], v[240:243], v[192:195], v[80:95]
  ds_read_b64_tr_b16 v[232:233], v7 offset:51200
  ds_read_b64_tr_b16 v[234:235], v7 offset:53760
  s_waitcnt lgkmcnt(10)
  v_mfma_f32_32x32x16_bf16 v[16:31], v[244:247], v[196:199], v[16:31]
  ds_read_b64_tr_b16 v[236:237], v7 offset:51456
  ds_read_b64_tr_b16 v[238:239], v7 offset:54016
  s_waitcnt lgkmcnt(10)
  v_mfma_f32_32x32x16_bf16 v[32:47], v[248:251], v[196:199], v[32:47]
  ds_read_b64_tr_b16 v[240:241], v7 offset:51712
  ds_read_b64_tr_b16 v[242:243], v7 offset:54272
  s_waitcnt lgkmcnt(10)
  v_mfma_f32_32x32x16_bf16 v[48:63], v[252:255], v[196:199], v[48:63]
  ds_read_b64_tr_b16 v[244:245], v7 offset:51968
  ds_read_b64_tr_b16 v[246:247], v7 offset:54528
  s_waitcnt lgkmcnt(10)
  v_mfma_f32_32x32x16_bf16 v[64:79], v[224:227], v[196:199], v[64:79]
  ds_read_b64_tr_b16 v[248:249], v7 offset:52224
  ds_read_b64_tr_b16 v[250:251], v7 offset:54784
  s_waitcnt lgkmcnt(10)
  v_mfma_f32_32x32x16_bf16 v[80:95], v[228:231], v[196:199], v[80:95]
  ds_read_b64_tr_b16 v[252:253], v7 offset:56320
  ds_read_b64_tr_b16 v[254:255], v7 offset:58880
  s_waitcnt lgkmcnt(10)
  v_mfma_f32_32x32x16_bf16 v[16:31], v[232:235], v[200:203], v[16:31]
  ds_read_b64_tr_b16 v[224:225], v7 offset:56576
  ds_read_b64_tr_b16 v[226:227], v7 offset:59136
  s_waitcnt lgkmcnt(10)
  v_mfma_f32_32x32x16_bf16 v[32:47], v[236:239], v[200:203], v[32:47]
  ds_read_b64_tr_b16 v[228:229], v7 offset:56832
  ds_read_b64_tr_b16 v[230:231], v7 offset:59392
  s_waitcnt lgkmcnt(10)
  v_mfma_f32_32x32x16_bf16 v[48:63], v[240:243], v[200:203], v[48:63]
  ds_read_b64_tr_b16 v[232:233], v7 offset:57088
  ds_read_b64_tr_b16 v[234:235], v7 offset:59648
  s_waitcnt lgkmcnt(10)
  v_mfma_f32_32x32x16_bf16 v[64:79], v[244:247], v[200:203], v[64:79]
  ds_read_b64_tr_b16 v[236:237], v7 offset:57344
  ds_read_b64_tr_b16 v[238:239], v7 offset:59904
  s_waitcnt lgkmcnt(10)
  v_mfma_f32_32x32x16_bf16 v[80:95], v[248:251], v[200:203], v[80:95]
  s_waitcnt vmcnt(0)
  s_barrier
  ds_read_b64_tr_b16 v[240:241], v9 offset:0
  ds_read_b64_tr_b16 v[242:243], v9 offset:2560
  s_waitcnt lgkmcnt(10)
  v_mfma_f32_32x32x16_bf16 v[16:31], v[252:255], v[204:207], v[16:31]
  ds_read_b64_tr_b16 v[244:245], v9 offset:256
  ds_read_b64_tr_b16 v[246:247], v9 offset:2816
  s_waitcnt lgkmcnt(10)
  v_mfma_f32_32x32x16_bf16 v[32:47], v[224:227], v[204:207], v[32:47]
  ds_read_b64_tr_b16 v[248:249], v9 offset:512
  ds_read_b64_tr_b16 v[250:251], v9 offset:3072
  s_waitcnt lgkmcnt(10)
  v_mfma_f32_32x32x16_bf16 v[48:63], v[228:231], v[204:207], v[48:63]
  ds_read_b64_tr_b16 v[252:253], v9 offset:768
  ds_read_b64_tr_b16 v[254:255], v9 offset:3328
  s_waitcnt lgkmcnt(10)
  v_mfma_f32_32x32x16_bf16 v[64:79], v[232:235], v[204:207], v[64:79]
  ds_read_b64_tr_b16 v[224:225], v9 offset:1024
  ds_read_b64_tr_b16 v[226:227], v9 offset:3584
  s_waitcnt lgkmcnt(10)
  v_mfma_f32_32x32x16_bf16 v[80:95], v[236:239], v[204:207], v[80:95]
  ds_read_b64_tr_b16 v[228:229], v9 offset:5120
  ds_read_b64_tr_b16 v[230:231], v9 offset:7680
  s_waitcnt lgkmcnt(10)
  v_mfma_f32_32x32x16_bf16 v[16:31], v[240:243], v[208:211], v[16:31]
  ds_read_b64_tr_b16 v[232:233], v9 offset:5376
  ds_read_b64_tr_b16 v[234:235], v9 offset:7936
  s_waitcnt lgkmcnt(10)
  v_mfma_f32_32x32x16_bf16 v[32:47], v[244:247], v[208:211], v[32:47]
  ds_read_b64_tr_b16 v[236:237], v9 offset:5632
  ds_read_b64_tr_b16 v[238:239], v9 offset:8192
  s_waitcnt lgkmcnt(10)
  v_mfma_f32_32x32x16_bf16 v[48:63], v[248:251], v[208:211], v[48:63]
  ds_read_b64_tr_b16 v[240:241], v9 offset:5888
  ds_read_b64_tr_b16 v[242:243], v9 offset:8448
  s_waitcnt lgkmcnt(10)
  v_mfma_f32_32x32x16_bf16 v[64:79], v[252:255], v[208:211], v[64:79]
  ds_read_b64_tr_b16 v[244:245], v9 offset:6144
  ds_read_b64_tr_b16 v[246:247], v9 offset:8704
  s_waitcnt lgkmcnt(10)
  v_mfma_f32_32x32x16_bf16 v[80:95], v[224:227], v[208:211], v[80:95]
  ds_read_b64_tr_b16 v[248:249], v9 offset:10240
  ds_read_b64_tr_b16 v[250:251], v9 offset:12800
  s_waitcnt lgkmcnt(10)
  v_mfma_f32_32x32x16_bf16 v[16:31], v[228:231], v[212:215], v[16:31]
  ds_read_b64_tr_b16 v[252:253], v9 offset:10496
  ds_read_b64_tr_b16 v[254:255], v9 offset:13056
  s_waitcnt lgkmcnt(10)
  v_mfma_f32_32x32x16_bf16 v[32:47], v[232:235], v[212:215], v[32:47]
  ds_read_b64_tr_b16 v[224:225], v9 offset:10752
  ds_read_b64_tr_b16 v[226:227], v9 offset:13312
  s_waitcnt lgkmcnt(10)
  v_mfma_f32_32x32x16_bf16 v[48:63], v[236:239], v[212:215], v[48:63]
  ds_read_b64_tr_b16 v[228:229], v9 offset:11008
  ds_read_b64_tr_b16 v[230:231], v9 offset:13568
  s_waitcnt lgkmcnt(10)
  v_mfma_f32_32x32x16_bf16 v[64:79], v[240:243], v[212:215], v[64:79]
  ds_read_b64_tr_b16 v[232:233], v9 offset:11264
  ds_read_b64_tr_b16 v[234:235], v9 offset:13824
  s_waitcnt lgkmcnt(10)
  v_mfma_f32_32x32x16_bf16 v[80:95], v[244:247], v[212:215], v[80:95]
  ds_read_b64_tr_b16 v[236:237], v9 offset:15360
  ds_read_b64_tr_b16 v[238:239], v9 offset:17920
  s_waitcnt lgkmcnt(10)
  v_mfma_f32_32x32x16_bf16 v[16:31], v[248:251], v[216:219], v[16:31]
  ds_read_b64_tr_b16 v[240:241], v9 offset:15616
  ds_read_b64_tr_b16 v[242:243], v9 offset:18176
  s_waitcnt lgkmcnt(10)
  v_mfma_f32_32x32x16_bf16 v[32:47], v[252:255], v[216:219], v[32:47]
  ds_read_b64_tr_b16 v[244:245], v9 offset:15872
  ds_read_b64_tr_b16 v[246:247], v9 offset:18432
  s_waitcnt lgkmcnt(10)
  v_mfma_f32_32x32x16_bf16 v[48:63], v[224:227], v[216:219], v[48:63]
  ds_read_b64_tr_b16 v[248:249], v9 offset:16128
  ds_read_b64_tr_b16 v[250:251], v9 offset:18688
  s_waitcnt lgkmcnt(10)
  v_mfma_f32_32x32x16_bf16 v[64:79], v[228:231], v[216:219], v[64:79]
  ds_read_b64_tr_b16 v[252:253], v9 offset:16384
  ds_read_b64_tr_b16 v[254:255], v9 offset:18944
  s_waitcnt lgkmcnt(10)
  v_mfma_f32_32x32x16_bf16 v[80:95], v[232:235], v[216:219], v[80:95]
  s_waitcnt lgkmcnt(8)
  v_mfma_f32_32x32x16_bf16 v[16:31], v[236:239], v[220:223], v[16:31]
  s_waitcnt lgkmcnt(6)
  v_mfma_f32_32x32x16_bf16 v[32:47], v[240:243], v[220:223], v[32:47]
  s_waitcnt lgkmcnt(4)
  v_mfma_f32_32x32x16_bf16 v[48:63], v[244:247], v[220:223], v[48:63]
  s_waitcnt lgkmcnt(2)
  v_mfma_f32_32x32x16_bf16 v[64:79], v[248:251], v[220:223], v[64:79]
  s_waitcnt lgkmcnt(0)
  v_mfma_f32_32x32x16_bf16 v[80:95], v[252:255], v[220:223], v[80:95]
  s_barrier
  s_mul_i32 s32, s24, 10240
  v_add_u32 v13, s32, v2
  s_xor_b32 s33, s24, 4
  s_mul_i32 s33, s33, 10240
  v_add_u32 v14, s33, v2
  s_cmp_eq_u32 s31, 1
  s_cbranch_scc1 kva_kernel_k1_40
  ds_write_b128 v13, v[56:59] offset:0
  ds_write_b128 v13, v[60:63] offset:1024
  ds_write_b128 v13, v[64:67] offset:2048
  ds_write_b128 v13, v[68:71] offset:3072
  ds_write_b128 v13, v[72:75] offset:4096
  ds_write_b128 v13, v[76:79] offset:5120
  ds_write_b128 v13, v[80:83] offset:6144
  ds_write_b128 v13, v[84:87] offset:7168
  ds_write_b128 v13, v[88:91] offset:8192
  ds_write_b128 v13, v[92:95] offset:9216
  s_waitcnt lgkmcnt(0)
  s_barrier
  ds_read_b128 v[96:99], v14 offset:0
  ds_read_b128 v[100:103], v14 offset:1024
  ds_read_b128 v[104:107], v14 offset:2048
  ds_read_b128 v[108:111], v14 offset:3072
  ds_read_b128 v[112:115], v14 offset:4096
  ds_read_b128 v[116:119], v14 offset:5120
  ds_read_b128 v[120:123], v14 offset:6144
  ds_read_b128 v[124:127], v14 offset:7168
  ds_read_b128 v[128:131], v14 offset:8192
  ds_read_b128 v[132:135], v14 offset:9216
  s_waitcnt lgkmcnt(9)
  v_add_f32 v16, v16, v96
  v_add_f32 v17, v17, v97
  v_add_f32 v18, v18, v98
  v_add_f32 v19, v19, v99
  v_cvt_pk_bf16_f32 v224, v16, v17
  v_cvt_pk_bf16_f32 v225, v18, v19
  s_waitcnt lgkmcnt(8)
  v_add_f32 v20, v20, v100
  v_add_f32 v21, v21, v101
  v_add_f32 v22, v22, v102
  v_add_f32 v23, v23, v103
  v_cvt_pk_bf16_f32 v226, v20, v21
  v_cvt_pk_bf16_f32 v227, v22, v23
  s_nop 0
  v_permlane32_swap_b32 v224, v226
  v_permlane32_swap_b32 v225, v227
  buffer_store_dwordx4 v[224:227], v10, s[12:15], s37 offen offset:0 sc1
  s_waitcnt lgkmcnt(7)
  v_add_f32 v24, v24, v104
  v_add_f32 v25, v25, v105
  v_add_f32 v26, v26, v106
  v_add_f32 v27, v27, v107
  v_cvt_pk_bf16_f32 v228, v24, v25
  v_cvt_pk_bf16_f32 v229, v26, v27
  s_waitcnt lgkmcnt(6)
  v_add_f32 v28, v28, v108
  v_add_f32 v29, v29, v109
  v_add_f32 v30, v30, v110
  v_add_f32 v31, v31, v111
  v_cvt_pk_bf16_f32 v230, v28, v29
  v_cvt_pk_bf16_f32 v231, v30, v31
  s_nop 0
  v_permlane32_swap_b32 v228, v230
  v_permlane32_swap_b32 v229, v231
  buffer_store_dwordx4 v[228:231], v10, s[12:15], s37 offen offset:128 sc1
  s_waitcnt lgkmcnt(5)
  v_add_f32 v32, v32, v112
  v_add_f32 v33, v33, v113
  v_add_f32 v34, v34, v114
  v_add_f32 v35, v35, v115
  v_cvt_pk_bf16_f32 v232, v32, v33
  v_cvt_pk_bf16_f32 v233, v34, v35
  s_waitcnt lgkmcnt(4)
  v_add_f32 v36, v36, v116
  v_add_f32 v37, v37, v117
  v_add_f32 v38, v38, v118
  v_add_f32 v39, v39, v119
  v_cvt_pk_bf16_f32 v234, v36, v37
  v_cvt_pk_bf16_f32 v235, v38, v39
  s_nop 0
  v_permlane32_swap_b32 v232, v234
  v_permlane32_swap_b32 v233, v235
  buffer_store_dwordx4 v[232:235], v10, s[12:15], s37 offen offset:256 sc1
  s_waitcnt lgkmcnt(3)
  v_add_f32 v40, v40, v120
  v_add_f32 v41, v41, v121
  v_add_f32 v42, v42, v122
  v_add_f32 v43, v43, v123
  v_cvt_pk_bf16_f32 v236, v40, v41
  v_cvt_pk_bf16_f32 v237, v42, v43
  s_waitcnt lgkmcnt(2)
  v_add_f32 v44, v44, v124
  v_add_f32 v45, v45, v125
  v_add_f32 v46, v46, v126
  v_add_f32 v47, v47, v127
  v_cvt_pk_bf16_f32 v238, v44, v45
  v_cvt_pk_bf16_f32 v239, v46, v47
  s_nop 0
  v_permlane32_swap_b32 v236, v238
  v_permlane32_swap_b32 v237, v239
  buffer_store_dwordx4 v[236:239], v10, s[12:15], s37 offen offset:384 sc1
  s_waitcnt lgkmcnt(1)
  v_add_f32 v48, v48, v128
  v_add_f32 v49, v49, v129
  v_add_f32 v50, v50, v130
  v_add_f32 v51, v51, v131
  v_cvt_pk_bf16_f32 v240, v48, v49
  v_cvt_pk_bf16_f32 v241, v50, v51
  s_waitcnt lgkmcnt(0)
  v_add_f32 v52, v52, v132
  v_add_f32 v53, v53, v133
  v_add_f32 v54, v54, v134
  v_add_f32 v55, v55, v135
  v_cvt_pk_bf16_f32 v242, v52, v53
  v_cvt_pk_bf16_f32 v243, v54, v55
  s_nop 0
  v_permlane32_swap_b32 v240, v242
  v_permlane32_swap_b32 v241, v243
  buffer_store_dwordx4 v[240:243], v10, s[12:15], s37 offen offset:512 sc1
  s_branch kva_kernel_e_41
kva_kernel_k1_40:
  ds_write_b128 v13, v[16:19] offset:0
  ds_write_b128 v13, v[20:23] offset:1024
  ds_write_b128 v13, v[24:27] offset:2048
  ds_write_b128 v13, v[28:31] offset:3072
  ds_write_b128 v13, v[32:35] offset:4096
  ds_write_b128 v13, v[36:39] offset:5120
  ds_write_b128 v13, v[40:43] offset:6144
  ds_write_b128 v13, v[44:47] offset:7168
  ds_write_b128 v13, v[48:51] offset:8192
  ds_write_b128 v13, v[52:55] offset:9216
  s_waitcnt lgkmcnt(0)
  s_barrier
  ds_read_b128 v[96:99], v14 offset:0
  ds_read_b128 v[100:103], v14 offset:1024
  ds_read_b128 v[104:107], v14 offset:2048
  ds_read_b128 v[108:111], v14 offset:3072
  ds_read_b128 v[112:115], v14 offset:4096
  ds_read_b128 v[116:119], v14 offset:5120
  ds_read_b128 v[120:123], v14 offset:6144
  ds_read_b128 v[124:127], v14 offset:7168
  ds_read_b128 v[128:131], v14 offset:8192
  ds_read_b128 v[132:135], v14 offset:9216
  s_waitcnt lgkmcnt(9)
  v_add_f32 v56, v56, v96
  v_add_f32 v57, v57, v97
  v_add_f32 v58, v58, v98
  v_add_f32 v59, v59, v99
  v_cvt_pk_bf16_f32 v224, v56, v57
  v_cvt_pk_bf16_f32 v225, v58, v59
  s_waitcnt lgkmcnt(8)
  v_add_f32 v60, v60, v100
  v_add_f32 v61, v61, v101
  v_add_f32 v62, v62, v102
  v_add_f32 v63, v63, v103
  v_cvt_pk_bf16_f32 v226, v60, v61
  v_cvt_pk_bf16_f32 v227, v62, v63
  s_nop 0
  v_permlane32_swap_b32 v224, v226
  v_permlane32_swap_b32 v225, v227
  buffer_store_dwordx4 v[224:227], v10, s[12:15], s37 offen offset:640 sc1
  s_waitcnt lgkmcnt(7)
  v_add_f32 v64, v64, v104
  v_add_f32 v65, v65, v105
  v_add_f32 v66, v66, v106
  v_add_f32 v67, v67, v107
  v_cvt_pk_bf16_f32 v228, v64, v65
  v_cvt_pk_bf16_f32 v229, v66, v67
  s_waitcnt lgkmcnt(6)
  v_add_f32 v68, v68, v108
  v_add_f32 v69, v69, v109
  v_add_f32 v70, v70, v110
  v_add_f32 v71, v71, v111
  v_cvt_pk_bf16_f32 v230, v68, v69
  v_cvt_pk_bf16_f32 v231, v70, v71
  s_nop 0
  v_permlane32_swap_b32 v228, v230
  v_permlane32_swap_b32 v229, v231
  buffer_store_dwordx4 v[228:231], v10, s[12:15], s37 offen offset:768 sc1
  s_waitcnt lgkmcnt(5)
  v_add_f32 v72, v72, v112
  v_add_f32 v73, v73, v113
  v_add_f32 v74, v74, v114
  v_add_f32 v75, v75, v115
  v_cvt_pk_bf16_f32 v232, v72, v73
  v_cvt_pk_bf16_f32 v233, v74, v75
  s_waitcnt lgkmcnt(4)
  v_add_f32 v76, v76, v116
  v_add_f32 v77, v77, v117
  v_add_f32 v78, v78, v118
  v_add_f32 v79, v79, v119
  v_cvt_pk_bf16_f32 v234, v76, v77
  v_cvt_pk_bf16_f32 v235, v78, v79
  s_nop 0
  v_permlane32_swap_b32 v232, v234
  v_permlane32_swap_b32 v233, v235
  buffer_store_dwordx4 v[232:235], v10, s[12:15], s37 offen offset:896 sc1
  s_waitcnt lgkmcnt(3)
  v_add_f32 v80, v80, v120
  v_add_f32 v81, v81, v121
  v_add_f32 v82, v82, v122
  v_add_f32 v83, v83, v123
  v_cvt_pk_bf16_f32 v236, v80, v81
  v_cvt_pk_bf16_f32 v237, v82, v83
  s_waitcnt lgkmcnt(2)
  v_add_f32 v84, v84, v124
  v_add_f32 v85, v85, v125
  v_add_f32 v86, v86, v126
  v_add_f32 v87, v87, v127
  v_cvt_pk_bf16_f32 v238, v84, v85
  v_cvt_pk_bf16_f32 v239, v86, v87
  s_nop 0
  v_permlane32_swap_b32 v236, v238
  v_permlane32_swap_b32 v237, v239
  buffer_store_dwordx4 v[236:239], v10, s[12:15], s37 offen offset:1024 sc1
  s_waitcnt lgkmcnt(1)
  v_add_f32 v88, v88, v128
  v_add_f32 v89, v89, v129
  v_add_f32 v90, v90, v130
  v_add_f32 v91, v91, v131
  v_cvt_pk_bf16_f32 v240, v88, v89
  v_cvt_pk_bf16_f32 v241, v90, v91
  s_waitcnt lgkmcnt(0)
  v_add_f32 v92, v92, v132
  v_add_f32 v93, v93, v133
  v_add_f32 v94, v94, v134
  v_add_f32 v95, v95, v135
  v_cvt_pk_bf16_f32 v242, v92, v93
  v_cvt_pk_bf16_f32 v243, v94, v95
  s_nop 0
  v_permlane32_swap_b32 v240, v242
  v_permlane32_swap_b32 v241, v243
  buffer_store_dwordx4 v[240:243], v10, s[12:15], s37 offen offset:1152 sc1
kva_kernel_e_41:
  s_nop 4
  s_lshl_b32 s32, s2, 9
  s_lshl_b32 s33, s24, 6
  s_add_u32 s32, s32, s33
  s_cmp_ge_u32 s2, 128
  s_cselect_b32 s33, -1, 0
  v_mov_b32 v15, s33
  v_lshlrev_b32 v16, 2, v0
  v_cmp_gt_u32 vcc, 16, v0
  s_and_saveexec_b64 s[40:41], vcc
  buffer_store_dword v15, v16, s[16:19], s32 offen
  s_mov_b64 exec, s[40:41]
  s_endpgm
kva_kernel_spin_18:
  s_nop 15
  s_mov_b32 s75, 262144
kva_kernel_sp_42:
  s_sleep 2
  buffer_load_dword v17, v18, s[68:71], 0 offen sc1
  s_waitcnt vmcnt(0)
  v_and_b32 v17, v17, v20
  v_cmp_ne_u32 vcc, v17, v20
  s_cbranch_vccz kva_kernel_kok_17
  s_sub_u32 s75, s75, 1
  s_cmp_lg_u32 s75, 0
  s_cbranch_scc1 kva_kernel_sp_42
  s_branch kva_kernel_kok_17
kva_kernel_sp_20:
  s_nop 15
  s_bitcmp1_b32 s36, s32
  s_cbranch_scc0 kva_kernel_sp1_43
  s_cmp_eq_u32 s32, 16
  s_cselect_b32 s38, s44, 0
  v_subrev_u32 v242, s38, v8
  v_cmp_gt_i32_e64 s[48:49], 0, v242
  v_cmp_gt_i32_e64 s[50:51], 1, v242
  v_cmp_gt_i32_e64 s[52:53], 2, v242
  v_cmp_gt_i32_e64 s[54:55], 3, v242
  v_cndmask_b32_e64 v112, v112, v11, s[48:49]
  v_cmp_gt_i32_e64 s[48:49], 8, v242
  v_cndmask_b32_e64 v113, v113, v11, s[50:51]
  v_cmp_gt_i32_e64 s[50:51], 9, v242
  v_cndmask_b32_e64 v114, v114, v11, s[52:53]
  v_cmp_gt_i32_e64 s[52:53], 10, v242
  v_cndmask_b32_e64 v115, v115, v11, s[54:55]
  v_cmp_gt_i32_e64 s[54:55], 11, v242
  v_cndmask_b32_e64 v116, v116, v11, s[48:49]
  v_cmp_gt_i32_e64 s[48:49], 16, v242
  v_cndmask_b32_e64 v117, v117, v11, s[50:51]
  v_cmp_gt_i32_e64 s[50:51], 17, v242
  v_cndmask_b32_e64 v118, v118, v11, s[52:53]
  v_cmp_gt_i32_e64 s[52:53], 18, v242
  v_cndmask_b32_e64 v119, v119, v11, s[54:55]
  v_cmp_gt_i32_e64 s[54:55], 19, v242
  v_cndmask_b32_e64 v120, v120, v11, s[48:49]
  v_cmp_gt_i32_e64 s[48:49], 24, v242
  v_cndmask_b32_e64 v121, v121, v11, s[50:51]
  v_cmp_gt_i32_e64 s[50:51], 25, v242
  v_cndmask_b32_e64 v122, v122, v11, s[52:53]
  v_cmp_gt_i32_e64 s[52:53], 26, v242
  v_cndmask_b32_e64 v123, v123, v11, s[54:55]
  v_cmp_gt_i32_e64 s[54:55], 27, v242
  v_cndmask_b32_e64 v124, v124, v11, s[48:49]
  v_cmp_gt_i32_e64 s[48:49], 32, v242
  v_cndmask_b32_e64 v125, v125, v11, s[50:51]
  v_cmp_gt_i32_e64 s[50:51], 33, v242
  v_cndmask_b32_e64 v126, v126, v11, s[52:53]
  v_cmp_gt_i32_e64 s[52:53], 34, v242
  v_cndmask_b32_e64 v127, v127, v11, s[54:55]
  v_cmp_gt_i32_e64 s[54:55], 35, v242
  v_cndmask_b32_e64 v128, v128, v11, s[48:49]
  v_cmp_gt_i32_e64 s[48:49], 40, v242
  v_cndmask_b32_e64 v129, v129, v11, s[50:51]
  v_cmp_gt_i32_e64 s[50:51], 41, v242
  v_cndmask_b32_e64 v130, v130, v11, s[52:53]
  v_cmp_gt_i32_e64 s[52:53], 42, v242
  v_cndmask_b32_e64 v131, v131, v11, s[54:55]
  v_cmp_gt_i32_e64 s[54:55], 43, v242
  v_cndmask_b32_e64 v132, v132, v11, s[48:49]
  v_cmp_gt_i32_e64 s[48:49], 48, v242
  v_cndmask_b32_e64 v133, v133, v11, s[50:51]
  v_cmp_gt_i32_e64 s[50:51], 49, v242
  v_cndmask_b32_e64 v134, v134, v11, s[52:53]
  v_cmp_gt_i32_e64 s[52:53], 50, v242
  v_cndmask_b32_e64 v135, v135, v11, s[54:55]
  v_cmp_gt_i32_e64 s[54:55], 51, v242
  v_cndmask_b32_e64 v136, v136, v11, s[48:49]
  v_cmp_gt_i32_e64 s[48:49], 56, v242
  v_cndmask_b32_e64 v137, v137, v11, s[50:51]
  v_cmp_gt_i32_e64 s[50:51], 57, v242
  v_cndmask_b32_e64 v138, v138, v11, s[52:53]
  v_cmp_gt_i32_e64 s[52:53], 58, v242
  v_cndmask_b32_e64 v139, v139, v11, s[54:55]
  v_cmp_gt_i32_e64 s[54:55], 59, v242
  v_cndmask_b32_e64 v140, v140, v11, s[48:49]
  v_cndmask_b32_e64 v141, v141, v11, s[50:51]
  v_cndmask_b32_e64 v142, v142, v11, s[52:53]
  v_cndmask_b32_e64 v143, v143, v11, s[54:55]
kva_kernel_sp1_43:
  s_branch kva_kernel_spb_21
kva_kernel_r2_23:
  s_nop 15
  v_max3_f32 v240, v112, v113, v114
  v_max3_f32 v241, v115, v116, v117
  v_max3_f32 v240, v240, v118, v119
  v_max3_f32 v241, v241, v120, v121
  v_max3_f32 v240, v240, v122, v123
  v_max3_f32 v241, v241, v124, v125
  v_max3_f32 v240, v240, v126, v127
  v_max3_f32 v241, v241, v128, v129
  v_max3_f32 v240, v240, v130, v131
  v_max3_f32 v241, v241, v132, v133
  v_max3_f32 v240, v240, v134, v135
  v_max3_f32 v241, v241, v136, v137
  v_max3_f32 v240, v240, v138, v139
  v_max3_f32 v241, v241, v140, v141
  v_max3_f32 v240, v240, v142, v143
  v_max_f32 v240, v240, v241
  v_mov_b32 v241, v240
  s_nop 1
  v_permlane32_swap_b32 v240, v241
  v_max_f32 v240, v240, v241
  v_max_f32 v240, 0, v240
  v_exp_f32 v241, -v240
  v_sub_f32 v112, v112, v240
  v_sub_f32 v113, v113, v240
  v_sub_f32 v114, v114, v240
  v_sub_f32 v115, v115, v240
  v_sub_f32 v116, v116, v240
  v_sub_f32 v117, v117, v240
  v_sub_f32 v118, v118, v240
  v_sub_f32 v119, v119, v240
  v_sub_f32 v120, v120, v240
  v_sub_f32 v121, v121, v240
  v_sub_f32 v122, v122, v240
  v_sub_f32 v123, v123, v240
  v_sub_f32 v124, v124, v240
  v_sub_f32 v125, v125, v240
  v_sub_f32 v126, v126, v240
  v_sub_f32 v127, v127, v240
  v_sub_f32 v128, v128, v240
  v_sub_f32 v129, v129, v240
  v_sub_f32 v130, v130, v240
  v_sub_f32 v131, v131, v240
  v_sub_f32 v132, v132, v240
  v_sub_f32 v133, v133, v240
  v_sub_f32 v134, v134, v240
  v_sub_f32 v135, v135, v240
  v_sub_f32 v136, v136, v240
  v_sub_f32 v137, v137, v240
  v_sub_f32 v138, v138, v240
  v_sub_f32 v139, v139, v240
  v_sub_f32 v140, v140, v240
  v_sub_f32 v141, v141, v240
  v_sub_f32 v142, v142, v240
  v_sub_f32 v143, v143, v240
  v_sub_f32 v144, v144, v240
  v_sub_f32 v145, v145, v240
  v_sub_f32 v146, v146, v240
  v_sub_f32 v147, v147, v240
  v_sub_f32 v148, v148, v240
  v_sub_f32 v149, v149, v240
  v_sub_f32 v150, v150, v240
  v_sub_f32 v151, v151, v240
  v_sub_f32 v152, v152, v240
  v_sub_f32 v153, v153, v240
  v_sub_f32 v154, v154, v240
  v_sub_f32 v155, v155, v240
  v_sub_f32 v156, v156, v240
  v_sub_f32 v157, v157, v240
  v_sub_f32 v158, v158, v240
  v_sub_f32 v159, v159, v240
  v_sub_f32 v160, v160, v240
  v_sub_f32 v161, v161, v240
  v_sub_f32 v162, v162, v240
  v_sub_f32 v163, v163, v240
  v_sub_f32 v164, v164, v240
  v_sub_f32 v165, v165, v240
  v_sub_f32 v166, v166, v240
  v_sub_f32 v167, v167, v240
  v_sub_f32 v168, v168, v240
  v_sub_f32 v169, v169, v240
  v_sub_f32 v170, v170, v240
  v_sub_f32 v171, v171, v240
  v_sub_f32 v172, v172, v240
  v_sub_f32 v173, v173, v240
  v_sub_f32 v174, v174, v240
  v_sub_f32 v175, v175, v240
  v_sub_f32 v192, v192, v240
  v_sub_f32 v193, v193, v240
  v_sub_f32 v194, v194, v240
  v_sub_f32 v195, v195, v240
  v_sub_f32 v196, v196, v240
  v_sub_f32 v197, v197, v240
  v_sub_f32 v198, v198, v240
  v_sub_f32 v199, v199, v240
  v_sub_f32 v200, v200, v240
  v_sub_f32 v201, v201, v240
  v_sub_f32 v202, v202, v240
  v_sub_f32 v203, v203, v240
  v_sub_f32 v204, v204, v240
  v_sub_f32 v205, v205, v240
  v_sub_f32 v206, v206, v240
  v_sub_f32 v207, v207, v240
  v_mul_f32 v48, v48, v241
  v_mul_f32 v49, v49, v241
  v_mul_f32 v50, v50, v241
  v_mul_f32 v51, v51, v241
  v_mul_f32 v52, v52, v241
  v_mul_f32 v53, v53, v241
  v_mul_f32 v54, v54, v241
  v_mul_f32 v55, v55, v241
  v_mul_f32 v56, v56, v241
  v_mul_f32 v57, v57, v241
  v_mul_f32 v58, v58, v241
  v_mul_f32 v59, v59, v241
  v_mul_f32 v60, v60, v241
  v_mul_f32 v61, v61, v241
  v_mul_f32 v62, v62, v241
  v_mul_f32 v63, v63, v241
  v_mul_f32 v64, v64, v241
  v_mul_f32 v65, v65, v241
  v_mul_f32 v66, v66, v241
  v_mul_f32 v67, v67, v241
  v_mul_f32 v68, v68, v241
  v_mul_f32 v69, v69, v241
  v_mul_f32 v70, v70, v241
  v_mul_f32 v71, v71, v241
  v_mul_f32 v72, v72, v241
  v_mul_f32 v73, v73, v241
  v_mul_f32 v74, v74, v241
  v_mul_f32 v75, v75, v241
  v_mul_f32 v76, v76, v241
  v_mul_f32 v77, v77, v241
  v_mul_f32 v78, v78, v241
  v_mul_f32 v79, v79, v241
  v_mul_f32 v80, v80, v241
  v_mul_f32 v81, v81, v241
  v_mul_f32 v82, v82, v241
  v_mul_f32 v83, v83, v241
  v_mul_f32 v84, v84, v241
  v_mul_f32 v85, v85, v241
  v_mul_f32 v86, v86, v241
  v_mul_f32 v87, v87, v241
  v_mul_f32 v88, v88, v241
  v_mul_f32 v89, v89, v241
  v_mul_f32 v90, v90, v241
  v_mul_f32 v91, v91, v241
  v_mul_f32 v92, v92, v241
  v_mul_f32 v93, v93, v241
  v_mul_f32 v94, v94, v241
  v_mul_f32 v95, v95, v241
  v_mul_f32 v96, v96, v241
  v_mul_f32 v97, v97, v241
  v_mul_f32 v98, v98, v241
  v_mul_f32 v99, v99, v241
  v_mul_f32 v100, v100, v241
  v_mul_f32 v101, v101, v241
  v_mul_f32 v102, v102, v241
  v_mul_f32 v103, v103, v241
  v_mul_f32 v104, v104, v241
  v_mul_f32 v105, v105, v241
  v_mul_f32 v106, v106, v241
  v_mul_f32 v107, v107, v241
  v_mul_f32 v108, v108, v241
  v_mul_f32 v109, v109, v241
  v_mul_f32 v110, v110, v241
  v_mul_f32 v111, v111, v241
  v_mul_f32 v9, v9, v241
  v_exp_f32 v232, v112
  v_exp_f32 v233, v113
  v_exp_f32 v234, v114
  v_add_f32 v10, v232, v233
  v_cvt_pk_bf16_f32 v208, v232, v233
  v_exp_f32 v235, v115
  v_add_f32 v10, v10, v234
  v_exp_f32 v236, v116
  v_add_f32 v10, v10, v235
  v_cvt_pk_bf16_f32 v209, v234, v235
  v_exp_f32 v237, v117
  v_add_f32 v10, v10, v236
  v_exp_f32 v238, v118
  v_add_f32 v10, v10, v237
  v_cvt_pk_bf16_f32 v210, v236, v237
  v_exp_f32 v239, v119
  v_add_f32 v10, v10, v238
  v_exp_f32 v232, v120
  v_add_f32 v10, v10, v239
  v_cvt_pk_bf16_f32 v211, v238, v239
  v_exp_f32 v233, v121
  v_add_f32 v10, v10, v232
  v_exp_f32 v234, v122
  v_add_f32 v10, v10, v233
  v_cvt_pk_bf16_f32 v212, v232, v233
  v_exp_f32 v235, v123
  v_add_f32 v10, v10, v234
  v_exp_f32 v236, v124
  v_add_f32 v10, v10, v235
  v_cvt_pk_bf16_f32 v213, v234, v235
  v_exp_f32 v237, v125
  v_add_f32 v10, v10, v236
  v_exp_f32 v238, v126
  v_add_f32 v10, v10, v237
  v_cvt_pk_bf16_f32 v214, v236, v237
  v_exp_f32 v239, v127
  v_add_f32 v10, v10, v238
  v_add_f32 v10, v10, v239
  v_cvt_pk_bf16_f32 v215, v238, v239
  v_exp_f32 v232, v128
  v_exp_f32 v233, v129
  v_add_f32 v10, v10, v232
  v_exp_f32 v234, v130
  v_add_f32 v10, v10, v233
  v_cvt_pk_bf16_f32 v224, v232, v233
  v_exp_f32 v235, v131
  v_add_f32 v10, v10, v234
  v_exp_f32 v236, v132
  v_add_f32 v10, v10, v235
  v_cvt_pk_bf16_f32 v225, v234, v235
  v_exp_f32 v237, v133
  v_add_f32 v10, v10, v236
  v_exp_f32 v238, v134
  v_add_f32 v10, v10, v237
  v_cvt_pk_bf16_f32 v226, v236, v237
  v_exp_f32 v239, v135
  v_add_f32 v10, v10, v238
  v_exp_f32 v232, v136
  v_add_f32 v10, v10, v239
  v_cvt_pk_bf16_f32 v227, v238, v239
  v_exp_f32 v233, v137
  v_add_f32 v10, v10, v232
  v_exp_f32 v234, v138
  v_add_f32 v10, v10, v233
  v_cvt_pk_bf16_f32 v228, v232, v233
  v_exp_f32 v235, v139
  v_add_f32 v10, v10, v234
  v_exp_f32 v236, v140
  v_add_f32 v10, v10, v235
  v_cvt_pk_bf16_f32 v229, v234, v235
  v_exp_f32 v237, v141
  v_add_f32 v10, v10, v236
  v_exp_f32 v238, v142
  v_add_f32 v10, v10, v237
  v_cvt_pk_bf16_f32 v230, v236, v237
  v_exp_f32 v239, v143
  v_add_f32 v10, v10, v238
  v_add_f32 v10, v10, v239
  v_cvt_pk_bf16_f32 v231, v238, v239
  s_branch kva_kernel_r2b_24
kva_kernel_sp_25:
  s_nop 15
  s_bitcmp1_b32 s36, s32
  s_cbranch_scc0 kva_kernel_sp1_44
  v_subrev_u32 v242, 64, v8
  v_cmp_gt_i32_e64 s[48:49], 0, v242
  v_cmp_gt_i32_e64 s[50:51], 1, v242
  v_cmp_gt_i32_e64 s[52:53], 2, v242
  v_cmp_gt_i32_e64 s[54:55], 3, v242
  v_cndmask_b32_e64 v144, v144, v11, s[48:49]
  v_cmp_gt_i32_e64 s[48:49], 8, v242
  v_cndmask_b32_e64 v145, v145, v11, s[50:51]
  v_cmp_gt_i32_e64 s[50:51], 9, v242
  v_cndmask_b32_e64 v146, v146, v11, s[52:53]
  v_cmp_gt_i32_e64 s[52:53], 10, v242
  v_cndmask_b32_e64 v147, v147, v11, s[54:55]
  v_cmp_gt_i32_e64 s[54:55], 11, v242
  v_cndmask_b32_e64 v148, v148, v11, s[48:49]
  v_cmp_gt_i32_e64 s[48:49], 16, v242
  v_cndmask_b32_e64 v149, v149, v11, s[50:51]
  v_cmp_gt_i32_e64 s[50:51], 17, v242
  v_cndmask_b32_e64 v150, v150, v11, s[52:53]
  v_cmp_gt_i32_e64 s[52:53], 18, v242
  v_cndmask_b32_e64 v151, v151, v11, s[54:55]
  v_cmp_gt_i32_e64 s[54:55], 19, v242
  v_cndmask_b32_e64 v152, v152, v11, s[48:49]
  v_cmp_gt_i32_e64 s[48:49], 24, v242
  v_cndmask_b32_e64 v153, v153, v11, s[50:51]
  v_cmp_gt_i32_e64 s[50:51], 25, v242
  v_cndmask_b32_e64 v154, v154, v11, s[52:53]
  v_cmp_gt_i32_e64 s[52:53], 26, v242
  v_cndmask_b32_e64 v155, v155, v11, s[54:55]
  v_cmp_gt_i32_e64 s[54:55], 27, v242
  v_cndmask_b32_e64 v156, v156, v11, s[48:49]
  v_cmp_gt_i32_e64 s[48:49], 32, v242
  v_cndmask_b32_e64 v157, v157, v11, s[50:51]
  v_cmp_gt_i32_e64 s[50:51], 33, v242
  v_cndmask_b32_e64 v158, v158, v11, s[52:53]
  v_cmp_gt_i32_e64 s[52:53], 34, v242
  v_cndmask_b32_e64 v159, v159, v11, s[54:55]
  v_cmp_gt_i32_e64 s[54:55], 35, v242
  v_cndmask_b32_e64 v160, v160, v11, s[48:49]
  v_cmp_gt_i32_e64 s[48:49], 40, v242
  v_cndmask_b32_e64 v161, v161, v11, s[50:51]
  v_cmp_gt_i32_e64 s[50:51], 41, v242
  v_cndmask_b32_e64 v162, v162, v11, s[52:53]
  v_cmp_gt_i32_e64 s[52:53], 42, v242
  v_cndmask_b32_e64 v163, v163, v11, s[54:55]
  v_cmp_gt_i32_e64 s[54:55], 43, v242
  v_cndmask_b32_e64 v164, v164, v11, s[48:49]
  v_cmp_gt_i32_e64 s[48:49], 48, v242
  v_cndmask_b32_e64 v165, v165, v11, s[50:51]
  v_cmp_gt_i32_e64 s[50:51], 49, v242
  v_cndmask_b32_e64 v166, v166, v11, s[52:53]
  v_cmp_gt_i32_e64 s[52:53], 50, v242
  v_cndmask_b32_e64 v167, v167, v11, s[54:55]
  v_cmp_gt_i32_e64 s[54:55], 51, v242
  v_cndmask_b32_e64 v168, v168, v11, s[48:49]
  v_cmp_gt_i32_e64 s[48:49], 56, v242
  v_cndmask_b32_e64 v169, v169, v11, s[50:51]
  v_cmp_gt_i32_e64 s[50:51], 57, v242
  v_cndmask_b32_e64 v170, v170, v11, s[52:53]
  v_cmp_gt_i32_e64 s[52:53], 58, v242
  v_cndmask_b32_e64 v171, v171, v11, s[54:55]
  v_cmp_gt_i32_e64 s[54:55], 59, v242
  v_cndmask_b32_e64 v172, v172, v11, s[48:49]
  v_cndmask_b32_e64 v173, v173, v11, s[50:51]
  v_cndmask_b32_e64 v174, v174, v11, s[52:53]
  v_cndmask_b32_e64 v175, v175, v11, s[54:55]
kva_kernel_sp1_44:
  s_cmp_eq_u32 s58, s32
  s_cselect_b64 exec, 1, 0
  buffer_store_dword v11, off, s[8:11], s59 sc1
  s_mov_b64 exec, -1
  s_cmp_lg_u32 s32, s42
  s_cbranch_scc1 kva_kernel_spb_26
  s_lshl_b32 s38, s28, 13
  s_add_u32 s38, s38, 0x20000
  v_add_u32 v244, s38, v2
  ds_read_b128 v[16:19], v244 offset:0
  ds_read_b128 v[20:23], v244 offset:1024
  ds_read_b128 v[24:27], v244 offset:2048
  ds_read_b128 v[28:31], v244 offset:3072
  ds_read_b128 v[32:35], v244 offset:4096
  ds_read_b128 v[36:39], v244 offset:5120
  ds_read_b128 v[40:43], v244 offset:6144
  ds_read_b128 v[44:47], v244 offset:7168
  v_mov_b32 v192, 0
  v_mov_b32 v193, 0
  v_mov_b32 v194, 0
  v_mov_b32 v195, 0
  v_mov_b32 v196, 0
  v_mov_b32 v197, 0
  v_mov_b32 v198, 0
  v_mov_b32 v199, 0
  v_mov_b32 v200, 0
  v_mov_b32 v201, 0
  v_mov_b32 v202, 0
  v_mov_b32 v203, 0
  v_mov_b32 v204, 0
  v_mov_b32 v205, 0
  v_mov_b32 v206, 0
  v_mov_b32 v207, 0
  s_waitcnt lgkmcnt(0)
  s_branch kva_kernel_spb_26
kva_kernel_r2_27:
  s_nop 15
  v_max3_f32 v240, v144, v145, v146
  v_max3_f32 v241, v147, v148, v149
  v_max3_f32 v240, v240, v150, v151
  v_max3_f32 v241, v241, v152, v153
  v_max3_f32 v240, v240, v154, v155
  v_max3_f32 v241, v241, v156, v157
  v_max3_f32 v240, v240, v158, v159
  v_max3_f32 v241, v241, v160, v161
  v_max3_f32 v240, v240, v162, v163
  v_max3_f32 v241, v241, v164, v165
  v_max3_f32 v240, v240, v166, v167
  v_max3_f32 v241, v241, v168, v169
  v_max3_f32 v240, v240, v170, v171
  v_max3_f32 v241, v241, v172, v173
  v_max3_f32 v240, v240, v174, v175
  v_max_f32 v240, v240, v241
  v_mov_b32 v241, v240
  s_nop 1
  v_permlane32_swap_b32 v240, v241
  v_max_f32 v240, v240, v241
  v_max_f32 v240, 0, v240
  v_exp_f32 v241, -v240
  v_sub_f32 v144, v144, v240
  v_sub_f32 v145, v145, v240
  v_sub_f32 v146, v146, v240
  v_sub_f32 v147, v147, v240
  v_sub_f32 v148, v148, v240
  v_sub_f32 v149, v149, v240
  v_sub_f32 v150, v150, v240
  v_sub_f32 v151, v151, v240
  v_sub_f32 v152, v152, v240
  v_sub_f32 v153, v153, v240
  v_sub_f32 v154, v154, v240
  v_sub_f32 v155, v155, v240
  v_sub_f32 v156, v156, v240
  v_sub_f32 v157, v157, v240
  v_sub_f32 v158, v158, v240
  v_sub_f32 v159, v159, v240
  v_sub_f32 v160, v160, v240
  v_sub_f32 v161, v161, v240
  v_sub_f32 v162, v162, v240
  v_sub_f32 v163, v163, v240
  v_sub_f32 v164, v164, v240
  v_sub_f32 v165, v165, v240
  v_sub_f32 v166, v166, v240
  v_sub_f32 v167, v167, v240
  v_sub_f32 v168, v168, v240
  v_sub_f32 v169, v169, v240
  v_sub_f32 v170, v170, v240
  v_sub_f32 v171, v171, v240
  v_sub_f32 v172, v172, v240
  v_sub_f32 v173, v173, v240
  v_sub_f32 v174, v174, v240
  v_sub_f32 v175, v175, v240
  v_sub_f32 v112, v112, v240
  v_sub_f32 v113, v113, v240
  v_sub_f32 v114, v114, v240
  v_sub_f32 v115, v115, v240
  v_sub_f32 v116, v116, v240
  v_sub_f32 v117, v117, v240
  v_sub_f32 v118, v118, v240
  v_sub_f32 v119, v119, v240
  v_sub_f32 v120, v120, v240
  v_sub_f32 v121, v121, v240
  v_sub_f32 v122, v122, v240
  v_sub_f32 v123, v123, v240
  v_sub_f32 v124, v124, v240
  v_sub_f32 v125, v125, v240
  v_sub_f32 v126, v126, v240
  v_sub_f32 v127, v127, v240
  v_sub_f32 v128, v128, v240
  v_sub_f32 v129, v129, v240
  v_sub_f32 v130, v130, v240
  v_sub_f32 v131, v131, v240
  v_sub_f32 v132, v132, v240
  v_sub_f32 v133, v133, v240
  v_sub_f32 v134, v134, v240
  v_sub_f32 v135, v135, v240
  v_sub_f32 v136, v136, v240
  v_sub_f32 v137, v137, v240
  v_sub_f32 v138, v138, v240
  v_sub_f32 v139, v139, v240
  v_sub_f32 v140, v140, v240
  v_sub_f32 v141, v141, v240
  v_sub_f32 v142, v142, v240
  v_sub_f32 v143, v143, v240
  v_sub_f32 v192, v192, v240
  v_sub_f32 v193, v193, v240
  v_sub_f32 v194, v194, v240
  v_sub_f32 v195, v195, v240
  v_sub_f32 v196, v196, v240
  v_sub_f32 v197, v197, v240
  v_sub_f32 v198, v198, v240
  v_sub_f32 v199, v199, v240
  v_sub_f32 v200, v200, v240
  v_sub_f32 v201, v201, v240
  v_sub_f32 v202, v202, v240
  v_sub_f32 v203, v203, v240
  v_sub_f32 v204, v204, v240
  v_sub_f32 v205, v205, v240
  v_sub_f32 v206, v206, v240
  v_sub_f32 v207, v207, v240
  v_mul_f32 v48, v48, v241
  v_mul_f32 v49, v49, v241
  v_mul_f32 v50, v50, v241
  v_mul_f32 v51, v51, v241
  v_mul_f32 v52, v52, v241
  v_mul_f32 v53, v53, v241
  v_mul_f32 v54, v54, v241
  v_mul_f32 v55, v55, v241
  v_mul_f32 v56, v56, v241
  v_mul_f32 v57, v57, v241
  v_mul_f32 v58, v58, v241
  v_mul_f32 v59, v59, v241
  v_mul_f32 v60, v60, v241
  v_mul_f32 v61, v61, v241
  v_mul_f32 v62, v62, v241
  v_mul_f32 v63, v63, v241
  v_mul_f32 v64, v64, v241
  v_mul_f32 v65, v65, v241
  v_mul_f32 v66, v66, v241
  v_mul_f32 v67, v67, v241
  v_mul_f32 v68, v68, v241
  v_mul_f32 v69, v69, v241
  v_mul_f32 v70, v70, v241
  v_mul_f32 v71, v71, v241
  v_mul_f32 v72, v72, v241
  v_mul_f32 v73, v73, v241
  v_mul_f32 v74, v74, v241
  v_mul_f32 v75, v75, v241
  v_mul_f32 v76, v76, v241
  v_mul_f32 v77, v77, v241
  v_mul_f32 v78, v78, v241
  v_mul_f32 v79, v79, v241
  v_mul_f32 v80, v80, v241
  v_mul_f32 v81, v81, v241
  v_mul_f32 v82, v82, v241
  v_mul_f32 v83, v83, v241
  v_mul_f32 v84, v84, v241
  v_mul_f32 v85, v85, v241
  v_mul_f32 v86, v86, v241
  v_mul_f32 v87, v87, v241
  v_mul_f32 v88, v88, v241
  v_mul_f32 v89, v89, v241
  v_mul_f32 v90, v90, v241
  v_mul_f32 v91, v91, v241
  v_mul_f32 v92, v92, v241
  v_mul_f32 v93, v93, v241
  v_mul_f32 v94, v94, v241
  v_mul_f32 v95, v95, v241
  v_mul_f32 v96, v96, v241
  v_mul_f32 v97, v97, v241
  v_mul_f32 v98, v98, v241
  v_mul_f32 v99, v99, v241
  v_mul_f32 v100, v100, v241
  v_mul_f32 v101, v101, v241
  v_mul_f32 v102, v102, v241
  v_mul_f32 v103, v103, v241
  v_mul_f32 v104, v104, v241
  v_mul_f32 v105, v105, v241
  v_mul_f32 v106, v106, v241
  v_mul_f32 v107, v107, v241
  v_mul_f32 v108, v108, v241
  v_mul_f32 v109, v109, v241
  v_mul_f32 v110, v110, v241
  v_mul_f32 v111, v111, v241
  v_mul_f32 v9, v9, v241
  v_exp_f32 v232, v144
  v_exp_f32 v233, v145
  v_exp_f32 v234, v146
  v_add_f32 v10, v232, v233
  v_cvt_pk_bf16_f32 v216, v232, v233
  v_exp_f32 v235, v147
  v_add_f32 v10, v10, v234
  v_exp_f32 v236, v148
  v_add_f32 v10, v10, v235
  v_cvt_pk_bf16_f32 v217, v234, v235
  v_exp_f32 v237, v149
  v_add_f32 v10, v10, v236
  v_exp_f32 v238, v150
  v_add_f32 v10, v10, v237
  v_cvt_pk_bf16_f32 v218, v236, v237
  v_exp_f32 v239, v151
  v_add_f32 v10, v10, v238
  v_exp_f32 v232, v152
  v_add_f32 v10, v10, v239
  v_cvt_pk_bf16_f32 v219, v238, v239
  v_exp_f32 v233, v153
  v_add_f32 v10, v10, v232
  v_exp_f32 v234, v154
  v_add_f32 v10, v10, v233
  v_cvt_pk_bf16_f32 v220, v232, v233
  v_exp_f32 v235, v155
  v_add_f32 v10, v10, v234
  v_exp_f32 v236, v156
  v_add_f32 v10, v10, v235
  v_cvt_pk_bf16_f32 v221, v234, v235
  v_exp_f32 v237, v157
  v_add_f32 v10, v10, v236
  v_exp_f32 v238, v158
  v_add_f32 v10, v10, v237
  v_cvt_pk_bf16_f32 v222, v236, v237
  v_exp_f32 v239, v159
  v_add_f32 v10, v10, v238
  v_add_f32 v10, v10, v239
  v_cvt_pk_bf16_f32 v223, v238, v239
  v_exp_f32 v232, v160
  v_exp_f32 v233, v161
  v_add_f32 v10, v10, v232
  v_exp_f32 v234, v162
  v_add_f32 v10, v10, v233
  v_cvt_pk_bf16_f32 v224, v232, v233
  v_exp_f32 v235, v163
  v_add_f32 v10, v10, v234
  v_exp_f32 v236, v164
  v_add_f32 v10, v10, v235
  v_cvt_pk_bf16_f32 v225, v234, v235
  v_exp_f32 v237, v165
  v_add_f32 v10, v10, v236
  v_exp_f32 v238, v166
  v_add_f32 v10, v10, v237
  v_cvt_pk_bf16_f32 v226, v236, v237
  v_exp_f32 v239, v167
  v_add_f32 v10, v10, v238
  v_exp_f32 v232, v168
  v_add_f32 v10, v10, v239
  v_cvt_pk_bf16_f32 v227, v238, v239
  v_exp_f32 v233, v169
  v_add_f32 v10, v10, v232
  v_exp_f32 v234, v170
  v_add_f32 v10, v10, v233
  v_cvt_pk_bf16_f32 v228, v232, v233
  v_exp_f32 v235, v171
  v_add_f32 v10, v10, v234
  v_exp_f32 v236, v172
  v_add_f32 v10, v10, v235
  v_cvt_pk_bf16_f32 v229, v234, v235
  v_exp_f32 v237, v173
  v_add_f32 v10, v10, v236
  v_exp_f32 v238, v174
  v_add_f32 v10, v10, v237
  v_cvt_pk_bf16_f32 v230, v236, v237
  v_exp_f32 v239, v175
  v_add_f32 v10, v10, v238
  v_add_f32 v10, v10, v239
  v_cvt_pk_bf16_f32 v231, v238, v239
  s_branch kva_kernel_r2b_28
kva_kernel_sp_29:
  s_nop 15
  s_bitcmp1_b32 s36, s32
  s_cbranch_scc0 kva_kernel_sp1_45
  s_cmp_eq_u32 s32, 16
  s_cselect_b32 s38, s44, 0
  v_subrev_u32 v242, s38, v8
  v_cmp_gt_i32_e64 s[48:49], 0, v242
  v_cmp_gt_i32_e64 s[50:51], 1, v242
  v_cmp_gt_i32_e64 s[52:53], 2, v242
  v_cmp_gt_i32_e64 s[54:55], 3, v242
  v_cndmask_b32_e64 v112, v112, v11, s[48:49]
  v_cmp_gt_i32_e64 s[48:49], 8, v242
  v_cndmask_b32_e64 v113, v113, v11, s[50:51]
  v_cmp_gt_i32_e64 s[50:51], 9, v242
  v_cndmask_b32_e64 v114, v114, v11, s[52:53]
  v_cmp_gt_i32_e64 s[52:53], 10, v242
  v_cndmask_b32_e64 v115, v115, v11, s[54:55]
  v_cmp_gt_i32_e64 s[54:55], 11, v242
  v_cndmask_b32_e64 v116, v116, v11, s[48:49]
  v_cmp_gt_i32_e64 s[48:49], 16, v242
  v_cndmask_b32_e64 v117, v117, v11, s[50:51]
  v_cmp_gt_i32_e64 s[50:51], 17, v242
  v_cndmask_b32_e64 v118, v118, v11, s[52:53]
  v_cmp_gt_i32_e64 s[52:53], 18, v242
  v_cndmask_b32_e64 v119, v119, v11, s[54:55]
  v_cmp_gt_i32_e64 s[54:55], 19, v242
  v_cndmask_b32_e64 v120, v120, v11, s[48:49]
  v_cmp_gt_i32_e64 s[48:49], 24, v242
  v_cndmask_b32_e64 v121, v121, v11, s[50:51]
  v_cmp_gt_i32_e64 s[50:51], 25, v242
  v_cndmask_b32_e64 v122, v122, v11, s[52:53]
  v_cmp_gt_i32_e64 s[52:53], 26, v242
  v_cndmask_b32_e64 v123, v123, v11, s[54:55]
  v_cmp_gt_i32_e64 s[54:55], 27, v242
  v_cndmask_b32_e64 v124, v124, v11, s[48:49]
  v_cmp_gt_i32_e64 s[48:49], 32, v242
  v_cndmask_b32_e64 v125, v125, v11, s[50:51]
  v_cmp_gt_i32_e64 s[50:51], 33, v242
  v_cndmask_b32_e64 v126, v126, v11, s[52:53]
  v_cmp_gt_i32_e64 s[52:53], 34, v242
  v_cndmask_b32_e64 v127, v127, v11, s[54:55]
  v_cmp_gt_i32_e64 s[54:55], 35, v242
  v_cndmask_b32_e64 v128, v128, v11, s[48:49]
  v_cmp_gt_i32_e64 s[48:49], 40, v242
  v_cndmask_b32_e64 v129, v129, v11, s[50:51]
  v_cmp_gt_i32_e64 s[50:51], 41, v242
  v_cndmask_b32_e64 v130, v130, v11, s[52:53]
  v_cmp_gt_i32_e64 s[52:53], 42, v242
  v_cndmask_b32_e64 v131, v131, v11, s[54:55]
  v_cmp_gt_i32_e64 s[54:55], 43, v242
  v_cndmask_b32_e64 v132, v132, v11, s[48:49]
  v_cmp_gt_i32_e64 s[48:49], 48, v242
  v_cndmask_b32_e64 v133, v133, v11, s[50:51]
  v_cmp_gt_i32_e64 s[50:51], 49, v242
  v_cndmask_b32_e64 v134, v134, v11, s[52:53]
  v_cmp_gt_i32_e64 s[52:53], 50, v242
  v_cndmask_b32_e64 v135, v135, v11, s[54:55]
  v_cmp_gt_i32_e64 s[54:55], 51, v242
  v_cndmask_b32_e64 v136, v136, v11, s[48:49]
  v_cmp_gt_i32_e64 s[48:49], 56, v242
  v_cndmask_b32_e64 v137, v137, v11, s[50:51]
  v_cmp_gt_i32_e64 s[50:51], 57, v242
  v_cndmask_b32_e64 v138, v138, v11, s[52:53]
  v_cmp_gt_i32_e64 s[52:53], 58, v242
  v_cndmask_b32_e64 v139, v139, v11, s[54:55]
  v_cmp_gt_i32_e64 s[54:55], 59, v242
  v_cndmask_b32_e64 v140, v140, v11, s[48:49]
  v_cndmask_b32_e64 v141, v141, v11, s[50:51]
  v_cndmask_b32_e64 v142, v142, v11, s[52:53]
  v_cndmask_b32_e64 v143, v143, v11, s[54:55]
kva_kernel_sp1_45:
  s_cmp_lg_u32 s32, s43
  s_cbranch_scc1 kva_kernel_spb_30
  v_max3_f32 v240, v112, v113, v114
  v_max3_f32 v241, v115, v116, v117
  v_max3_f32 v240, v240, v118, v119
  v_max3_f32 v241, v241, v120, v121
  v_max3_f32 v240, v240, v122, v123
  v_max3_f32 v241, v241, v124, v125
  v_max3_f32 v240, v240, v126, v127
  v_max3_f32 v241, v241, v128, v129
  v_max3_f32 v240, v240, v130, v131
  v_max3_f32 v241, v241, v132, v133
  v_max3_f32 v240, v240, v134, v135
  v_max3_f32 v241, v241, v136, v137
  v_max3_f32 v240, v240, v138, v139
  v_max3_f32 v241, v241, v140, v141
  v_max3_f32 v240, v240, v142, v143
  v_max_f32 v240, v240, v241
  v_mov_b32 v241, v240
  s_nop 1
  v_permlane32_swap_b32 v240, v241
  v_max_f32 v240, v240, v241
  v_sub_f32 v112, v112, v240
  v_sub_f32 v113, v113, v240
  v_sub_f32 v114, v114, v240
  v_sub_f32 v115, v115, v240
  v_sub_f32 v116, v116, v240
  v_sub_f32 v117, v117, v240
  v_sub_f32 v118, v118, v240
  v_sub_f32 v119, v119, v240
  v_sub_f32 v120, v120, v240
  v_sub_f32 v121, v121, v240
  v_sub_f32 v122, v122, v240
  v_sub_f32 v123, v123, v240
  v_sub_f32 v124, v124, v240
  v_sub_f32 v125, v125, v240
  v_sub_f32 v126, v126, v240
  v_sub_f32 v127, v127, v240
  v_sub_f32 v128, v128, v240
  v_sub_f32 v129, v129, v240
  v_sub_f32 v130, v130, v240
  v_sub_f32 v131, v131, v240
  v_sub_f32 v132, v132, v240
  v_sub_f32 v133, v133, v240
  v_sub_f32 v134, v134, v240
  v_sub_f32 v135, v135, v240
  v_sub_f32 v136, v136, v240
  v_sub_f32 v137, v137, v240
  v_sub_f32 v138, v138, v240
  v_sub_f32 v139, v139, v240
  v_sub_f32 v140, v140, v240
  v_sub_f32 v141, v141, v240
  v_sub_f32 v142, v142, v240
  v_sub_f32 v143, v143, v240
  v_sub_f32 v192, v192, v240
  v_sub_f32 v193, v193, v240
  v_sub_f32 v194, v194, v240
  v_sub_f32 v195, v195, v240
  v_sub_f32 v196, v196, v240
  v_sub_f32 v197, v197, v240
  v_sub_f32 v198, v198, v240
  v_sub_f32 v199, v199, v240
  v_sub_f32 v200, v200, v240
  v_sub_f32 v201, v201, v240
  v_sub_f32 v202, v202, v240
  v_sub_f32 v203, v203, v240
  v_sub_f32 v204, v204, v240
  v_sub_f32 v205, v205, v240
  v_sub_f32 v206, v206, v240
  v_sub_f32 v207, v207, v240
  s_branch kva_kernel_spb_30
kva_kernel_fin_31:
  s_nop 15
  v_mov_b32 v240, v9
  v_mov_b32 v241, v9
  s_nop 1
  v_permlane32_swap_b32 v240, v241
  v_add_f32 v240, v240, v241
  v_rcp_f32 v240, v240
  s_nop 0
  v_mul_f32 v48, v48, v240
  v_mul_f32 v49, v49, v240
  v_mul_f32 v50, v50, v240
  v_mul_f32 v51, v51, v240
  v_mul_f32 v52, v52, v240
  v_mul_f32 v53, v53, v240
  v_mul_f32 v54, v54, v240
  v_mul_f32 v55, v55, v240
  v_mul_f32 v56, v56, v240
  v_mul_f32 v57, v57, v240
  v_mul_f32 v58, v58, v240
  v_mul_f32 v59, v59, v240
  v_mul_f32 v60, v60, v240
  v_mul_f32 v61, v61, v240
  v_mul_f32 v62, v62, v240
  v_mul_f32 v63, v63, v240
  v_cvt_pk_bf16_f32 v244, v48, v49
  v_cvt_pk_bf16_f32 v245, v50, v51
  v_cvt_pk_bf16_f32 v246, v52, v53
  v_cvt_pk_bf16_f32 v247, v54, v55
  buffer_store_dwordx4 v[244:247], v2, s[20:23], s40 offen offset:0 sc1
  v_cvt_pk_bf16_f32 v248, v56, v57
  v_cvt_pk_bf16_f32 v249, v58, v59
  v_cvt_pk_bf16_f32 v250, v60, v61
  v_cvt_pk_bf16_f32 v251, v62, v63
  buffer_store_dwordx4 v[248:251], v2, s[20:23], s40 offen offset:1024 sc1
  v_mul_f32 v64, v64, v240
  v_mul_f32 v65, v65, v240
  v_mul_f32 v66, v66, v240
  v_mul_f32 v67, v67, v240
  v_mul_f32 v68, v68, v240
  v_mul_f32 v69, v69, v240
  v_mul_f32 v70, v70, v240
  v_mul_f32 v71, v71, v240
  v_mul_f32 v72, v72, v240
  v_mul_f32 v73, v73, v240
  v_mul_f32 v74, v74, v240
  v_mul_f32 v75, v75, v240
  v_mul_f32 v76, v76, v240
  v_mul_f32 v77, v77, v240
  v_mul_f32 v78, v78, v240
  v_mul_f32 v79, v79, v240
  v_cvt_pk_bf16_f32 v244, v64, v65
  v_cvt_pk_bf16_f32 v245, v66, v67
  v_cvt_pk_bf16_f32 v246, v68, v69
  v_cvt_pk_bf16_f32 v247, v70, v71
  buffer_store_dwordx4 v[244:247], v2, s[20:23], s40 offen offset:2048 sc1
  v_cvt_pk_bf16_f32 v248, v72, v73
  v_cvt_pk_bf16_f32 v249, v74, v75
  v_cvt_pk_bf16_f32 v250, v76, v77
  v_cvt_pk_bf16_f32 v251, v78, v79
  buffer_store_dwordx4 v[248:251], v2, s[20:23], s40 offen offset:3072 sc1
  v_mul_f32 v80, v80, v240
  v_mul_f32 v81, v81, v240
  v_mul_f32 v82, v82, v240
  v_mul_f32 v83, v83, v240
  v_mul_f32 v84, v84, v240
  v_mul_f32 v85, v85, v240
  v_mul_f32 v86, v86, v240
  v_mul_f32 v87, v87, v240
  v_mul_f32 v88, v88, v240
  v_mul_f32 v89, v89, v240
  v_mul_f32 v90, v90, v240
  v_mul_f32 v91, v91, v240
  v_mul_f32 v92, v92, v240
  v_mul_f32 v93, v93, v240
  v_mul_f32 v94, v94, v240
  v_mul_f32 v95, v95, v240
  v_cvt_pk_bf16_f32 v244, v80, v81
  v_cvt_pk_bf16_f32 v245, v82, v83
  v_cvt_pk_bf16_f32 v246, v84, v85
  v_cvt_pk_bf16_f32 v247, v86, v87
  s_add_u32 s38, s40, 4096
  buffer_store_dwordx4 v[244:247], v2, s[20:23], s38 offen offset:0 sc1
  v_cvt_pk_bf16_f32 v248, v88, v89
  v_cvt_pk_bf16_f32 v249, v90, v91
  v_cvt_pk_bf16_f32 v250, v92, v93
  v_cvt_pk_bf16_f32 v251, v94, v95
  s_add_u32 s38, s40, 4096
  buffer_store_dwordx4 v[248:251], v2, s[20:23], s38 offen offset:1024 sc1
  v_mul_f32 v96, v96, v240
  v_mul_f32 v97, v97, v240
  v_mul_f32 v98, v98, v240
  v_mul_f32 v99, v99, v240
  v_mul_f32 v100, v100, v240
  v_mul_f32 v101, v101, v240
  v_mul_f32 v102, v102, v240
  v_mul_f32 v103, v103, v240
  v_mul_f32 v104, v104, v240
  v_mul_f32 v105, v105, v240
  v_mul_f32 v106, v106, v240
  v_mul_f32 v107, v107, v240
  v_mul_f32 v108, v108, v240
  v_mul_f32 v109, v109, v240
  v_mul_f32 v110, v110, v240
  v_mul_f32 v111, v111, v240
  v_cvt_pk_bf16_f32 v244, v96, v97
  v_cvt_pk_bf16_f32 v245, v98, v99
  v_cvt_pk_bf16_f32 v246, v100, v101
  v_cvt_pk_bf16_f32 v247, v102, v103
  s_add_u32 s38, s40, 4096
  buffer_store_dwordx4 v[244:247], v2, s[20:23], s38 offen offset:2048 sc1
  v_cvt_pk_bf16_f32 v248, v104, v105
  v_cvt_pk_bf16_f32 v249, v106, v107
  v_cvt_pk_bf16_f32 v250, v108, v109
  v_cvt_pk_bf16_f32 v251, v110, v111
  s_add_u32 s38, s40, 4096
  buffer_store_dwordx4 v[248:251], v2, s[20:23], s38 offen offset:3072 sc1
  v_mov_b32 v48, 0
  v_mov_b32 v49, 0
  v_mov_b32 v50, 0
  v_mov_b32 v51, 0
  v_mov_b32 v52, 0
  v_mov_b32 v53, 0
  v_mov_b32 v54, 0
  v_mov_b32 v55, 0
  v_mov_b32 v56, 0
  v_mov_b32 v57, 0
  v_mov_b32 v58, 0
  v_mov_b32 v59, 0
  v_mov_b32 v60, 0
  v_mov_b32 v61, 0
  v_mov_b32 v62, 0
  v_mov_b32 v63, 0
  v_mov_b32 v64, 0
  v_mov_b32 v65, 0
  v_mov_b32 v66, 0
  v_mov_b32 v67, 0
  v_mov_b32 v68, 0
  v_mov_b32 v69, 0
  v_mov_b32 v70, 0
  v_mov_b32 v71, 0
  v_mov_b32 v72, 0
  v_mov_b32 v73, 0
  v_mov_b32 v74, 0
  v_mov_b32 v75, 0
  v_mov_b32 v76, 0
  v_mov_b32 v77, 0
  v_mov_b32 v78, 0
  v_mov_b32 v79, 0
  v_mov_b32 v80, 0
  v_mov_b32 v81, 0
  v_mov_b32 v82, 0
  v_mov_b32 v83, 0
  v_mov_b32 v84, 0
  v_mov_b32 v85, 0
  v_mov_b32 v86, 0
  v_mov_b32 v87, 0
  v_mov_b32 v88, 0
  v_mov_b32 v89, 0
  v_mov_b32 v90, 0
  v_mov_b32 v91, 0
  v_mov_b32 v92, 0
  v_mov_b32 v93, 0
  v_mov_b32 v94, 0
  v_mov_b32 v95, 0
  v_mov_b32 v96, 0
  v_mov_b32 v97, 0
  v_mov_b32 v98, 0
  v_mov_b32 v99, 0
  v_mov_b32 v100, 0
  v_mov_b32 v101, 0
  v_mov_b32 v102, 0
  v_mov_b32 v103, 0
  v_mov_b32 v104, 0
  v_mov_b32 v105, 0
  v_mov_b32 v106, 0
  v_mov_b32 v107, 0
  v_mov_b32 v108, 0
  v_mov_b32 v109, 0
  v_mov_b32 v110, 0
  v_mov_b32 v111, 0
  v_mov_b32 v9, 0
  s_branch kva_kernel_finb_32
kva_kernel_r2_33:
  s_nop 15
  v_max3_f32 v240, v112, v113, v114
  v_max3_f32 v241, v115, v116, v117
  v_max3_f32 v240, v240, v118, v119
  v_max3_f32 v241, v241, v120, v121
  v_max3_f32 v240, v240, v122, v123
  v_max3_f32 v241, v241, v124, v125
  v_max3_f32 v240, v240, v126, v127
  v_max3_f32 v241, v241, v128, v129
  v_max3_f32 v240, v240, v130, v131
  v_max3_f32 v241, v241, v132, v133
  v_max3_f32 v240, v240, v134, v135
  v_max3_f32 v241, v241, v136, v137
  v_max3_f32 v240, v240, v138, v139
  v_max3_f32 v241, v241, v140, v141
  v_max3_f32 v240, v240, v142, v143
  v_max_f32 v240, v240, v241
  v_mov_b32 v241, v240
  s_nop 1
  v_permlane32_swap_b32 v240, v241
  v_max_f32 v240, v240, v241
  v_max_f32 v240, 0, v240
  v_exp_f32 v241, -v240
  v_sub_f32 v112, v112, v240
  v_sub_f32 v113, v113, v240
  v_sub_f32 v114, v114, v240
  v_sub_f32 v115, v115, v240
  v_sub_f32 v116, v116, v240
  v_sub_f32 v117, v117, v240
  v_sub_f32 v118, v118, v240
  v_sub_f32 v119, v119, v240
  v_sub_f32 v120, v120, v240
  v_sub_f32 v121, v121, v240
  v_sub_f32 v122, v122, v240
  v_sub_f32 v123, v123, v240
  v_sub_f32 v124, v124, v240
  v_sub_f32 v125, v125, v240
  v_sub_f32 v126, v126, v240
  v_sub_f32 v127, v127, v240
  v_sub_f32 v128, v128, v240
  v_sub_f32 v129, v129, v240
  v_sub_f32 v130, v130, v240
  v_sub_f32 v131, v131, v240
  v_sub_f32 v132, v132, v240
  v_sub_f32 v133, v133, v240
  v_sub_f32 v134, v134, v240
  v_sub_f32 v135, v135, v240
  v_sub_f32 v136, v136, v240
  v_sub_f32 v137, v137, v240
  v_sub_f32 v138, v138, v240
  v_sub_f32 v139, v139, v240
  v_sub_f32 v140, v140, v240
  v_sub_f32 v141, v141, v240
  v_sub_f32 v142, v142, v240
  v_sub_f32 v143, v143, v240
  v_sub_f32 v144, v144, v240
  v_sub_f32 v145, v145, v240
  v_sub_f32 v146, v146, v240
  v_sub_f32 v147, v147, v240
  v_sub_f32 v148, v148, v240
  v_sub_f32 v149, v149, v240
  v_sub_f32 v150, v150, v240
  v_sub_f32 v151, v151, v240
  v_sub_f32 v152, v152, v240
  v_sub_f32 v153, v153, v240
  v_sub_f32 v154, v154, v240
  v_sub_f32 v155, v155, v240
  v_sub_f32 v156, v156, v240
  v_sub_f32 v157, v157, v240
  v_sub_f32 v158, v158, v240
  v_sub_f32 v159, v159, v240
  v_sub_f32 v160, v160, v240
  v_sub_f32 v161, v161, v240
  v_sub_f32 v162, v162, v240
  v_sub_f32 v163, v163, v240
  v_sub_f32 v164, v164, v240
  v_sub_f32 v165, v165, v240
  v_sub_f32 v166, v166, v240
  v_sub_f32 v167, v167, v240
  v_sub_f32 v168, v168, v240
  v_sub_f32 v169, v169, v240
  v_sub_f32 v170, v170, v240
  v_sub_f32 v171, v171, v240
  v_sub_f32 v172, v172, v240
  v_sub_f32 v173, v173, v240
  v_sub_f32 v174, v174, v240
  v_sub_f32 v175, v175, v240
  v_sub_f32 v192, v192, v240
  v_sub_f32 v193, v193, v240
  v_sub_f32 v194, v194, v240
  v_sub_f32 v195, v195, v240
  v_sub_f32 v196, v196, v240
  v_sub_f32 v197, v197, v240
  v_sub_f32 v198, v198, v240
  v_sub_f32 v199, v199, v240
  v_sub_f32 v200, v200, v240
  v_sub_f32 v201, v201, v240
  v_sub_f32 v202, v202, v240
  v_sub_f32 v203, v203, v240
  v_sub_f32 v204, v204, v240
  v_sub_f32 v205, v205, v240
  v_sub_f32 v206, v206, v240
  v_sub_f32 v207, v207, v240
  v_mul_f32 v48, v48, v241
  v_mul_f32 v49, v49, v241
  v_mul_f32 v50, v50, v241
  v_mul_f32 v51, v51, v241
  v_mul_f32 v52, v52, v241
  v_mul_f32 v53, v53, v241
  v_mul_f32 v54, v54, v241
  v_mul_f32 v55, v55, v241
  v_mul_f32 v56, v56, v241
  v_mul_f32 v57, v57, v241
  v_mul_f32 v58, v58, v241
  v_mul_f32 v59, v59, v241
  v_mul_f32 v60, v60, v241
  v_mul_f32 v61, v61, v241
  v_mul_f32 v62, v62, v241
  v_mul_f32 v63, v63, v241
  v_mul_f32 v64, v64, v241
  v_mul_f32 v65, v65, v241
  v_mul_f32 v66, v66, v241
  v_mul_f32 v67, v67, v241
  v_mul_f32 v68, v68, v241
  v_mul_f32 v69, v69, v241
  v_mul_f32 v70, v70, v241
  v_mul_f32 v71, v71, v241
  v_mul_f32 v72, v72, v241
  v_mul_f32 v73, v73, v241
  v_mul_f32 v74, v74, v241
  v_mul_f32 v75, v75, v241
  v_mul_f32 v76, v76, v241
  v_mul_f32 v77, v77, v241
  v_mul_f32 v78, v78, v241
  v_mul_f32 v79, v79, v241
  v_mul_f32 v80, v80, v241
  v_mul_f32 v81, v81, v241
  v_mul_f32 v82, v82, v241
  v_mul_f32 v83, v83, v241
  v_mul_f32 v84, v84, v241
  v_mul_f32 v85, v85, v241
  v_mul_f32 v86, v86, v241
  v_mul_f32 v87, v87, v241
  v_mul_f32 v88, v88, v241
  v_mul_f32 v89, v89, v241
  v_mul_f32 v90, v90, v241
  v_mul_f32 v91, v91, v241
  v_mul_f32 v92, v92, v241
  v_mul_f32 v93, v93, v241
  v_mul_f32 v94, v94, v241
  v_mul_f32 v95, v95, v241
  v_mul_f32 v96, v96, v241
  v_mul_f32 v97, v97, v241
  v_mul_f32 v98, v98, v241
  v_mul_f32 v99, v99, v241
  v_mul_f32 v100, v100, v241
  v_mul_f32 v101, v101, v241
  v_mul_f32 v102, v102, v241
  v_mul_f32 v103, v103, v241
  v_mul_f32 v104, v104, v241
  v_mul_f32 v105, v105, v241
  v_mul_f32 v106, v106, v241
  v_mul_f32 v107, v107, v241
  v_mul_f32 v108, v108, v241
  v_mul_f32 v109, v109, v241
  v_mul_f32 v110, v110, v241
  v_mul_f32 v111, v111, v241
  v_mul_f32 v9, v9, v241
  v_exp_f32 v232, v112
  v_exp_f32 v233, v113
  v_exp_f32 v234, v114
  v_add_f32 v10, v232, v233
  v_cvt_pk_bf16_f32 v208, v232, v233
  v_exp_f32 v235, v115
  v_add_f32 v10, v10, v234
  v_exp_f32 v236, v116
  v_add_f32 v10, v10, v235
  v_cvt_pk_bf16_f32 v209, v234, v235
  v_exp_f32 v237, v117
  v_add_f32 v10, v10, v236
  v_exp_f32 v238, v118
  v_add_f32 v10, v10, v237
  v_cvt_pk_bf16_f32 v210, v236, v237
  v_exp_f32 v239, v119
  v_add_f32 v10, v10, v238
  v_exp_f32 v232, v120
  v_add_f32 v10, v10, v239
  v_cvt_pk_bf16_f32 v211, v238, v239
  v_exp_f32 v233, v121
  v_add_f32 v10, v10, v232
  v_exp_f32 v234, v122
  v_add_f32 v10, v10, v233
  v_cvt_pk_bf16_f32 v212, v232, v233
  v_exp_f32 v235, v123
  v_add_f32 v10, v10, v234
  v_exp_f32 v236, v124
  v_add_f32 v10, v10, v235
  v_cvt_pk_bf16_f32 v213, v234, v235
  v_exp_f32 v237, v125
  v_add_f32 v10, v10, v236
  v_exp_f32 v238, v126
  v_add_f32 v10, v10, v237
  v_cvt_pk_bf16_f32 v214, v236, v237
  v_exp_f32 v239, v127
  v_add_f32 v10, v10, v238
  v_add_f32 v10, v10, v239
  v_cvt_pk_bf16_f32 v215, v238, v239
  v_exp_f32 v232, v128
  v_exp_f32 v233, v129
  v_add_f32 v10, v10, v232
  v_exp_f32 v234, v130
  v_add_f32 v10, v10, v233
  v_cvt_pk_bf16_f32 v224, v232, v233
  v_exp_f32 v235, v131
  v_add_f32 v10, v10, v234
  v_exp_f32 v236, v132
  v_add_f32 v10, v10, v235
  v_cvt_pk_bf16_f32 v225, v234, v235
  v_exp_f32 v237, v133
  v_add_f32 v10, v10, v236
  v_exp_f32 v238, v134
  v_add_f32 v10, v10, v237
  v_cvt_pk_bf16_f32 v226, v236, v237
  v_exp_f32 v239, v135
  v_add_f32 v10, v10, v238
  v_exp_f32 v232, v136
  v_add_f32 v10, v10, v239
  v_cvt_pk_bf16_f32 v227, v238, v239
  v_exp_f32 v233, v137
  v_add_f32 v10, v10, v232
  v_exp_f32 v234, v138
  v_add_f32 v10, v10, v233
  v_cvt_pk_bf16_f32 v228, v232, v233
  v_exp_f32 v235, v139
  v_add_f32 v10, v10, v234
  v_exp_f32 v236, v140
  v_add_f32 v10, v10, v235
  v_cvt_pk_bf16_f32 v229, v234, v235
  v_exp_f32 v237, v141
  v_add_f32 v10, v10, v236
  v_exp_f32 v238, v142
  v_add_f32 v10, v10, v237
  v_cvt_pk_bf16_f32 v230, v236, v237
  v_exp_f32 v239, v143
  v_add_f32 v10, v10, v238
  v_add_f32 v10, v10, v239
  v_cvt_pk_bf16_f32 v231, v238, v239
  s_branch kva_kernel_r2b_34
kva_kernel_ospin_39:
  s_nop 15
  s_mov_b32 s75, 262144
kva_kernel_osp_46:
  s_mov_b64 exec, 0xff
  buffer_load_dword v17, v18, s[44:47], s58 offen sc1
  s_waitcnt vmcnt(0)
  s_mov_b64 exec, 0xff
  v_cmp_eq_u32 vcc, 0, v17
  s_mov_b64 exec, -1
  s_cbranch_vccz kva_kernel_wj_38
  s_sub_u32 s75, s75, 1
  s_cmp_lg_u32 s75, 0
  s_cbranch_scc1 kva_kernel_osp_46
  s_branch kva_kernel_wj_38
kva_kernel_lnw_6:
  s_nop 15
  s_movk_i32 s95, 2000
kva_kernel_sp_47:
  s_sleep 2
  buffer_load_dword v21, v15, s[36:39], 0 offen sc1
  s_waitcnt vmcnt(0)
  v_and_b32 v21, v21, v63
  v_cmp_ne_u32 vcc, v21, v63
  s_cmp_eq_u64 vcc, 0
  s_cbranch_scc1 kva_kernel_lnb_7
  s_sub_u32 s95, s95, 1
  s_cmp_lg_u32 s95, 0
  s_cbranch_scc1 kva_kernel_sp_47
  v_mov_b32 v22, 0
  v_mov_b32 v63, 0
  s_mov_b32 s94, 0
  s_mov_b32 s95, 0
kva_kernel_fb_48:
  buffer_load_ushort v1, off, s[24:27], s95
  buffer_load_dword v62, v15, s[48:51], s94 offen offset:0
  s_waitcnt vmcnt(0)
  v_lshlrev_b32 v1, 16, v1
  v_mul_f32 v61, 1069066811, v1
  v_exp_f32 v61, -v61
  s_nop 0
  v_add_f32 v61, 1.0, v61
  v_rcp_f32 v61, v61
  s_nop 0
  v_mul_f32 v1, v1, v61
  v_cvt_pk_bf16_f32 v1, v1, v1
  v_lshlrev_b32 v1, 16, v1
  v_lshlrev_b32 v61, 16, v62
  v_fmac_f32 v22, v61, v1
  v_and_b32 v61, 0xffff0000, v62
  v_fmac_f32 v63, v61, v1
  s_add_u32 s95, s95, 2
  s_add_u32 s94, s94, 7680
  s_cmp_lt_u32 s95, 1280
  s_cbranch_scc1 kva_kernel_fb_48
  v_cvt_pk_bf16_f32 v24, v22, v63
  v_mov_b32 v22, 0
  v_mov_b32 v63, 0
  s_mov_b32 s94, 0
  s_mov_b32 s95, 0
kva_kernel_fb_49:
  buffer_load_ushort v1, off, s[24:27], s95
  buffer_load_dword v62, v15, s[48:51], s94 offen offset:256
  s_waitcnt vmcnt(0)
  v_lshlrev_b32 v1, 16, v1
  v_mul_f32 v61, 1069066811, v1
  v_exp_f32 v61, -v61
  s_nop 0
  v_add_f32 v61, 1.0, v61
  v_rcp_f32 v61, v61
  s_nop 0
  v_mul_f32 v1, v1, v61
  v_cvt_pk_bf16_f32 v1, v1, v1
  v_lshlrev_b32 v1, 16, v1
  v_lshlrev_b32 v61, 16, v62
  v_fmac_f32 v22, v61, v1
  v_and_b32 v61, 0xffff0000, v62
  v_fmac_f32 v63, v61, v1
  s_add_u32 s95, s95, 2
  s_add_u32 s94, s94, 7680
  s_cmp_lt_u32 s95, 1280
  s_cbranch_scc1 kva_kernel_fb_49
  v_cvt_pk_bf16_f32 v25, v22, v63
  v_mov_b32 v22, 0
  v_mov_b32 v63, 0
  s_mov_b32 s94, 0
  s_mov_b32 s95, 0
kva_kernel_fb_50:
  buffer_load_ushort v1, off, s[24:27], s95
  buffer_load_dword v62, v15, s[48:51], s94 offen offset:512
  s_waitcnt vmcnt(0)
  v_lshlrev_b32 v1, 16, v1
  v_mul_f32 v61, 1069066811, v1
  v_exp_f32 v61, -v61
  s_nop 0
  v_add_f32 v61, 1.0, v61
  v_rcp_f32 v61, v61
  s_nop 0
  v_mul_f32 v1, v1, v61
  v_cvt_pk_bf16_f32 v1, v1, v1
  v_lshlrev_b32 v1, 16, v1
  v_lshlrev_b32 v61, 16, v62
  v_fmac_f32 v22, v61, v1
  v_and_b32 v61, 0xffff0000, v62
  v_fmac_f32 v63, v61, v1
  s_add_u32 s95, s95, 2
  s_add_u32 s94, s94, 7680
  s_cmp_lt_u32 s95, 1280
  s_cbranch_scc1 kva_kernel_fb_50
  v_cvt_pk_bf16_f32 v26, v22, v63
  v_mov_b32 v22, 0
  v_mov_b32 v63, 0
  s_mov_b32 s94, 0
  s_mov_b32 s95, 0
kva_kernel_fb_51:
  buffer_load_ushort v1, off, s[24:27], s95
  buffer_load_dword v62, v15, s[48:51], s94 offen offset:768
  s_waitcnt vmcnt(0)
  v_lshlrev_b32 v1, 16, v1
  v_mul_f32 v61, 1069066811, v1
  v_exp_f32 v61, -v61
  s_nop 0
  v_add_f32 v61, 1.0, v61
  v_rcp_f32 v61, v61
  s_nop 0
  v_mul_f32 v1, v1, v61
  v_cvt_pk_bf16_f32 v1, v1, v1
  v_lshlrev_b32 v1, 16, v1
  v_lshlrev_b32 v61, 16, v62
  v_fmac_f32 v22, v61, v1
  v_and_b32 v61, 0xffff0000, v62
  v_fmac_f32 v63, v61, v1
  s_add_u32 s95, s95, 2
  s_add_u32 s94, s94, 7680
  s_cmp_lt_u32 s95, 1280
  s_cbranch_scc1 kva_kernel_fb_51
  v_cvt_pk_bf16_f32 v27, v22, v63
  v_mov_b32 v22, 0
  v_mov_b32 v63, 0
  s_mov_b32 s94, 0
  s_mov_b32 s95, 0
kva_kernel_fb_52:
  buffer_load_ushort v1, off, s[24:27], s95
  buffer_load_dword v62, v15, s[48:51], s94 offen offset:1024
  s_waitcnt vmcnt(0)
  v_lshlrev_b32 v1, 16, v1
  v_mul_f32 v61, 1069066811, v1
  v_exp_f32 v61, -v61
  s_nop 0
  v_add_f32 v61, 1.0, v61
  v_rcp_f32 v61, v61
  s_nop 0
  v_mul_f32 v1, v1, v61
  v_cvt_pk_bf16_f32 v1, v1, v1
  v_lshlrev_b32 v1, 16, v1
  v_lshlrev_b32 v61, 16, v62
  v_fmac_f32 v22, v61, v1
  v_and_b32 v61, 0xffff0000, v62
  v_fmac_f32 v63, v61, v1
  s_add_u32 s95, s95, 2
  s_add_u32 s94, s94, 7680
  s_cmp_lt_u32 s95, 1280
  s_cbranch_scc1 kva_kernel_fb_52
  v_cvt_pk_bf16_f32 v28, v22, v63
  v_mov_b32 v22, 0
  v_mov_b32 v63, 0
  s_mov_b32 s94, 0
  s_mov_b32 s95, 0
kva_kernel_fb_53:
  buffer_load_ushort v1, off, s[24:27], s95
  buffer_load_dword v62, v15, s[48:51], s94 offen offset:1280
  s_waitcnt vmcnt(0)
  v_lshlrev_b32 v1, 16, v1
  v_mul_f32 v61, 1069066811, v1
  v_exp_f32 v61, -v61
  s_nop 0
  v_add_f32 v61, 1.0, v61
  v_rcp_f32 v61, v61
  s_nop 0
  v_mul_f32 v1, v1, v61
  v_cvt_pk_bf16_f32 v1, v1, v1
  v_lshlrev_b32 v1, 16, v1
  v_lshlrev_b32 v61, 16, v62
  v_fmac_f32 v22, v61, v1
  v_and_b32 v61, 0xffff0000, v62
  v_fmac_f32 v63, v61, v1
  s_add_u32 s95, s95, 2
  s_add_u32 s94, s94, 7680
  s_cmp_lt_u32 s95, 1280
  s_cbranch_scc1 kva_kernel_fb_53
  v_cvt_pk_bf16_f32 v61, v22, v63
  v_lshlrev_b32 v22, 16, v61
  v_and_b32 v63, 0xffff0000, v61
  v_add_f32 v22, 1.0, v22
  v_add_f32 v63, 1.0, v63
  v_cvt_pk_bf16_f32 v29, v22, v63
  v_mov_b32 v22, 0
  v_mov_b32 v63, 0
  s_mov_b32 s94, 0
  s_mov_b32 s95, 0
kva_kernel_fb_54:
  buffer_load_ushort v1, off, s[24:27], s95
  buffer_load_dword v62, v15, s[48:51], s94 offen offset:1536
  s_waitcnt vmcnt(0)
  v_lshlrev_b32 v1, 16, v1
  v_mul_f32 v61, 1069066811, v1
  v_exp_f32 v61, -v61
  s_nop 0
  v_add_f32 v61, 1.0, v61
  v_rcp_f32 v61, v61
  s_nop 0
  v_mul_f32 v1, v1, v61
  v_cvt_pk_bf16_f32 v1, v1, v1
  v_lshlrev_b32 v1, 16, v1
  v_lshlrev_b32 v61, 16, v62
  v_fmac_f32 v22, v61, v1
  v_and_b32 v61, 0xffff0000, v62
  v_fmac_f32 v63, v61, v1
  s_add_u32 s95, s95, 2
  s_add_u32 s94, s94, 7680
  s_cmp_lt_u32 s95, 1280
  s_cbranch_scc1 kva_kernel_fb_54
  v_cvt_pk_bf16_f32 v61, v22, v63
  v_lshlrev_b32 v22, 16, v61
  v_and_b32 v63, 0xffff0000, v61
  v_add_f32 v22, 1.0, v22
  v_add_f32 v63, 1.0, v63
  v_cvt_pk_bf16_f32 v30, v22, v63
  v_mov_b32 v22, 0
  v_mov_b32 v63, 0
  s_mov_b32 s94, 0
  s_mov_b32 s95, 0
kva_kernel_fb_55:
  buffer_load_ushort v1, off, s[24:27], s95
  buffer_load_dword v62, v15, s[48:51], s94 offen offset:1792
  s_waitcnt vmcnt(0)
  v_lshlrev_b32 v1, 16, v1
  v_mul_f32 v61, 1069066811, v1
  v_exp_f32 v61, -v61
  s_nop 0
  v_add_f32 v61, 1.0, v61
  v_rcp_f32 v61, v61
  s_nop 0
  v_mul_f32 v1, v1, v61
  v_cvt_pk_bf16_f32 v1, v1, v1
  v_lshlrev_b32 v1, 16, v1
  v_lshlrev_b32 v61, 16, v62
  v_fmac_f32 v22, v61, v1
  v_and_b32 v61, 0xffff0000, v62
  v_fmac_f32 v63, v61, v1
  s_add_u32 s95, s95, 2
  s_add_u32 s94, s94, 7680
  s_cmp_lt_u32 s95, 1280
  s_cbranch_scc1 kva_kernel_fb_55
  v_cvt_pk_bf16_f32 v61, v22, v63
  v_lshlrev_b32 v22, 16, v61
  v_and_b32 v63, 0xffff0000, v61
  v_add_f32 v22, 1.0, v22
  v_add_f32 v63, 1.0, v63
  v_cvt_pk_bf16_f32 v31, v22, v63
  v_mov_b32 v22, 0
  v_mov_b32 v63, 0
  s_mov_b32 s94, 0
  s_mov_b32 s95, 0
kva_kernel_fb_56:
  buffer_load_ushort v1, off, s[24:27], s95
  buffer_load_dword v62, v15, s[48:51], s94 offen offset:2048
  s_waitcnt vmcnt(0)
  v_lshlrev_b32 v1, 16, v1
  v_mul_f32 v61, 1069066811, v1
  v_exp_f32 v61, -v61
  s_nop 0
  v_add_f32 v61, 1.0, v61
  v_rcp_f32 v61, v61
  s_nop 0
  v_mul_f32 v1, v1, v61
  v_cvt_pk_bf16_f32 v1, v1, v1
  v_lshlrev_b32 v1, 16, v1
  v_lshlrev_b32 v61, 16, v62
  v_fmac_f32 v22, v61, v1
  v_and_b32 v61, 0xffff0000, v62
  v_fmac_f32 v63, v61, v1
  s_add_u32 s95, s95, 2
  s_add_u32 s94, s94, 7680
  s_cmp_lt_u32 s95, 1280
  s_cbranch_scc1 kva_kernel_fb_56
  v_cvt_pk_bf16_f32 v61, v22, v63
  v_lshlrev_b32 v22, 16, v61
  v_and_b32 v63, 0xffff0000, v61
  v_add_f32 v22, 1.0, v22
  v_add_f32 v63, 1.0, v63
  v_cvt_pk_bf16_f32 v21, v22, v63
  v_mov_b32 v22, 0
  v_mov_b32 v63, 0
  s_mov_b32 s94, 0
  s_mov_b32 s95, 0
kva_kernel_fb_57:
  buffer_load_ushort v1, off, s[24:27], s95
  buffer_load_dword v62, v15, s[48:51], s94 offen offset:2304
  s_waitcnt vmcnt(0)
  v_lshlrev_b32 v1, 16, v1
  v_mul_f32 v61, 1069066811, v1
  v_exp_f32 v61, -v61
  s_nop 0
  v_add_f32 v61, 1.0, v61
  v_rcp_f32 v61, v61
  s_nop 0
  v_mul_f32 v1, v1, v61
  v_cvt_pk_bf16_f32 v1, v1, v1
  v_lshlrev_b32 v1, 16, v1
  v_lshlrev_b32 v61, 16, v62
  v_fmac_f32 v22, v61, v1
  v_and_b32 v61, 0xffff0000, v62
  v_fmac_f32 v63, v61, v1
  s_add_u32 s95, s95, 2
  s_add_u32 s94, s94, 7680
  s_cmp_lt_u32 s95, 1280
  s_cbranch_scc1 kva_kernel_fb_57
  v_cvt_pk_bf16_f32 v61, v22, v63
  v_lshlrev_b32 v22, 16, v61
  v_and_b32 v63, 0xffff0000, v61
  v_add_f32 v22, 1.0, v22
  v_add_f32 v63, 1.0, v63
  v_cvt_pk_bf16_f32 v22, v22, v63
  s_branch kva_kernel_lnc_8
kva_kernel_hsp_9:
  s_nop 15
  s_mov_b32 s75, 262144
kva_kernel_sp_58:
  s_sleep 2
  buffer_load_dword v17, v18, s[68:71], 0 offen sc1
  s_waitcnt vmcnt(0)
  v_and_b32 v17, v17, v19
  v_cmp_ne_u32 vcc, v17, v19
  s_cbranch_vccz kva_kernel_hok_10
  s_sub_u32 s75, s75, 1
  s_cmp_lg_u32 s75, 0
  s_cbranch_scc1 kva_kernel_sp_58
  s_branch kva_kernel_hok_10
kva_kernel_lnw_12:
  s_nop 15
  s_movk_i32 s95, 2000
kva_kernel_sp_59:
  s_sleep 2
  buffer_load_dword v21, v15, s[36:39], 0 offen sc1
  s_waitcnt vmcnt(0)
  v_and_b32 v21, v21, v63
  v_cmp_ne_u32 vcc, v21, v63
  s_cmp_eq_u64 vcc, 0
  s_cbranch_scc1 kva_kernel_lnb_13
  s_sub_u32 s95, s95, 1
  s_cmp_lg_u32 s95, 0
  s_cbranch_scc1 kva_kernel_sp_59
  v_mov_b32 v22, 0
  v_mov_b32 v63, 0
  s_mov_b32 s94, 0
  s_mov_b32 s95, 0
kva_kernel_fb_60:
  buffer_load_ushort v1, off, s[24:27], s95
  buffer_load_dword v62, v15, s[48:51], s94 offen offset:0
  s_waitcnt vmcnt(0)
  v_lshlrev_b32 v1, 16, v1
  v_mul_f32 v61, 1069066811, v1
  v_exp_f32 v61, -v61
  s_nop 0
  v_add_f32 v61, 1.0, v61
  v_rcp_f32 v61, v61
  s_nop 0
  v_mul_f32 v1, v1, v61
  v_cvt_pk_bf16_f32 v1, v1, v1
  v_lshlrev_b32 v1, 16, v1
  v_lshlrev_b32 v61, 16, v62
  v_fmac_f32 v22, v61, v1
  v_and_b32 v61, 0xffff0000, v62
  v_fmac_f32 v63, v61, v1
  s_add_u32 s95, s95, 2
  s_add_u32 s94, s94, 7680
  s_cmp_lt_u32 s95, 1280
  s_cbranch_scc1 kva_kernel_fb_60
  v_cvt_pk_bf16_f32 v24, v22, v63
  v_mov_b32 v22, 0
  v_mov_b32 v63, 0
  s_mov_b32 s94, 0
  s_mov_b32 s95, 0
kva_kernel_fb_61:
  buffer_load_ushort v1, off, s[24:27], s95
  buffer_load_dword v62, v15, s[48:51], s94 offen offset:256
  s_waitcnt vmcnt(0)
  v_lshlrev_b32 v1, 16, v1
  v_mul_f32 v61, 1069066811, v1
  v_exp_f32 v61, -v61
  s_nop 0
  v_add_f32 v61, 1.0, v61
  v_rcp_f32 v61, v61
  s_nop 0
  v_mul_f32 v1, v1, v61
  v_cvt_pk_bf16_f32 v1, v1, v1
  v_lshlrev_b32 v1, 16, v1
  v_lshlrev_b32 v61, 16, v62
  v_fmac_f32 v22, v61, v1
  v_and_b32 v61, 0xffff0000, v62
  v_fmac_f32 v63, v61, v1
  s_add_u32 s95, s95, 2
  s_add_u32 s94, s94, 7680
  s_cmp_lt_u32 s95, 1280
  s_cbranch_scc1 kva_kernel_fb_61
  v_cvt_pk_bf16_f32 v25, v22, v63
  v_mov_b32 v22, 0
  v_mov_b32 v63, 0
  s_mov_b32 s94, 0
  s_mov_b32 s95, 0
kva_kernel_fb_62:
  buffer_load_ushort v1, off, s[24:27], s95
  buffer_load_dword v62, v15, s[48:51], s94 offen offset:512
  s_waitcnt vmcnt(0)
  v_lshlrev_b32 v1, 16, v1
  v_mul_f32 v61, 1069066811, v1
  v_exp_f32 v61, -v61
  s_nop 0
  v_add_f32 v61, 1.0, v61
  v_rcp_f32 v61, v61
  s_nop 0
  v_mul_f32 v1, v1, v61
  v_cvt_pk_bf16_f32 v1, v1, v1
  v_lshlrev_b32 v1, 16, v1
  v_lshlrev_b32 v61, 16, v62
  v_fmac_f32 v22, v61, v1
  v_and_b32 v61, 0xffff0000, v62
  v_fmac_f32 v63, v61, v1
  s_add_u32 s95, s95, 2
  s_add_u32 s94, s94, 7680
  s_cmp_lt_u32 s95, 1280
  s_cbranch_scc1 kva_kernel_fb_62
  v_cvt_pk_bf16_f32 v26, v22, v63
  v_mov_b32 v22, 0
  v_mov_b32 v63, 0
  s_mov_b32 s94, 0
  s_mov_b32 s95, 0
kva_kernel_fb_63:
  buffer_load_ushort v1, off, s[24:27], s95
  buffer_load_dword v62, v15, s[48:51], s94 offen offset:768
  s_waitcnt vmcnt(0)
  v_lshlrev_b32 v1, 16, v1
  v_mul_f32 v61, 1069066811, v1
  v_exp_f32 v61, -v61
  s_nop 0
  v_add_f32 v61, 1.0, v61
  v_rcp_f32 v61, v61
  s_nop 0
  v_mul_f32 v1, v1, v61
  v_cvt_pk_bf16_f32 v1, v1, v1
  v_lshlrev_b32 v1, 16, v1
  v_lshlrev_b32 v61, 16, v62
  v_fmac_f32 v22, v61, v1
  v_and_b32 v61, 0xffff0000, v62
  v_fmac_f32 v63, v61, v1
  s_add_u32 s95, s95, 2
  s_add_u32 s94, s94, 7680
  s_cmp_lt_u32 s95, 1280
  s_cbranch_scc1 kva_kernel_fb_63
  v_cvt_pk_bf16_f32 v27, v22, v63
  v_mov_b32 v22, 0
  v_mov_b32 v63, 0
  s_mov_b32 s94, 0
  s_mov_b32 s95, 0
kva_kernel_fb_64:
  buffer_load_ushort v1, off, s[24:27], s95
  buffer_load_dword v62, v15, s[48:51], s94 offen offset:1024
  s_waitcnt vmcnt(0)
  v_lshlrev_b32 v1, 16, v1
  v_mul_f32 v61, 1069066811, v1
  v_exp_f32 v61, -v61
  s_nop 0
  v_add_f32 v61, 1.0, v61
  v_rcp_f32 v61, v61
  s_nop 0
  v_mul_f32 v1, v1, v61
  v_cvt_pk_bf16_f32 v1, v1, v1
  v_lshlrev_b32 v1, 16, v1
  v_lshlrev_b32 v61, 16, v62
  v_fmac_f32 v22, v61, v1
  v_and_b32 v61, 0xffff0000, v62
  v_fmac_f32 v63, v61, v1
  s_add_u32 s95, s95, 2
  s_add_u32 s94, s94, 7680
  s_cmp_lt_u32 s95, 1280
  s_cbranch_scc1 kva_kernel_fb_64
  v_cvt_pk_bf16_f32 v28, v22, v63
  v_mov_b32 v22, 0
  v_mov_b32 v63, 0
  s_mov_b32 s94, 0
  s_mov_b32 s95, 0
kva_kernel_fb_65:
  buffer_load_ushort v1, off, s[24:27], s95
  buffer_load_dword v62, v15, s[48:51], s94 offen offset:1280
  s_waitcnt vmcnt(0)
  v_lshlrev_b32 v1, 16, v1
  v_mul_f32 v61, 1069066811, v1
  v_exp_f32 v61, -v61
  s_nop 0
  v_add_f32 v61, 1.0, v61
  v_rcp_f32 v61, v61
  s_nop 0
  v_mul_f32 v1, v1, v61
  v_cvt_pk_bf16_f32 v1, v1, v1
  v_lshlrev_b32 v1, 16, v1
  v_lshlrev_b32 v61, 16, v62
  v_fmac_f32 v22, v61, v1
  v_and_b32 v61, 0xffff0000, v62
  v_fmac_f32 v63, v61, v1
  s_add_u32 s95, s95, 2
  s_add_u32 s94, s94, 7680
  s_cmp_lt_u32 s95, 1280
  s_cbranch_scc1 kva_kernel_fb_65
  v_cvt_pk_bf16_f32 v61, v22, v63
  v_lshlrev_b32 v22, 16, v61
  v_and_b32 v63, 0xffff0000, v61
  v_add_f32 v22, 1.0, v22
  v_add_f32 v63, 1.0, v63
  v_cvt_pk_bf16_f32 v29, v22, v63
  v_mov_b32 v22, 0
  v_mov_b32 v63, 0
  s_mov_b32 s94, 0
  s_mov_b32 s95, 0
kva_kernel_fb_66:
  buffer_load_ushort v1, off, s[24:27], s95
  buffer_load_dword v62, v15, s[48:51], s94 offen offset:1536
  s_waitcnt vmcnt(0)
  v_lshlrev_b32 v1, 16, v1
  v_mul_f32 v61, 1069066811, v1
  v_exp_f32 v61, -v61
  s_nop 0
  v_add_f32 v61, 1.0, v61
  v_rcp_f32 v61, v61
  s_nop 0
  v_mul_f32 v1, v1, v61
  v_cvt_pk_bf16_f32 v1, v1, v1
  v_lshlrev_b32 v1, 16, v1
  v_lshlrev_b32 v61, 16, v62
  v_fmac_f32 v22, v61, v1
  v_and_b32 v61, 0xffff0000, v62
  v_fmac_f32 v63, v61, v1
  s_add_u32 s95, s95, 2
  s_add_u32 s94, s94, 7680
  s_cmp_lt_u32 s95, 1280
  s_cbranch_scc1 kva_kernel_fb_66
  v_cvt_pk_bf16_f32 v61, v22, v63
  v_lshlrev_b32 v22, 16, v61
  v_and_b32 v63, 0xffff0000, v61
  v_add_f32 v22, 1.0, v22
  v_add_f32 v63, 1.0, v63
  v_cvt_pk_bf16_f32 v30, v22, v63
  v_mov_b32 v22, 0
  v_mov_b32 v63, 0
  s_mov_b32 s94, 0
  s_mov_b32 s95, 0
kva_kernel_fb_67:
  buffer_load_ushort v1, off, s[24:27], s95
  buffer_load_dword v62, v15, s[48:51], s94 offen offset:1792
  s_waitcnt vmcnt(0)
  v_lshlrev_b32 v1, 16, v1
  v_mul_f32 v61, 1069066811, v1
  v_exp_f32 v61, -v61
  s_nop 0
  v_add_f32 v61, 1.0, v61
  v_rcp_f32 v61, v61
  s_nop 0
  v_mul_f32 v1, v1, v61
  v_cvt_pk_bf16_f32 v1, v1, v1
  v_lshlrev_b32 v1, 16, v1
  v_lshlrev_b32 v61, 16, v62
  v_fmac_f32 v22, v61, v1
  v_and_b32 v61, 0xffff0000, v62
  v_fmac_f32 v63, v61, v1
  s_add_u32 s95, s95, 2
  s_add_u32 s94, s94, 7680
  s_cmp_lt_u32 s95, 1280
  s_cbranch_scc1 kva_kernel_fb_67
  v_cvt_pk_bf16_f32 v61, v22, v63
  v_lshlrev_b32 v22, 16, v61
  v_and_b32 v63, 0xffff0000, v61
  v_add_f32 v22, 1.0, v22
  v_add_f32 v63, 1.0, v63
  v_cvt_pk_bf16_f32 v31, v22, v63
  v_mov_b32 v22, 0
  v_mov_b32 v63, 0
  s_mov_b32 s94, 0
  s_mov_b32 s95, 0
kva_kernel_fb_68:
  buffer_load_ushort v1, off, s[24:27], s95
  buffer_load_dword v62, v15, s[48:51], s94 offen offset:2048
  s_waitcnt vmcnt(0)
  v_lshlrev_b32 v1, 16, v1
  v_mul_f32 v61, 1069066811, v1
  v_exp_f32 v61, -v61
  s_nop 0
  v_add_f32 v61, 1.0, v61
  v_rcp_f32 v61, v61
  s_nop 0
  v_mul_f32 v1, v1, v61
  v_cvt_pk_bf16_f32 v1, v1, v1
  v_lshlrev_b32 v1, 16, v1
  v_lshlrev_b32 v61, 16, v62
  v_fmac_f32 v22, v61, v1
  v_and_b32 v61, 0xffff0000, v62
  v_fmac_f32 v63, v61, v1
  s_add_u32 s95, s95, 2
  s_add_u32 s94, s94, 7680
  s_cmp_lt_u32 s95, 1280
  s_cbranch_scc1 kva_kernel_fb_68
  v_cvt_pk_bf16_f32 v61, v22, v63
  v_lshlrev_b32 v22, 16, v61
  v_and_b32 v63, 0xffff0000, v61
  v_add_f32 v22, 1.0, v22
  v_add_f32 v63, 1.0, v63
  v_cvt_pk_bf16_f32 v21, v22, v63
  v_mov_b32 v22, 0
  v_mov_b32 v63, 0
  s_mov_b32 s94, 0
  s_mov_b32 s95, 0
kva_kernel_fb_69:
  buffer_load_ushort v1, off, s[24:27], s95
  buffer_load_dword v62, v15, s[48:51], s94 offen offset:2304
  s_waitcnt vmcnt(0)
  v_lshlrev_b32 v1, 16, v1
  v_mul_f32 v61, 1069066811, v1
  v_exp_f32 v61, -v61
  s_nop 0
  v_add_f32 v61, 1.0, v61
  v_rcp_f32 v61, v61
  s_nop 0
  v_mul_f32 v1, v1, v61
  v_cvt_pk_bf16_f32 v1, v1, v1
  v_lshlrev_b32 v1, 16, v1
  v_lshlrev_b32 v61, 16, v62
  v_fmac_f32 v22, v61, v1
  v_and_b32 v61, 0xffff0000, v62
  v_fmac_f32 v63, v61, v1
  s_add_u32 s95, s95, 2
  s_add_u32 s94, s94, 7680
  s_cmp_lt_u32 s95, 1280
  s_cbranch_scc1 kva_kernel_fb_69
  v_cvt_pk_bf16_f32 v61, v22, v63
  v_lshlrev_b32 v22, 16, v61
  v_and_b32 v63, 0xffff0000, v61
  v_add_f32 v22, 1.0, v22
  v_add_f32 v63, 1.0, v63
  v_cvt_pk_bf16_f32 v22, v22, v63
  s_branch kva_kernel_lnc_14
kva_kernel_hsp_15:
  s_nop 15
  s_mov_b32 s75, 262144
kva_kernel_sp_70:
  s_sleep 2
  buffer_load_dword v17, v18, s[68:71], 0 offen sc1
  s_waitcnt vmcnt(0)
  v_and_b32 v17, v17, v19
  v_cmp_ne_u32 vcc, v17, v19
  s_cbranch_vccz kva_kernel_hok_16
  s_sub_u32 s75, s75, 1
  s_cmp_lg_u32 s75, 0
  s_cbranch_scc1 kva_kernel_sp_70
  s_branch kva_kernel_hok_16
.Lend_kva_kernel:
.globl tail_kernel
.p2align 8
.type tail_kernel,@function
tail_kernel:
  s_load_dwordx2 s[4:5], s[0:1], 0
  s_load_dwordx2 s[8:9], s[0:1], 120
  s_load_dwordx2 s[12:13], s[0:1], 104
  s_load_dwordx2 s[16:17], s[0:1], 56
  s_waitcnt lgkmcnt(0)
  s_mov_b32 s6, 2621440
  s_mov_b32 s7, 0x00020000
  s_mov_b32 s10, 268435456
  s_mov_b32 s11, 0x00020000
  s_mov_b32 s14, 2621440
  s_mov_b32 s15, 0x00020000
  s_mov_b32 s18, 1280
  s_mov_b32 s19, 0x00020000
  s_cmp_lt_u32 s2, 256
  s_cbranch_scc1 tail_kernel_go_1
  s_endpgm
tail_kernel_go_1:
  v_lshrrev_b32 v1, 6, v0
  v_and_b32 v0, 63, v0
  v_readfirstlane_b32 s32, v1
  s_and_b32 s33, s2, 7
  s_lshr_b32 s34, s2, 3
  s_mul_i32 s36, s33, 27
  s_add_u32 s36, s36, s34
  s_mul_i32 s37, s33, 5
  s_add_u32 s37, s37, s34
  s_sub_u32 s37, s37, 27
  s_cmp_ge_u32 s34, 27
  s_cselect_b32 s35, s37, s36
  s_cselect_b32 s43, 1, 0
  s_mov_b32 s44, 0xffff0000
  s_cmp_ge_u32 s32, 10
  s_cbranch_scc1 tail_kernel_dma_2
  s_cmp_ge_u32 s32, 5
  s_cselect_b32 s38, 1, 0
  s_mul_i32 s36, s38, 5
  s_sub_u32 s39, s32, s36
  v_lshlrev_b32 v2, 4, v0
  s_lshl_b32 s36, s2, 1
  s_add_u32 s36, s36, s38
  s_mul_i32 s40, s36, 5120
  s_lshl_b32 s37, s39, 10
  s_add_u32 s36, s40, s37
  s_add_u32 s36, s36, 67108864
  buffer_load_dwordx4 v[32:35], v2, s[8:11], s36 offen
  s_add_u32 s36, s36, 2621440
  buffer_load_dwordx4 v[36:39], v2, s[8:11], s36 offen
  s_add_u32 s36, s36, 2621440
  buffer_load_dwordx4 v[40:43], v2, s[8:11], s36 offen
  s_add_u32 s36, s36, 2621440
  buffer_load_dwordx4 v[44:47], v2, s[8:11], s36 offen
  v_and_b32 v6, 3, v0
  v_lshrrev_b32 v8, 2, v0
  v_lshlrev_b32 v5, 4, v8
  v_lshlrev_b32 v4, 5, v8
  v_mul_u32_u24 v3, 1280, v6
  v_add_u32 v3, v3, v5
  s_lshl_b32 s37, s39, 8
  s_add_u32 s40, s40, s37
  buffer_load_dwordx4 v[48:51], v3, s[4:7], s40 offen
  s_lshl_b32 s36, s39, 9
  s_add_u32 s42, s36, 5120
  buffer_load_dwordx4 v[52:55], v4, s[8:11], s42 offen offset:0
  buffer_load_dwordx4 v[56:59], v4, s[8:11], s42 offen offset:16
  s_add_u32 s42, s36, 10240
  buffer_load_dwordx4 v[60:63], v4, s[8:11], s42 offen offset:0
  buffer_load_dwordx4 v[64:67], v4, s[8:11], s42 offen offset:16
  s_add_u32 s42, s36, 7680
  buffer_load_dwordx4 v[68:71], v4, s[8:11], s42 offen offset:0
  buffer_load_dwordx4 v[72:75], v4, s[8:11], s42 offen offset:16
  s_add_u32 s42, s36, 12800
  buffer_load_dwordx4 v[76:79], v4, s[8:11], s42 offen offset:0
  buffer_load_dwordx4 v[80:83], v4, s[8:11], s42 offen offset:16
  buffer_load_dwordx4 v[84:87], v5, s[16:19], s37 offen
  s_lshl_b32 s36, s38, 8
  v_lshlrev_b32 v7, 6, v6
  v_add_u32 v7, s36, v7
  s_lshl_b32 s36, s39, 3
  v_add_u32 v15, s36, v7
  s_waitcnt vmcnt(13)
  v_lshlrev_b32 v16, 16, v32
  v_and_b32 v17, 0xffff0000, v32
  v_lshlrev_b32 v18, 16, v33
  v_and_b32 v19, 0xffff0000, v33
  v_lshlrev_b32 v20, 16, v34
  v_and_b32 v21, 0xffff0000, v34
  v_lshlrev_b32 v22, 16, v35
  v_and_b32 v23, 0xffff0000, v35
  s_waitcnt vmcnt(12)
  v_lshlrev_b32 v24, 16, v36
  v_and_b32 v25, 0xffff0000, v36
  v_lshlrev_b32 v26, 16, v37
  v_and_b32 v27, 0xffff0000, v37
  v_lshlrev_b32 v28, 16, v38
  v_and_b32 v29, 0xffff0000, v38
  v_lshlrev_b32 v30, 16, v39
  v_and_b32 v31, 0xffff0000, v39
  s_waitcnt vmcnt(11)
  v_lshlrev_b32 v8, 16, v40
  v_and_b32 v9, 0xffff0000, v40
  v_add_f32 v16, v16, v8
  v_add_f32 v17, v17, v9
  v_lshlrev_b32 v10, 16, v41
  v_and_b32 v11, 0xffff0000, v41
  v_add_f32 v18, v18, v10
  v_add_f32 v19, v19, v11
  v_lshlrev_b32 v8, 16, v42
  v_and_b32 v9, 0xffff0000, v42
  v_add_f32 v20, v20, v8
  v_add_f32 v21, v21, v9
  v_lshlrev_b32 v10, 16, v43
  v_and_b32 v11, 0xffff0000, v43
  v_add_f32 v22, v22, v10
  v_add_f32 v23, v23, v11
  s_waitcnt vmcnt(10)
  v_lshlrev_b32 v8, 16, v44
  v_and_b32 v9, 0xffff0000, v44
  v_add_f32 v24, v24, v8
  v_add_f32 v25, v25, v9
  v_lshlrev_b32 v10, 16, v45
  v_and_b32 v11, 0xffff0000, v45
  v_add_f32 v26, v26, v10
  v_add_f32 v27, v27, v11
  v_lshlrev_b32 v8, 16, v46
  v_and_b32 v9, 0xffff0000, v46
  v_add_f32 v28, v28, v8
  v_add_f32 v29, v29, v9
  v_lshlrev_b32 v10, 16, v47
  v_and_b32 v11, 0xffff0000, v47
  v_add_f32 v30, v30, v10
  v_add_f32 v31, v31, v11
  v_add_f32 v16, v16, v24
  v_add_f32 v17, v17, v25
  v_add_f32 v18, v18, v26
  v_add_f32 v19, v19, v27
  v_add_f32 v20, v20, v28
  v_add_f32 v21, v21, v29
  v_add_f32 v22, v22, v30
  v_add_f32 v23, v23, v31
  s_waitcnt vmcnt(7)
  v_cvt_pk_bf16_f32 v8, v16, v17
  v_lshlrev_b32 v16, 16, v8
  v_and_b32 v17, 0xffff0000, v8
  v_mul_f32 v16, v16, v52
  v_mul_f32 v17, v17, v53
  v_cvt_pk_bf16_f32 v8, v16, v17
  v_lshlrev_b32 v16, 16, v8
  v_and_b32 v17, 0xffff0000, v8
  v_lshlrev_b32 v8, 16, v48
  v_and_b32 v9, 0xffff0000, v48
  v_add_f32 v16, v16, v8
  v_add_f32 v17, v17, v9
  v_cvt_pk_bf16_f32 v48, v16, v17
  v_lshlrev_b32 v16, 16, v48
  v_and_b32 v17, 0xffff0000, v48
  v_cvt_pk_bf16_f32 v8, v18, v19
  v_lshlrev_b32 v18, 16, v8
  v_and_b32 v19, 0xffff0000, v8
  v_mul_f32 v18, v18, v54
  v_mul_f32 v19, v19, v55
  v_cvt_pk_bf16_f32 v8, v18, v19
  v_lshlrev_b32 v18, 16, v8
  v_and_b32 v19, 0xffff0000, v8
  v_lshlrev_b32 v8, 16, v49
  v_and_b32 v9, 0xffff0000, v49
  v_add_f32 v18, v18, v8
  v_add_f32 v19, v19, v9
  v_cvt_pk_bf16_f32 v49, v18, v19
  v_lshlrev_b32 v18, 16, v49
  v_and_b32 v19, 0xffff0000, v49
  v_cvt_pk_bf16_f32 v8, v20, v21
  v_lshlrev_b32 v20, 16, v8
  v_and_b32 v21, 0xffff0000, v8
  v_mul_f32 v20, v20, v56
  v_mul_f32 v21, v21, v57
  v_cvt_pk_bf16_f32 v8, v20, v21
  v_lshlrev_b32 v20, 16, v8
  v_and_b32 v21, 0xffff0000, v8
  v_lshlrev_b32 v8, 16, v50
  v_and_b32 v9, 0xffff0000, v50
  v_add_f32 v20, v20, v8
  v_add_f32 v21, v21, v9
  v_cvt_pk_bf16_f32 v50, v20, v21
  v_lshlrev_b32 v20, 16, v50
  v_and_b32 v21, 0xffff0000, v50
  v_cvt_pk_bf16_f32 v8, v22, v23
  v_lshlrev_b32 v22, 16, v8
  v_and_b32 v23, 0xffff0000, v8
  v_mul_f32 v22, v22, v58
  v_mul_f32 v23, v23, v59
  v_cvt_pk_bf16_f32 v8, v22, v23
  v_lshlrev_b32 v22, 16, v8
  v_and_b32 v23, 0xffff0000, v8
  v_lshlrev_b32 v8, 16, v51
  v_and_b32 v9, 0xffff0000, v51
  v_add_f32 v22, v22, v8
  v_add_f32 v23, v23, v9
  v_cvt_pk_bf16_f32 v51, v22, v23
  v_lshlrev_b32 v22, 16, v51
  v_and_b32 v23, 0xffff0000, v51
  s_add_u32 s36, s40, 4194304
  buffer_store_dwordx4 v[48:51], v3, s[8:11], s36 offen sc1
  v_add_f32 v10, v16, v17
  v_add_f32 v11, v18, v19
  v_add_f32 v12, v20, v21
  v_add_f32 v13, v22, v23
  v_add_f32 v10, v10, v11
  v_add_f32 v12, v12, v13
  v_add_f32 v10, v10, v12
  s_nop 1
  v_add_f32_dpp v10, v10, v10 row_ror:4 row_mask:0xf bank_mask:0xf
  s_nop 1
  v_add_f32_dpp v10, v10, v10 row_ror:8 row_mask:0xf bank_mask:0xf
  v_mov_b32 v13, v10
  s_nop 1
  v_permlane32_swap_b32 v10, v13
  v_add_f32 v10, v10, v13
  v_mov_b32 v13, v10
  s_nop 1
  v_permlane16_swap_b32 v10, v13
  v_add_f32 v10, v10, v13
  v_mul_f32 v12, 0x3c000000, v10
  v_sub_f32 v24, v16, v12
  v_sub_f32 v25, v17, v12
  v_sub_f32 v26, v18, v12
  v_sub_f32 v27, v19, v12
  v_sub_f32 v28, v20, v12
  v_sub_f32 v29, v21, v12
  v_sub_f32 v30, v22, v12
  v_sub_f32 v31, v23, v12
  v_mul_f32 v11, v24, v24
  v_mul_f32 v13, v25, v25
  v_fmac_f32 v11, v26, v26
  v_fmac_f32 v13, v27, v27
  v_fmac_f32 v11, v28, v28
  v_fmac_f32 v13, v29, v29
  v_fmac_f32 v11, v30, v30
  v_fmac_f32 v13, v31, v31
  v_add_f32 v11, v11, v13
  s_nop 1
  v_add_f32_dpp v11, v11, v11 row_ror:4 row_mask:0xf bank_mask:0xf
  s_nop 1
  v_add_f32_dpp v11, v11, v11 row_ror:8 row_mask:0xf bank_mask:0xf
  v_mov_b32 v13, v11
  s_nop 1
  v_permlane32_swap_b32 v11, v13
  v_add_f32 v11, v11, v13
  v_mov_b32 v13, v11
  s_nop 1
  v_permlane16_swap_b32 v11, v13
  v_add_f32 v11, v11, v13
  ds_write_b64 v15, v[10:11] offset:55296
  s_waitcnt lgkmcnt(0)
  s_barrier
  ds_read_b128 v[24:27], v7 offset:55296
  ds_read_b128 v[28:31], v7 offset:55312
  ds_read_b64 v[32:33], v7 offset:55328
  s_waitcnt vmcnt(6)
  v_add_f32 v60, 1.0, v60
  v_add_f32 v61, 1.0, v61
  v_cvt_pk_bf16_f32 v8, v60, v61
  v_lshlrev_b32 v60, 16, v8
  v_and_b32 v61, 0xffff0000, v8
  v_add_f32 v62, 1.0, v62
  v_add_f32 v63, 1.0, v63
  v_cvt_pk_bf16_f32 v8, v62, v63
  v_lshlrev_b32 v62, 16, v8
  v_and_b32 v63, 0xffff0000, v8
  v_add_f32 v64, 1.0, v64
  v_add_f32 v65, 1.0, v65
  v_cvt_pk_bf16_f32 v8, v64, v65
  v_lshlrev_b32 v64, 16, v8
  v_and_b32 v65, 0xffff0000, v8
  v_add_f32 v66, 1.0, v66
  v_add_f32 v67, 1.0, v67
  v_cvt_pk_bf16_f32 v8, v66, v67
  v_lshlrev_b32 v66, 16, v8
  v_and_b32 v67, 0xffff0000, v8
  s_waitcnt lgkmcnt(0)
  v_add_f32 v10, v24, v26
  v_add_f32 v13, v28, v30
  v_add_f32 v11, v25, v27
  v_add_f32 v10, v10, v32
  v_add_f32 v11, v11, v29
  v_add_f32 v10, v10, v13
  v_add_f32 v11, v11, v31
  v_mul_f32 v12, 0x3acccccd, v10
  v_add_f32 v11, v11, v33
  v_mov_b32 v13, 0x3c000000
  v_fma_f32 v24, v24, v13, -v12
  v_fma_f32 v26, v26, v13, -v12
  v_fma_f32 v28, v28, v13, -v12
  v_fma_f32 v30, v30, v13, -v12
  v_fma_f32 v32, v32, v13, -v12
  v_mul_f32 v10, v24, v24
  v_fmac_f32 v10, v26, v26
  v_fmac_f32 v10, v28, v28
  v_fmac_f32 v10, v30, v30
  v_fmac_f32 v10, v32, v32
  v_mul_f32 v10, 0x43000000, v10
  v_add_f32 v10, v10, v11
  v_mul_f32 v10, 0x3acccccd, v10
  v_cvt_pk_bf16_f32 v13, v10, v12
  v_lshlrev_b32 v10, 16, v13
  v_and_b32 v12, 0xffff0000, v13
  v_add_f32 v10, 0x3727c5ac, v10
  v_cvt_pk_bf16_f32 v10, v10, v10
  v_lshlrev_b32 v10, 16, v10
  v_sqrt_f32 v10, v10
  s_nop 0
  v_cvt_pk_bf16_f32 v10, v10, v10
  v_lshlrev_b32 v10, 16, v10
  v_rcp_f32 v10, v10
  s_waitcnt vmcnt(4)
  v_sub_f32 v16, v16, v12
  v_sub_f32 v17, v17, v12
  v_cvt_pk_bf16_f32 v8, v16, v17
  v_lshlrev_b32 v16, 16, v8
  v_and_b32 v17, 0xffff0000, v8
  v_mul_f32 v16, v16, v10
  v_mul_f32 v17, v17, v10
  v_cvt_pk_bf16_f32 v8, v16, v17
  v_lshlrev_b32 v16, 16, v8
  v_and_b32 v17, 0xffff0000, v8
  v_mul_f32 v16, v16, v60
  v_mul_f32 v17, v17, v61
  v_cvt_pk_bf16_f32 v8, v16, v17
  v_lshlrev_b32 v16, 16, v8
  v_and_b32 v17, 0xffff0000, v8
  v_add_f32 v16, v16, v68
  v_add_f32 v17, v17, v69
  v_cvt_pk_bf16_f32 v88, v16, v17
  v_sub_f32 v18, v18, v12
  v_sub_f32 v19, v19, v12
  v_cvt_pk_bf16_f32 v8, v18, v19
  v_lshlrev_b32 v18, 16, v8
  v_and_b32 v19, 0xffff0000, v8
  v_mul_f32 v18, v18, v10
  v_mul_f32 v19, v19, v10
  v_cvt_pk_bf16_f32 v8, v18, v19
  v_lshlrev_b32 v18, 16, v8
  v_and_b32 v19, 0xffff0000, v8
  v_mul_f32 v18, v18, v62
  v_mul_f32 v19, v19, v63
  v_cvt_pk_bf16_f32 v8, v18, v19
  v_lshlrev_b32 v18, 16, v8
  v_and_b32 v19, 0xffff0000, v8
  v_add_f32 v18, v18, v70
  v_add_f32 v19, v19, v71
  v_cvt_pk_bf16_f32 v89, v18, v19
  v_sub_f32 v20, v20, v12
  v_sub_f32 v21, v21, v12
  v_cvt_pk_bf16_f32 v8, v20, v21
  v_lshlrev_b32 v20, 16, v8
  v_and_b32 v21, 0xffff0000, v8
  v_mul_f32 v20, v20, v10
  v_mul_f32 v21, v21, v10
  v_cvt_pk_bf16_f32 v8, v20, v21
  v_lshlrev_b32 v20, 16, v8
  v_and_b32 v21, 0xffff0000, v8
  v_mul_f32 v20, v20, v64
  v_mul_f32 v21, v21, v65
  v_cvt_pk_bf16_f32 v8, v20, v21
  v_lshlrev_b32 v20, 16, v8
  v_and_b32 v21, 0xffff0000, v8
  v_add_f32 v20, v20, v72
  v_add_f32 v21, v21, v73
  v_cvt_pk_bf16_f32 v90, v20, v21
  v_sub_f32 v22, v22, v12
  v_sub_f32 v23, v23, v12
  v_cvt_pk_bf16_f32 v8, v22, v23
  v_lshlrev_b32 v22, 16, v8
  v_and_b32 v23, 0xffff0000, v8
  v_mul_f32 v22, v22, v10
  v_mul_f32 v23, v23, v10
  v_cvt_pk_bf16_f32 v8, v22, v23
  v_lshlrev_b32 v22, 16, v8
  v_and_b32 v23, 0xffff0000, v8
  v_mul_f32 v22, v22, v66
  v_mul_f32 v23, v23, v67
  v_cvt_pk_bf16_f32 v8, v22, v23
  v_lshlrev_b32 v22, 16, v8
  v_and_b32 v23, 0xffff0000, v8
  v_add_f32 v22, v22, v74
  v_add_f32 v23, v23, v75
  v_cvt_pk_bf16_f32 v91, v22, v23
  s_add_u32 s36, s40, 7340032
  buffer_store_dwordx4 v[88:91], v3, s[8:11], s36 offen sc1
  s_waitcnt vmcnt(2)
  v_lshlrev_b32 v16, 16, v88
  v_and_b32 v17, 0xffff0000, v88
  v_lshlrev_b32 v8, 16, v84
  v_and_b32 v9, 0xffff0000, v84
  v_mul_f32 v10, v16, v8
  v_mul_f32 v11, v17, v9
  v_lshlrev_b32 v18, 16, v89
  v_and_b32 v19, 0xffff0000, v89
  v_lshlrev_b32 v8, 16, v85
  v_and_b32 v9, 0xffff0000, v85
  v_fmac_f32 v10, v18, v8
  v_fmac_f32 v11, v19, v9
  v_lshlrev_b32 v20, 16, v90
  v_and_b32 v21, 0xffff0000, v90
  v_lshlrev_b32 v8, 16, v86
  v_and_b32 v9, 0xffff0000, v86
  v_fmac_f32 v10, v20, v8
  v_fmac_f32 v11, v21, v9
  v_lshlrev_b32 v22, 16, v91
  v_and_b32 v23, 0xffff0000, v91
  v_lshlrev_b32 v8, 16, v87
  v_and_b32 v9, 0xffff0000, v87
  v_fmac_f32 v10, v22, v8
  v_fmac_f32 v11, v23, v9
  v_add_f32 v10, v10, v11
  s_nop 1
  v_add_f32_dpp v10, v10, v10 row_ror:4 row_mask:0xf bank_mask:0xf
  s_nop 1
  v_add_f32_dpp v10, v10, v10 row_ror:8 row_mask:0xf bank_mask:0xf
  v_mov_b32 v13, v10
  s_nop 1
  v_permlane32_swap_b32 v10, v13
  v_add_f32 v10, v10, v13
  v_mov_b32 v13, v10
  s_nop 1
  v_permlane16_swap_b32 v10, v13
  v_add_f32 v10, v10, v13
  v_lshrrev_b32 v15, 1, v15
  ds_write_b32 v15, v10 offset:55808
  v_mul_f32 v16, v16, v76
  v_mul_f32 v17, v17, v77
  v_cvt_pk_bf16_f32 v8, v16, v17
  v_lshlrev_b32 v16, 16, v8
  v_and_b32 v17, 0xffff0000, v8
  v_lshlrev_b32 v8, 16, v48
  v_and_b32 v9, 0xffff0000, v48
  v_add_f32 v16, v16, v8
  v_add_f32 v17, v17, v9
  v_cvt_pk_bf16_f32 v92, v16, v17
  v_mul_f32 v18, v18, v78
  v_mul_f32 v19, v19, v79
  v_cvt_pk_bf16_f32 v8, v18, v19
  v_lshlrev_b32 v18, 16, v8
  v_and_b32 v19, 0xffff0000, v8
  v_lshlrev_b32 v8, 16, v49
  v_and_b32 v9, 0xffff0000, v49
  v_add_f32 v18, v18, v8
  v_add_f32 v19, v19, v9
  v_cvt_pk_bf16_f32 v93, v18, v19
  v_mul_f32 v20, v20, v80
  v_mul_f32 v21, v21, v81
  v_cvt_pk_bf16_f32 v8, v20, v21
  v_lshlrev_b32 v20, 16, v8
  v_and_b32 v21, 0xffff0000, v8
  v_lshlrev_b32 v8, 16, v50
  v_and_b32 v9, 0xffff0000, v50
  v_add_f32 v20, v20, v8
  v_add_f32 v21, v21, v9
  v_cvt_pk_bf16_f32 v94, v20, v21
  v_mul_f32 v22, v22, v82
  v_mul_f32 v23, v23, v83
  v_cvt_pk_bf16_f32 v8, v22, v23
  v_lshlrev_b32 v22, 16, v8
  v_and_b32 v23, 0xffff0000, v8
  v_lshlrev_b32 v8, 16, v51
  v_and_b32 v9, 0xffff0000, v51
  v_add_f32 v22, v22, v8
  v_add_f32 v23, v23, v9
  v_cvt_pk_bf16_f32 v95, v22, v23
  s_waitcnt vmcnt(0) lgkmcnt(0)
  s_barrier
  s_cmp_lg_u32 s32, 0
  s_cbranch_scc1 tail_kernel_nk_3
  v_and_b32 v8, 7, v0
  v_lshlrev_b32 v9, 5, v8
  ds_read_b128 v[16:19], v9 offset:55808
  ds_read_b32 v20, v9 offset:55824
  s_lshl_b32 s36, s2, 3
  v_add_u32 v10, s36, v8
  v_sub_u32 v11, 34815, v10
  v_lshlrev_b32 v10, 2, v10
  v_lshlrev_b32 v8, 2, v8
  s_waitcnt lgkmcnt(0)
  v_add_f32 v16, v16, v17
  v_add_f32 v18, v18, v19
  v_add_f32 v16, v16, v20
  v_add_f32 v16, v16, v18
  v_cvt_pk_bf16_f32 v16, v16, v16
  v_ashrrev_i32 v17, 31, v16
  v_or_b32 v17, 0x80000000, v17
  v_xor_b32 v16, v16, v17
  v_and_or_b32 v16, v16, s44, v11
  s_mov_b32 s36, 65536
  v_lshrrev_b32 v9, 3, v0
  v_lshl_add_u32 v10, v9, 13, v10
  buffer_store_dword v16, v10, s[8:11], s36 offen sc1
  v_cmp_gt_u32 vcc, 8, v0
  s_and_saveexec_b64 s[46:47], vcc
  ds_write_b32 v8, v16 offset:56064
  s_mov_b64 exec, s[46:47]
tail_kernel_nk_3:
  s_cmp_ge_u32 s32, 8
  s_cbranch_scc1 tail_kernel_b3_4
  s_lshl_b32 s36, s32, 10
  s_add_u32 s36, s36, 65536
  s_lshl_b32 s41, s33, 13
  s_add_u32 s36, s36, s41
  s_mov_b32 s41, 0
tail_kernel_poll_5:
  buffer_load_dwordx4 v[16:19], v2, s[8:11], s36 offen sc1
  s_add_u32 s41, s41, 1
  s_waitcnt vmcnt(0)
  v_min3_u32 v20, v16, v17, v18
  v_min_u32 v20, v20, v19
  v_cmp_eq_u32 vcc, 0, v20
  s_and_b64 exec, exec, vcc
  s_cbranch_execz tail_kernel_pd_6
  s_cmp_lt_u32 s41, 262144
  s_cbranch_scc1 tail_kernel_poll_5
tail_kernel_pd_6:
  s_mov_b64 exec, -1
  s_mov_b32 s42, 0
  v_mov_b32 v24, 0
  v_max3_u32 v20, v16, v17, v18
  v_max_u32 v20, v20, v19
  s_nop 1
  v_max_u32_dpp v20, v20, v20 row_shr:1 row_mask:0xf bank_mask:0xf
  s_nop 1
  v_max_u32_dpp v20, v20, v20 row_shr:2 row_mask:0xf bank_mask:0xf
  s_nop 1
  v_max_u32_dpp v20, v20, v20 row_shr:4 row_mask:0xf bank_mask:0xf
  s_nop 1
  v_max_u32_dpp v20, v20, v20 row_shr:8 row_mask:0xf bank_mask:0xf
  s_nop 1
  v_max_u32_dpp v20, v20, v20 row_bcast:15 row_mask:0xa bank_mask:0xf
  s_nop 1
  v_max_u32_dpp v20, v20, v20 row_bcast:31 row_mask:0xc bank_mask:0xf
  s_nop 0
  v_readlane_b32 s36, v20, 63
  s_add_u32 s42, s42, s36
  v_writelane_b32 v24, s42, 0
  s_mov_b32 s50, s42
  v_subrev_u32 v20, s42, v16
  v_subrev_u32 v21, s42, v17
  v_subrev_u32 v22, s42, v18
  v_subrev_u32 v23, s42, v19
  v_max3_u32 v20, v20, v21, v22
  v_max_u32 v20, v20, v23
  s_nop 1
  v_max_u32_dpp v20, v20, v20 row_shr:1 row_mask:0xf bank_mask:0xf
  s_nop 1
  v_max_u32_dpp v20, v20, v20 row_shr:2 row_mask:0xf bank_mask:0xf
  s_nop 1
  v_max_u32_dpp v20, v20, v20 row_shr:4 row_mask:0xf bank_mask:0xf
  s_nop 1
  v_max_u32_dpp v20, v20, v20 row_shr:8 row_mask:0xf bank_mask:0xf
  s_nop 1
  v_max_u32_dpp v20, v20, v20 row_bcast:15 row_mask:0xa bank_mask:0xf
  s_nop 1
  v_max_u32_dpp v20, v20, v20 row_bcast:31 row_mask:0xc bank_mask:0xf
  s_nop 0
  v_readlane_b32 s36, v20, 63
  s_add_u32 s42, s42, s36
  v_writelane_b32 v24, s42, 1
  s_mov_b32 s51, s42
  v_subrev_u32 v20, s42, v16
  v_subrev_u32 v21, s42, v17
  v_subrev_u32 v22, s42, v18
  v_subrev_u32 v23, s42, v19
  v_max3_u32 v20, v20, v21, v22
  v_max_u32 v20, v20, v23
  s_nop 1
  v_max_u32_dpp v20, v20, v20 row_shr:1 row_mask:0xf bank_mask:0xf
  s_nop 1
  v_max_u32_dpp v20, v20, v20 row_shr:2 row_mask:0xf bank_mask:0xf
  s_nop 1
  v_max_u32_dpp v20, v20, v20 row_shr:4 row_mask:0xf bank_mask:0xf
  s_nop 1
  v_max_u32_dpp v20, v20, v20 row_shr:8 row_mask:0xf bank_mask:0xf
  s_nop 1
  v_max_u32_dpp v20, v20, v20 row_bcast:15 row_mask:0xa bank_mask:0xf
  s_nop 1
  v_max_u32_dpp v20, v20, v20 row_bcast:31 row_mask:0xc bank_mask:0xf
  s_nop 0
  v_readlane_b32 s36, v20, 63
  s_add_u32 s42, s42, s36
  v_writelane_b32 v24, s42, 2
  s_mov_b32 s52, s42
  v_subrev_u32 v20, s42, v16
  v_subrev_u32 v21, s42, v17
  v_subrev_u32 v22, s42, v18
  v_subrev_u32 v23, s42, v19
  v_max3_u32 v20, v20, v21, v22
  v_max_u32 v20, v20, v23
  s_nop 1
  v_max_u32_dpp v20, v20, v20 row_shr:1 row_mask:0xf bank_mask:0xf
  s_nop 1
  v_max_u32_dpp v20, v20, v20 row_shr:2 row_mask:0xf bank_mask:0xf
  s_nop 1
  v_max_u32_dpp v20, v20, v20 row_shr:4 row_mask:0xf bank_mask:0xf
  s_nop 1
  v_max_u32_dpp v20, v20, v20 row_shr:8 row_mask:0xf bank_mask:0xf
  s_nop 1
  v_max_u32_dpp v20, v20, v20 row_bcast:15 row_mask:0xa bank_mask:0xf
  s_nop 1
  v_max_u32_dpp v20, v20, v20 row_bcast:31 row_mask:0xc bank_mask:0xf
  s_nop 0
  v_readlane_b32 s36, v20, 63
  s_add_u32 s42, s42, s36
  v_writelane_b32 v24, s42, 3
  s_mov_b32 s53, s42
  v_subrev_u32 v20, s42, v16
  v_subrev_u32 v21, s42, v17
  v_subrev_u32 v22, s42, v18
  v_subrev_u32 v23, s42, v19
  v_max3_u32 v20, v20, v21, v22
  v_max_u32 v20, v20, v23
  s_nop 1
  v_max_u32_dpp v20, v20, v20 row_shr:1 row_mask:0xf bank_mask:0xf
  s_nop 1
  v_max_u32_dpp v20, v20, v20 row_shr:2 row_mask:0xf bank_mask:0xf
  s_nop 1
  v_max_u32_dpp v20, v20, v20 row_shr:4 row_mask:0xf bank_mask:0xf
  s_nop 1
  v_max_u32_dpp v20, v20, v20 row_shr:8 row_mask:0xf bank_mask:0xf
  s_nop 1
  v_max_u32_dpp v20, v20, v20 row_bcast:15 row_mask:0xa bank_mask:0xf
  s_nop 1
  v_max_u32_dpp v20, v20, v20 row_bcast:31 row_mask:0xc bank_mask:0xf
  s_nop 0
  v_readlane_b32 s36, v20, 63
  s_add_u32 s42, s42, s36
  v_writelane_b32 v24, s42, 4
  s_mov_b32 s54, s42
  v_subrev_u32 v20, s42, v16
  v_subrev_u32 v21, s42, v17
  v_subrev_u32 v22, s42, v18
  v_subrev_u32 v23, s42, v19
  v_max3_u32 v20, v20, v21, v22
  v_max_u32 v20, v20, v23
  s_nop 1
  v_max_u32_dpp v20, v20, v20 row_shr:1 row_mask:0xf bank_mask:0xf
  s_nop 1
  v_max_u32_dpp v20, v20, v20 row_shr:2 row_mask:0xf bank_mask:0xf
  s_nop 1
  v_max_u32_dpp v20, v20, v20 row_shr:4 row_mask:0xf bank_mask:0xf
  s_nop 1
  v_max_u32_dpp v20, v20, v20 row_shr:8 row_mask:0xf bank_mask:0xf
  s_nop 1
  v_max_u32_dpp v20, v20, v20 row_bcast:15 row_mask:0xa bank_mask:0xf
  s_nop 1
  v_max_u32_dpp v20, v20, v20 row_bcast:31 row_mask:0xc bank_mask:0xf
  s_nop 0
  v_readlane_b32 s36, v20, 63
  s_add_u32 s42, s42, s36
  v_writelane_b32 v24, s42, 5
  s_mov_b32 s55, s42
  v_subrev_u32 v20, s42, v16
  v_subrev_u32 v21, s42, v17
  v_subrev_u32 v22, s42, v18
  v_subrev_u32 v23, s42, v19
  v_max3_u32 v20, v20, v21, v22
  v_max_u32 v20, v20, v23
  s_nop 1
  v_max_u32_dpp v20, v20, v20 row_shr:1 row_mask:0xf bank_mask:0xf
  s_nop 1
  v_max_u32_dpp v20, v20, v20 row_shr:2 row_mask:0xf bank_mask:0xf
  s_nop 1
  v_max_u32_dpp v20, v20, v20 row_shr:4 row_mask:0xf bank_mask:0xf
  s_nop 1
  v_max_u32_dpp v20, v20, v20 row_shr:8 row_mask:0xf bank_mask:0xf
  s_nop 1
  v_max_u32_dpp v20, v20, v20 row_bcast:15 row_mask:0xa bank_mask:0xf
  s_nop 1
  v_max_u32_dpp v20, v20, v20 row_bcast:31 row_mask:0xc bank_mask:0xf
  s_nop 0
  v_readlane_b32 s36, v20, 63
  s_add_u32 s42, s42, s36
  v_writelane_b32 v24, s42, 6
  s_mov_b32 s56, s42
  v_subrev_u32 v20, s42, v16
  v_subrev_u32 v21, s42, v17
  v_subrev_u32 v22, s42, v18
  v_subrev_u32 v23, s42, v19
  v_max3_u32 v20, v20, v21, v22
  v_max_u32 v20, v20, v23
  s_nop 1
  v_max_u32_dpp v20, v20, v20 row_shr:1 row_mask:0xf bank_mask:0xf
  s_nop 1
  v_max_u32_dpp v20, v20, v20 row_shr:2 row_mask:0xf bank_mask:0xf
  s_nop 1
  v_max_u32_dpp v20, v20, v20 row_shr:4 row_mask:0xf bank_mask:0xf
  s_nop 1
  v_max_u32_dpp v20, v20, v20 row_shr:8 row_mask:0xf bank_mask:0xf
  s_nop 1
  v_max_u32_dpp v20, v20, v20 row_bcast:15 row_mask:0xa bank_mask:0xf
  s_nop 1
  v_max_u32_dpp v20, v20, v20 row_bcast:31 row_mask:0xc bank_mask:0xf
  s_nop 0
  v_readlane_b32 s36, v20, 63
  s_add_u32 s42, s42, s36
  v_writelane_b32 v24, s42, 7
  s_mov_b32 s57, s42
  s_lshl_b32 s36, s32, 5
  v_lshlrev_b32 v8, 2, v0
  v_add_u32 v8, s36, v8
  v_cmp_gt_u32 vcc, 8, v0
  s_and_saveexec_b64 s[46:47], vcc
  ds_write_b32 v8, v24 offset:56320
  s_mov_b64 exec, s[46:47]
tail_kernel_b3_4:
  s_waitcnt lgkmcnt(0)
  s_barrier
  v_lshlrev_b32 v8, 2, v0
  ds_read_b32 v16, v8 offset:56320
  s_lshl_b32 s36, s38, 4
  v_mov_b32 v9, s36
  ds_read_b128 v[20:23], v9 offset:56064
  v_lshrrev_b32 v10, 4, v0
  v_lshlrev_b32 v100, 8, v10
  v_bfe_u32 v11, v0, 2, 2
  v_lshl_add_u32 v100, v11, 5, v100
  v_lshl_add_u32 v100, v6, 3, v100
  s_mul_i32 s36, s32, 6144
  v_add_u32 v100, s36, v100
  s_waitcnt lgkmcnt(0)
  s_cmp_ge_u32 s32, 8
  s_cbranch_scc1 tail_kernel_nr_7
  v_mov_b32 v25, 64
  v_cmp_lt_u32 vcc, s50, v16
  s_bcnt1_i32_b64 s36, vcc
  v_writelane_b32 v25, s36, 0
  v_cmp_lt_u32 vcc, s51, v16
  s_bcnt1_i32_b64 s36, vcc
  v_writelane_b32 v25, s36, 1
  v_cmp_lt_u32 vcc, s52, v16
  s_bcnt1_i32_b64 s36, vcc
  v_writelane_b32 v25, s36, 2
  v_cmp_lt_u32 vcc, s53, v16
  s_bcnt1_i32_b64 s36, vcc
  v_writelane_b32 v25, s36, 3
  v_cmp_lt_u32 vcc, s54, v16
  s_bcnt1_i32_b64 s36, vcc
  v_writelane_b32 v25, s36, 4
  v_cmp_lt_u32 vcc, s55, v16
  s_bcnt1_i32_b64 s36, vcc
  v_writelane_b32 v25, s36, 5
  v_cmp_lt_u32 vcc, s56, v16
  s_bcnt1_i32_b64 s36, vcc
  v_writelane_b32 v25, s36, 6
  v_cmp_lt_u32 vcc, s57, v16
  s_bcnt1_i32_b64 s36, vcc
  v_writelane_b32 v25, s36, 7
  v_cmp_gt_u32 vcc, 8, v25
  v_lshlrev_b32 v25, 2, v25
  s_and_saveexec_b64 s[46:47], vcc
  ds_write_b32 v25, v24 offset:56576
  s_mov_b64 exec, s[46:47]
  s_waitcnt lgkmcnt(0)
tail_kernel_nr_7:
  s_barrier
  v_mov_b32 v11, 0
  v_cmp_gt_u32 vcc, v16, v20
  s_bcnt1_i32_b64 s36, vcc
  v_cmp_eq_u32 vcc, 0, v6
  v_mov_b32 v12, s36
  s_nop 0
  v_cndmask_b32 v11, v11, v12, vcc
  v_cmp_gt_u32 vcc, v16, v21
  s_bcnt1_i32_b64 s36, vcc
  v_cmp_eq_u32 vcc, 1, v6
  v_mov_b32 v12, s36
  s_nop 0
  v_cndmask_b32 v11, v11, v12, vcc
  v_cmp_gt_u32 vcc, v16, v22
  s_bcnt1_i32_b64 s36, vcc
  v_cmp_eq_u32 vcc, 2, v6
  v_mov_b32 v12, s36
  s_nop 0
  v_cndmask_b32 v11, v11, v12, vcc
  v_cmp_gt_u32 vcc, v16, v23
  s_bcnt1_i32_b64 s36, vcc
  v_cmp_eq_u32 vcc, 3, v6
  v_mov_b32 v12, s36
  s_nop 0
  v_cndmask_b32 v11, v11, v12, vcc
  v_cmp_lt_u32 vcc, 7, v11
  s_and_saveexec_b64 s[46:47], vcc
  buffer_store_dwordx4 v[92:95], v3, s[12:15], s40 offen
  s_mov_b64 exec, s[46:47]
  s_cmp_lt_u32 s32, 9
  s_cselect_b32 s36, s43, 0
  s_cmp_eq_u32 s36, 1
  s_cbranch_scc1 tail_kernel_dn_8
  s_endpgm
tail_kernel_dn_8:
  s_barrier
  ds_read_b64_tr_b16 v[104:105], v100 offset:0
  ds_read_b64_tr_b16 v[106:107], v100 offset:128
  ds_read_b64_tr_b16 v[108:109], v100 offset:1024
  ds_read_b64_tr_b16 v[110:111], v100 offset:1152
  ds_read_b64_tr_b16 v[112:113], v100 offset:2048
  ds_read_b64_tr_b16 v[114:115], v100 offset:2176
  ds_read_b64_tr_b16 v[116:117], v100 offset:3072
  ds_read_b64_tr_b16 v[118:119], v100 offset:3200
  ds_read_b64_tr_b16 v[120:121], v100 offset:4096
  ds_read_b64_tr_b16 v[122:123], v100 offset:4224
  ds_read_b64_tr_b16 v[124:125], v100 offset:5120
  ds_read_b64_tr_b16 v[126:127], v100 offset:5248
  v_and_b32 v8, 7, v0
  v_lshlrev_b32 v8, 4, v8
  v_lshl_add_u32 v8, v10, 7, v8
  s_mul_i32 s36, s32, 3072
  s_add_u32 s36, s36, 131072
  s_mov_b32 s41, 0
  v_and_b32 v11, 8, v0
  v_cmp_eq_u32 vcc, 0, v11
  v_mov_b32 v16, 0
  v_mov_b32 v17, 0
  v_mov_b32 v18, 0
  v_mov_b32 v19, 0
  v_mov_b32 v20, 0
  v_mov_b32 v21, 0
  v_mov_b32 v22, 0
  v_mov_b32 v23, 0
  v_mov_b32 v24, 0
  v_mov_b32 v25, 0
  v_mov_b32 v26, 0
  v_mov_b32 v27, 0
  v_mov_b32 v28, 0
  v_mov_b32 v29, 0
  v_mov_b32 v30, 0
  v_mov_b32 v31, 0
  v_mov_b32 v32, 0
  v_mov_b32 v33, 0
  v_mov_b32 v34, 0
  v_mov_b32 v35, 0
  v_mov_b32 v36, 0
  v_mov_b32 v37, 0
  v_mov_b32 v38, 0
  v_mov_b32 v39, 0
  s_mov_b64 exec, vcc
tail_kernel_poll2_9:
  buffer_load_dwordx4 v[16:19], v8, s[8:11], s36 offen offset:0 sc1
  buffer_load_dwordx4 v[20:23], v8, s[8:11], s36 offen offset:512 sc1
  buffer_load_dwordx4 v[24:27], v8, s[8:11], s36 offen offset:1024 sc1
  buffer_load_dwordx4 v[28:31], v8, s[8:11], s36 offen offset:1536 sc1
  buffer_load_dwordx4 v[32:35], v8, s[8:11], s36 offen offset:2048 sc1
  buffer_load_dwordx4 v[36:39], v8, s[8:11], s36 offen offset:2560 sc1
  s_add_u32 s41, s41, 1
  s_waitcnt vmcnt(5)
  v_max3_u32 v11, v16, v17, v18
  v_mov_b32 v12, v19
  s_waitcnt vmcnt(4)
  v_max3_u32 v11, v11, v20, v21
  v_max3_u32 v12, v12, v22, v23
  s_waitcnt vmcnt(3)
  v_max3_u32 v11, v11, v24, v25
  v_max3_u32 v12, v12, v26, v27
  s_waitcnt vmcnt(2)
  v_max3_u32 v11, v11, v28, v29
  v_max3_u32 v12, v12, v30, v31
  s_waitcnt vmcnt(1)
  v_max3_u32 v11, v11, v32, v33
  v_max3_u32 v12, v12, v34, v35
  s_waitcnt vmcnt(0)
  v_max3_u32 v11, v11, v36, v37
  v_max3_u32 v12, v12, v38, v39
  v_max_u32 v11, v11, v12
  v_cmp_eq_u32 vcc, -1, v11
  s_and_b64 exec, exec, vcc
  s_cbranch_execz tail_kernel_pd2_10
  s_cmp_lt_u32 s41, 262144
  s_cbranch_scc1 tail_kernel_poll2_9
tail_kernel_pd2_10:
  s_mov_b64 exec, -1
  s_waitcnt lgkmcnt(0)
  v_mfma_f32_16x16x32_bf16 v[96:99], v[104:107], v[16:19], 0
  v_mfma_f32_16x16x32_bf16 v[96:99], v[108:111], v[20:23], v[96:99]
  v_mfma_f32_16x16x32_bf16 v[96:99], v[112:115], v[24:27], v[96:99]
  v_mfma_f32_16x16x32_bf16 v[96:99], v[116:119], v[28:31], v[96:99]
  v_mfma_f32_16x16x32_bf16 v[96:99], v[120:123], v[32:35], v[96:99]
  v_mfma_f32_16x16x32_bf16 v[96:99], v[124:127], v[36:39], v[96:99]
  s_lshl_b32 s36, s32, 10
  v_add_u32 v8, s36, v2
  s_nop 5
  ds_write_b128 v8, v[96:99] offset:56832
  s_waitcnt lgkmcnt(0)
  s_barrier
  s_endpgm
tail_kernel_dma_2:
  s_nop 15
  s_sub_u32 s37, s32, 10
  s_barrier
  v_lshlrev_b32 v1, 4, v0
  s_cmp_eq_u32 s43, 1
  s_cbranch_scc1 tail_kernel_dd_11
  s_mul_i32 s36, s35, 20480
  s_mul_i32 s42, s37, 10240
  s_add_u32 s36, s36, s42
  s_add_u32 s36, s36, 83886080
  s_mul_i32 m0, s37, 10304
  s_nop 0
  buffer_load_dwordx4 v1, s[8:11], s36 offen offset:0 lds
  buffer_load_dwordx4 v1, s[8:11], s36 offen offset:1024 lds
  buffer_load_dwordx4 v1, s[8:11], s36 offen offset:2048 lds
  buffer_load_dwordx4 v1, s[8:11], s36 offen offset:3072 lds
  s_add_u32 m0, m0, 4096
  s_add_u32 s36, s36, 4096
  buffer_load_dwordx4 v1, s[8:11], s36 offen offset:0 lds
  buffer_load_dwordx4 v1, s[8:11], s36 offen offset:1024 lds
  buffer_load_dwordx4 v1, s[8:11], s36 offen offset:2048 lds
  buffer_load_dwordx4 v1, s[8:11], s36 offen offset:3072 lds
  s_add_u32 m0, m0, 4096
  s_add_u32 s36, s36, 4096
  buffer_load_dwordx4 v1, s[8:11], s36 offen offset:0 lds
  buffer_load_dwordx4 v1, s[8:11], s36 offen offset:1024 lds
  s_barrier
  s_branch tail_kernel_dj_12
tail_kernel_dd_11:
  s_nop 15
  s_barrier
  s_barrier
  s_mul_i32 s36, s35, 55296
  s_mul_i32 m0, s37, 27648
  s_add_u32 s36, s36, m0
  s_add_u32 s36, s36, 88342528
  buffer_load_dwordx4 v1, s[8:11], s36 offen offset:0 lds
  buffer_load_dwordx4 v1, s[8:11], s36 offen offset:1024 lds
  buffer_load_dwordx4 v1, s[8:11], s36 offen offset:2048 lds
  buffer_load_dwordx4 v1, s[8:11], s36 offen offset:3072 lds
  s_add_u32 m0, m0, 4096
  s_add_u32 s36, s36, 4096
  buffer_load_dwordx4 v1, s[8:11], s36 offen offset:0 lds
  buffer_load_dwordx4 v1, s[8:11], s36 offen offset:1024 lds
  buffer_load_dwordx4 v1, s[8:11], s36 offen offset:2048 lds
  buffer_load_dwordx4 v1, s[8:11], s36 offen offset:3072 lds
  s_add_u32 m0, m0, 4096
  s_add_u32 s36, s36, 4096
  buffer_load_dwordx4 v1, s[8:11], s36 offen offset:0 lds
  buffer_load_dwordx4 v1, s[8:11], s36 offen offset:1024 lds
  buffer_load_dwordx4 v1, s[8:11], s36 offen offset:2048 lds
  buffer_load_dwordx4 v1, s[8:11], s36 offen offset:3072 lds
  s_add_u32 m0, m0, 4096
  s_add_u32 s36, s36, 4096
  buffer_load_dwordx4 v1, s[8:11], s36 offen offset:0 lds
  buffer_load_dwordx4 v1, s[8:11], s36 offen offset:1024 lds
  buffer_load_dwordx4 v1, s[8:11], s36 offen offset:2048 lds
  buffer_load_dwordx4 v1, s[8:11], s36 offen offset:3072 lds
  s_add_u32 m0, m0, 4096
  s_add_u32 s36, s36, 4096
  buffer_load_dwordx4 v1, s[8:11], s36 offen offset:0 lds
  buffer_load_dwordx4 v1, s[8:11], s36 offen offset:1024 lds
  buffer_load_dwordx4 v1, s[8:11], s36 offen offset:2048 lds
  buffer_load_dwordx4 v1, s[8:11], s36 offen offset:3072 lds
  s_add_u32 m0, m0, 4096
  s_add_u32 s36, s36, 4096
  buffer_load_dwordx4 v1, s[8:11], s36 offen offset:0 lds
  buffer_load_dwordx4 v1, s[8:11], s36 offen offset:1024 lds
  buffer_load_dwordx4 v1, s[8:11], s36 offen offset:2048 lds
  buffer_load_dwordx4 v1, s[8:11], s36 offen offset:3072 lds
  s_add_u32 m0, m0, 4096
  s_add_u32 s36, s36, 4096
  buffer_load_dwordx4 v1, s[8:11], s36 offen offset:0 lds
  buffer_load_dwordx4 v1, s[8:11], s36 offen offset:1024 lds
  buffer_load_dwordx4 v1, s[8:11], s36 offen offset:2048 lds
  s_cmp_eq_u32 s32, 10
  s_cbranch_scc1 tail_kernel_w10_13
  s_barrier
  s_waitcnt vmcnt(0)
  s_barrier
  s_endpgm
tail_kernel_dj_12:
  s_nop 15
  s_waitcnt vmcnt(0)
  s_barrier
  s_cmp_eq_u32 s32, 10
  s_cbranch_scc1 tail_kernel_w10_13
  s_endpgm
tail_kernel_w10_13:
  s_nop 15
  v_and_b32 v7, 7, v0
  v_lshlrev_b32 v5, 2, v7
  s_barrier
  ds_read_b32 v6, v5 offset:56576
  v_lshrrev_b32 v4, 4, v0
  s_waitcnt lgkmcnt(0)
  v_and_b32 v5, 0x7ff, v6
  v_sub_u32 v5, 2047, v5
  v_mul_u32_u24 v5, 1280, v5
  s_cmp_eq_u32 s43, 1
  s_cbranch_scc1 tail_kernel_f2_14
  v_lshl_add_u32 v5, v4, 4, v5
  s_mov_b32 s36, 7340032
  buffer_load_dwordx4 v[16:19], v5, s[8:11], s36 offen offset:0 sc1
  buffer_load_dwordx4 v[20:23], v5, s[8:11], s36 offen offset:64 sc1
  buffer_load_dwordx4 v[24:27], v5, s[8:11], s36 offen offset:128 sc1
  buffer_load_dwordx4 v[28:31], v5, s[8:11], s36 offen offset:192 sc1
  buffer_load_dwordx4 v[32:35], v5, s[8:11], s36 offen offset:256 sc1
  buffer_load_dwordx4 v[36:39], v5, s[8:11], s36 offen offset:320 sc1
  buffer_load_dwordx4 v[40:43], v5, s[8:11], s36 offen offset:384 sc1
  buffer_load_dwordx4 v[44:47], v5, s[8:11], s36 offen offset:448 sc1
  buffer_load_dwordx4 v[48:51], v5, s[8:11], s36 offen offset:512 sc1
  buffer_load_dwordx4 v[52:55], v5, s[8:11], s36 offen offset:576 sc1
  buffer_load_dwordx4 v[56:59], v5, s[8:11], s36 offen offset:640 sc1
  buffer_load_dwordx4 v[60:63], v5, s[8:11], s36 offen offset:704 sc1
  buffer_load_dwordx4 v[64:67], v5, s[8:11], s36 offen offset:768 sc1
  buffer_load_dwordx4 v[68:71], v5, s[8:11], s36 offen offset:832 sc1
  buffer_load_dwordx4 v[72:75], v5, s[8:11], s36 offen offset:896 sc1
  buffer_load_dwordx4 v[76:79], v5, s[8:11], s36 offen offset:960 sc1
  buffer_load_dwordx4 v[80:83], v5, s[8:11], s36 offen offset:1024 sc1
  buffer_load_dwordx4 v[84:87], v5, s[8:11], s36 offen offset:1088 sc1
  buffer_load_dwordx4 v[88:91], v5, s[8:11], s36 offen offset:1152 sc1
  buffer_load_dwordx4 v[92:95], v5, s[8:11], s36 offen offset:1216 sc1
  v_lshlrev_b32 v1, 7, v4
  v_bfe_u32 v2, v0, 2, 2
  v_lshl_add_u32 v1, v2, 4, v1
  v_and_b32 v2, 1, v0
  v_lshl_add_u32 v1, v2, 3, v1
  v_bfe_u32 v2, v0, 1, 1
  v_mul_u32_u24 v2, 10304, v2
  v_add_u32 v1, v1, v2
  ds_read_b64_tr_b16 v[96:97], v1 offset:0
  ds_read_b64_tr_b16 v[98:99], v1 offset:64
  ds_read_b64_tr_b16 v[100:101], v1 offset:512
  ds_read_b64_tr_b16 v[102:103], v1 offset:576
  ds_read_b64_tr_b16 v[104:105], v1 offset:1024
  ds_read_b64_tr_b16 v[106:107], v1 offset:1088
  ds_read_b64_tr_b16 v[108:109], v1 offset:1536
  ds_read_b64_tr_b16 v[110:111], v1 offset:1600
  ds_read_b64_tr_b16 v[112:113], v1 offset:2048
  ds_read_b64_tr_b16 v[114:115], v1 offset:2112
  ds_read_b64_tr_b16 v[116:117], v1 offset:2560
  ds_read_b64_tr_b16 v[118:119], v1 offset:2624
  ds_read_b64_tr_b16 v[120:121], v1 offset:3072
  ds_read_b64_tr_b16 v[122:123], v1 offset:3136
  ds_read_b64_tr_b16 v[124:125], v1 offset:3584
  ds_read_b64_tr_b16 v[126:127], v1 offset:3648
  ds_read_b64_tr_b16 v[128:129], v1 offset:4096
  ds_read_b64_tr_b16 v[130:131], v1 offset:4160
  ds_read_b64_tr_b16 v[132:133], v1 offset:4608
  ds_read_b64_tr_b16 v[134:135], v1 offset:4672
  ds_read_b64_tr_b16 v[136:137], v1 offset:5120
  ds_read_b64_tr_b16 v[138:139], v1 offset:5184
  ds_read_b64_tr_b16 v[140:141], v1 offset:5632
  ds_read_b64_tr_b16 v[142:143], v1 offset:5696
  ds_read_b64_tr_b16 v[144:145], v1 offset:6144
  ds_read_b64_tr_b16 v[146:147], v1 offset:6208
  ds_read_b64_tr_b16 v[148:149], v1 offset:6656
  ds_read_b64_tr_b16 v[150:151], v1 offset:6720
  ds_read_b64_tr_b16 v[152:153], v1 offset:7168
  ds_read_b64_tr_b16 v[154:155], v1 offset:7232
  ds_read_b64_tr_b16 v[156:157], v1 offset:7680
  ds_read_b64_tr_b16 v[158:159], v1 offset:7744
  v_lshlrev_b32 v2, 4, v7
  v_lshl_add_u32 v2, v4, 3, v2
  s_lshl_b32 s37, s35, 7
  s_add_u32 s37, s37, 131072
  s_mov_b32 s42, 1069066811
  v_and_b32 v3, 0x28, v0
  s_waitcnt lgkmcnt(0)
  s_waitcnt vmcnt(19)
  v_mfma_f32_16x16x32_bf16 v[8:11], v[96:99], v[16:19], 0
  ds_read_b64_tr_b16 v[96:97], v1 offset:8192
  ds_read_b64_tr_b16 v[98:99], v1 offset:8256
  s_waitcnt vmcnt(18)
  v_mfma_f32_16x16x32_bf16 v[12:15], v[100:103], v[20:23], 0
  ds_read_b64_tr_b16 v[100:101], v1 offset:8704
  ds_read_b64_tr_b16 v[102:103], v1 offset:8768
  s_waitcnt vmcnt(17)
  v_mfma_f32_16x16x32_bf16 v[8:11], v[104:107], v[24:27], v[8:11]
  ds_read_b64_tr_b16 v[104:105], v1 offset:9216
  ds_read_b64_tr_b16 v[106:107], v1 offset:9280
  s_waitcnt vmcnt(16)
  v_mfma_f32_16x16x32_bf16 v[12:15], v[108:111], v[28:31], v[12:15]
  ds_read_b64_tr_b16 v[108:109], v1 offset:9728
  ds_read_b64_tr_b16 v[110:111], v1 offset:9792
  s_waitcnt vmcnt(15)
  v_mfma_f32_16x16x32_bf16 v[8:11], v[112:115], v[32:35], v[8:11]
  s_waitcnt vmcnt(14)
  v_mfma_f32_16x16x32_bf16 v[12:15], v[116:119], v[36:39], v[12:15]
  s_waitcnt vmcnt(13)
  v_mfma_f32_16x16x32_bf16 v[8:11], v[120:123], v[40:43], v[8:11]
  s_waitcnt vmcnt(12)
  v_mfma_f32_16x16x32_bf16 v[12:15], v[124:127], v[44:47], v[12:15]
  s_waitcnt vmcnt(11)
  v_mfma_f32_16x16x32_bf16 v[8:11], v[128:131], v[48:51], v[8:11]
  s_waitcnt vmcnt(10)
  v_mfma_f32_16x16x32_bf16 v[12:15], v[132:135], v[52:55], v[12:15]
  s_waitcnt vmcnt(9)
  v_mfma_f32_16x16x32_bf16 v[8:11], v[136:139], v[56:59], v[8:11]
  s_waitcnt vmcnt(8)
  v_mfma_f32_16x16x32_bf16 v[12:15], v[140:143], v[60:63], v[12:15]
  s_waitcnt vmcnt(7)
  v_mfma_f32_16x16x32_bf16 v[8:11], v[144:147], v[64:67], v[8:11]
  s_waitcnt vmcnt(6)
  v_mfma_f32_16x16x32_bf16 v[12:15], v[148:151], v[68:71], v[12:15]
  s_waitcnt vmcnt(5)
  v_mfma_f32_16x16x32_bf16 v[8:11], v[152:155], v[72:75], v[8:11]
  s_waitcnt vmcnt(4)
  v_mfma_f32_16x16x32_bf16 v[12:15], v[156:159], v[76:79], v[12:15]
  s_waitcnt vmcnt(3) lgkmcnt(6)
  v_mfma_f32_16x16x32_bf16 v[8:11], v[96:99], v[80:83], v[8:11]
  s_waitcnt vmcnt(2) lgkmcnt(4)
  v_mfma_f32_16x16x32_bf16 v[12:15], v[100:103], v[84:87], v[12:15]
  s_waitcnt vmcnt(1) lgkmcnt(2)
  v_mfma_f32_16x16x32_bf16 v[8:11], v[104:107], v[88:91], v[8:11]
  s_waitcnt vmcnt(0) lgkmcnt(0)
  v_mfma_f32_16x16x32_bf16 v[12:15], v[108:111], v[92:95], v[12:15]
  s_nop 7
  v_add_f32 v8, v8, v12
  v_add_f32 v9, v9, v13
  v_add_f32 v10, v10, v14
  v_add_f32 v11, v11, v15
  v_cvt_pk_bf16_f32 v16, v8, v9
  v_lshlrev_b32 v8, 16, v16
  v_and_b32 v9, 0xffff0000, v16
  v_cvt_pk_bf16_f32 v16, v10, v11
  v_lshlrev_b32 v10, 16, v16
  v_and_b32 v11, 0xffff0000, v16
  v_mov_b32 v12, v8
  s_nop 1
  v_permlane32_swap_b32 v8, v12
  v_mov_b32 v13, v9
  s_nop 1
  v_permlane32_swap_b32 v9, v13
  v_mov_b32 v14, v10
  s_nop 1
  v_permlane32_swap_b32 v10, v14
  v_mov_b32 v15, v11
  s_nop 1
  v_permlane32_swap_b32 v11, v15
  v_mul_f32 v16, s42, v8
  v_exp_f32 v16, -v16
  v_mul_f32 v17, s42, v9
  v_exp_f32 v17, -v17
  v_mul_f32 v18, s42, v10
  v_exp_f32 v18, -v18
  v_mul_f32 v19, s42, v11
  v_exp_f32 v19, -v19
  v_add_f32 v16, 1.0, v16
  v_rcp_f32 v16, v16
  v_add_f32 v17, 1.0, v17
  v_rcp_f32 v17, v17
  v_add_f32 v18, 1.0, v18
  v_rcp_f32 v18, v18
  v_add_f32 v19, 1.0, v19
  v_rcp_f32 v19, v19
  v_mul_f32 v8, v8, v16
  v_mul_f32 v9, v9, v17
  v_mul_f32 v10, v10, v18
  v_mul_f32 v11, v11, v19
  v_cvt_pk_bf16_f32 v16, v8, v9
  v_lshlrev_b32 v8, 16, v16
  v_and_b32 v9, 0xffff0000, v16
  v_cvt_pk_bf16_f32 v16, v10, v11
  v_lshlrev_b32 v10, 16, v16
  v_and_b32 v11, 0xffff0000, v16
  v_mul_f32 v8, v8, v12
  v_mul_f32 v9, v9, v13
  v_mul_f32 v10, v10, v14
  v_mul_f32 v11, v11, v15
  v_cvt_pk_bf16_f32 v8, v8, v9
  v_cvt_pk_bf16_f32 v9, v10, v11
  v_min_u32 v8, -2, v8
  v_min_u32 v9, -2, v9
  v_cmp_eq_u32 vcc, 0, v3
  s_and_saveexec_b64 s[46:47], vcc
  buffer_store_dwordx2 v[8:9], v2, s[8:11], s37 offen sc1
  s_mov_b64 exec, s[46:47]
  s_endpgm
tail_kernel_f2_14:
  s_nop 15
  v_lshl_add_u32 v5, v4, 3, v5
  s_lshl_b32 s37, s35, 5
  s_add_u32 s36, s37, 7340032
  buffer_load_dwordx2 v[8:9], v5, s[8:11], s36 offen sc1
  s_add_u32 s36, s37, 4194304
  buffer_load_dwordx2 v[10:11], v5, s[8:11], s36 offen sc1
  v_lshlrev_b32 v1, 4, v4
  s_lshl_b32 s36, s35, 6
  s_add_u32 s36, s36, 12800
  buffer_load_dwordx4 v[12:15], v1, s[8:11], s36 offen
  s_mov_b32 s42, 1069066811
  v_and_b32 v6, 0xffff0000, v6
  v_ashrrev_i32 v2, 31, v6
  v_not_b32 v2, v2
  v_or_b32 v2, 0x80000000, v2
  v_xor_b32 v6, v6, v2
  v_and_b32 v6, 0xffff0000, v6
  v_mul_f32 v6, s42, v6
  v_exp_f32 v6, -v6
  s_nop 0
  v_add_f32 v6, 1.0, v6
  v_rcp_f32 v6, v6
  s_nop 0
  v_cvt_pk_bf16_f32 v6, v6, v6
  v_lshlrev_b32 v6, 16, v6
  v_lshlrev_b32 v1, 4, v0
  v_and_b32 v3, 8, v0
  s_waitcnt vmcnt(0)
  s_barrier
  v_lshlrev_b32 v56, 16, v8
  v_and_b32 v57, 0xffff0000, v8
  v_lshlrev_b32 v58, 16, v9
  v_and_b32 v59, 0xffff0000, v9
  v_lshlrev_b32 v60, 16, v10
  v_and_b32 v61, 0xffff0000, v10
  v_lshlrev_b32 v62, 16, v11
  v_and_b32 v63, 0xffff0000, v11
  s_barrier
  ds_read_b128 v[16:19], v1 offset:56832
  ds_read_b128 v[20:23], v1 offset:57856
  ds_read_b128 v[24:27], v1 offset:58880
  ds_read_b128 v[28:31], v1 offset:59904
  ds_read_b128 v[32:35], v1 offset:60928
  ds_read_b128 v[36:39], v1 offset:61952
  ds_read_b128 v[40:43], v1 offset:62976
  ds_read_b128 v[44:47], v1 offset:64000
  ds_read_b128 v[48:51], v1 offset:65024
  s_waitcnt lgkmcnt(7)
  v_add_f32 v16, v16, v20
  v_add_f32 v17, v17, v21
  v_add_f32 v18, v18, v22
  v_add_f32 v19, v19, v23
  s_waitcnt lgkmcnt(6)
  v_add_f32 v16, v16, v24
  v_add_f32 v17, v17, v25
  v_add_f32 v18, v18, v26
  v_add_f32 v19, v19, v27
  s_waitcnt lgkmcnt(5)
  v_add_f32 v16, v16, v28
  v_add_f32 v17, v17, v29
  v_add_f32 v18, v18, v30
  v_add_f32 v19, v19, v31
  s_waitcnt lgkmcnt(4)
  v_add_f32 v16, v16, v32
  v_add_f32 v17, v17, v33
  v_add_f32 v18, v18, v34
  v_add_f32 v19, v19, v35
  s_waitcnt lgkmcnt(3)
  v_add_f32 v16, v16, v36
  v_add_f32 v17, v17, v37
  v_add_f32 v18, v18, v38
  v_add_f32 v19, v19, v39
  s_waitcnt lgkmcnt(2)
  v_add_f32 v16, v16, v40
  v_add_f32 v17, v17, v41
  v_add_f32 v18, v18, v42
  v_add_f32 v19, v19, v43
  s_waitcnt lgkmcnt(1)
  v_add_f32 v16, v16, v44
  v_add_f32 v17, v17, v45
  v_add_f32 v18, v18, v46
  v_add_f32 v19, v19, v47
  s_waitcnt lgkmcnt(0)
  v_add_f32 v16, v16, v48
  v_add_f32 v17, v17, v49
  v_add_f32 v18, v18, v50
  v_add_f32 v19, v19, v51
  v_cvt_pk_bf16_f32 v2, v16, v17
  v_lshlrev_b32 v16, 16, v2
  v_and_b32 v17, 0xffff0000, v2
  v_cvt_pk_bf16_f32 v2, v18, v19
  v_lshlrev_b32 v18, 16, v2
  v_and_b32 v19, 0xffff0000, v2
  v_mul_f32 v16, v16, v6
  v_mul_f32 v17, v17, v6
  v_mul_f32 v18, v18, v6
  v_mul_f32 v19, v19, v6
  v_cvt_pk_bf16_f32 v2, v16, v17
  v_lshlrev_b32 v16, 16, v2
  v_and_b32 v17, 0xffff0000, v2
  v_cvt_pk_bf16_f32 v2, v18, v19
  v_lshlrev_b32 v18, 16, v2
  v_and_b32 v19, 0xffff0000, v2
  v_add_f32 v16, v16, v56
  v_add_f32 v17, v17, v57
  v_add_f32 v18, v18, v58
  v_add_f32 v19, v19, v59
  v_cvt_pk_bf16_f32 v2, v16, v17
  v_lshlrev_b32 v16, 16, v2
  v_and_b32 v17, 0xffff0000, v2
  v_cvt_pk_bf16_f32 v2, v18, v19
  v_lshlrev_b32 v18, 16, v2
  v_and_b32 v19, 0xffff0000, v2
  v_mul_f32 v16, v16, v12
  v_mul_f32 v17, v17, v13
  v_mul_f32 v18, v18, v14
  v_mul_f32 v19, v19, v15
  v_cvt_pk_bf16_f32 v2, v16, v17
  v_lshlrev_b32 v16, 16, v2
  v_and_b32 v17, 0xffff0000, v2
  v_cvt_pk_bf16_f32 v2, v18, v19
  v_lshlrev_b32 v18, 16, v2
  v_and_b32 v19, 0xffff0000, v2
  v_add_f32 v16, v16, v60
  v_add_f32 v17, v17, v61
  v_add_f32 v18, v18, v62
  v_add_f32 v19, v19, v63
  v_cvt_pk_bf16_f32 v16, v16, v17
  v_cvt_pk_bf16_f32 v17, v18, v19
  v_cmp_eq_u32 vcc, 0, v3
  s_and_saveexec_b64 s[46:47], vcc
  buffer_store_dwordx2 v[16:17], v5, s[12:15], s37 offen
  s_mov_b64 exec, s[46:47]
  s_endpgm
.Lend_tail_kernel:
.Ltext_end:
.section .rodata,"a"
.p2align 6
.amdhsa_kernel kva_kernel
  .amdhsa_next_free_vgpr 256
  .amdhsa_next_free_sgpr 102
  .amdhsa_accum_offset 256
  .amdhsa_group_segment_fixed_size 0
  .amdhsa_kernarg_size 128
  .amdhsa_user_sgpr_count 2
  .amdhsa_user_sgpr_kernarg_segment_ptr 1
  .amdhsa_system_sgpr_workgroup_id_x 1
.end_amdhsa_kernel
.p2align 6
.amdhsa_kernel tail_kernel
  .amdhsa_next_free_vgpr 160
  .amdhsa_next_free_sgpr 102
  .amdhsa_accum_offset 160
  .amdhsa_group_segment_fixed_size 0
  .amdhsa_kernarg_size 128
  .amdhsa_user_sgpr_count 2
  .amdhsa_user_sgpr_kernarg_segment_ptr 1
  .amdhsa_system_sgpr_workgroup_id_x 1
.end_amdhsa_kernel
```
